```python
import torch

def _softmax(x, axis=-1):
    return torch.softmax(x, dim=axis)
def _gelu(x):
    return torch.nn.functional.gelu(x, approximate="tanh")
def _silu(x):
    return torch.nn.functional.silu(x)
def _sigmoid(x):
    return torch.sigmoid(x)
def _layernorm(x, axis=-1, eps=1e-5):
    m = x.mean(dim=axis, keepdim=True)
    v = x.var(dim=axis, keepdim=True, unbiased=False)
    return (x - m) / torch.sqrt(v + eps)
def _scatter_add(tgt, idx, src, axis=0):
    return tgt.clone().index_add_(axis, idx, src)
def _segment_sum(src, seg, n):
    out = torch.zeros((n,) + src.shape[1:], dtype=src.dtype)
    return out.index_add_(0, seg, src)
def _pad(x, pw):
    flat = tuple(v for pair in reversed(pw) for v in pair)
    return torch.nn.functional.pad(x, flat)

kernel_name = 'sequential_preLN__ssm_conv_s4__dense_activation_mish__prompt'

def setup_inputs():

    _w = (lambda a: (lambda t: t.to(torch.bfloat16) if t.is_floating_point() else t)(torch.as_tensor(a)))
    def _A_setup():
        B, L, D, N = 1, 2048, 640, 128
        A_re = -(lambda _x: torch.exp(torch.as_tensor(_x)))((lambda *s: torch.randn(*s, dtype=torch.bfloat16) * 6.4)(D, N))
        A_im = torch.pi * (lambda *s: torch.randn(*s, dtype=torch.bfloat16) * 0.05)(D, N)
        B_re = (lambda *s: torch.randn(*s, dtype=torch.bfloat16) * 0.1)(D, N)
        B_im = (lambda *s: torch.randn(*s, dtype=torch.bfloat16) * 0.1)(D, N)
        C_re = (lambda *s: torch.randn(*s, dtype=torch.bfloat16) * 0.1)(D, N)
        C_im = (lambda *s: torch.randn(*s, dtype=torch.bfloat16) * 0.1)(D, N)
        log_dt = (lambda *s: torch.randn(*s, dtype=torch.bfloat16) * 0.05)(D) * 0.5 - 4.0
        Dskip = (lambda *s: torch.randn(*s, dtype=torch.bfloat16) * 0.05)(D)
        return {
            "u": _w((lambda *s: torch.randn(*s, dtype=torch.bfloat16) * 0.05)(B, L, D)),
            "A_re": _w(A_re),
            "A_im": _w(A_im),
            "B_re": _w(B_re),
            "B_im": _w(B_im),
            "C_re": _w(C_re),
            "C_im": _w(C_im),
            "log_dt": _w(log_dt),
            "Dskip": _w(Dskip),
        }
    _A_in = _A_setup()

    def _B_setup():
        B, S, D, F = 1, 2048, 640, 1728
        return {
            "x": _w((lambda *s: torch.randn(*s, dtype=torch.bfloat16) * 0.05)(B, S, D)),
            "w1": _w((lambda *s: torch.randn(*s, dtype=torch.bfloat16) * 0.8)(D, F) * (D ** -0.5)),
            "b1": _w((lambda *s: torch.randn(*s, dtype=torch.bfloat16) * 0.2)(F)),
            "w2": _w((lambda *s: torch.randn(*s, dtype=torch.bfloat16) * 0.2)(F, D) * (F ** -0.5)),
        }
    _B_in = _B_setup()

    return {
        "A_u": _A_in["u"],
        "A_A_re": _A_in["A_re"],
        "A_A_im": _A_in["A_im"],
        "A_B_re": _A_in["B_re"],
        "A_B_im": _A_in["B_im"],
        "A_C_re": _A_in["C_re"],
        "A_C_im": _A_in["C_im"],
        "A_log_dt": _A_in["log_dt"],
        "A_Dskip": _A_in["Dskip"],
        "B_x": _B_in["x"],
        "B_w1": _B_in["w1"],
        "B_b1": _B_in["b1"],
        "B_w2": _B_in["w2"],
    }

def reference(A_u, A_A_re, A_A_im, A_B_re, A_B_im, A_C_re, A_C_im, A_log_dt, A_Dskip, B_x, B_w1, B_b1, B_w2):
    def _A_ref(u, A_re, A_im, B_re, B_im, C_re, C_im, log_dt, Dskip):
        Bsz, L, D = u.shape
        dt = torch.exp(log_dt)[:, None]
        A = A_re + 1j * A_im
        Bc = B_re + 1j * B_im
        Cc = C_re + 1j * C_im
        logdA = dt * A
        dB = dt * Bc
        l = (lambda x, dt: x.to(dt))(torch.arange(L), A_re.dtype)
        P = torch.exp(logdA[:, :, None] * l[None, None, :])
        K = torch.einsum("dn,dnl,dn->dl", Cc, P, dB).real
        L2 = 2 * L
        Kp = _pad(K, ((0, 0), (0, L)))
        up = (lambda x, *d: x.permute(*d))(u, 0, 2, 1)
        up = _pad(up, ((0, 0), (0, 0), (0, L)))
        Kf = (lambda x, axes=(-2,-1): torch.fft.rfft2(x.float(), dim=axes))(Kp[:, None, :], axes=(-2, -1))
        Uf = (lambda x, axes=(-2,-1): torch.fft.rfft2(x.float(), dim=axes))(up[:, :, None, :], axes=(-2, -1))
        Yf = Uf * Kf[None, :, :, :]
        y = (lambda x, s, axes=(-2,-1): torch.fft.irfft2(x, s=s, dim=axes).to(torch.bfloat16))(Yf, (1, L2), axes=(-2, -1))[:, :, 0, :L]
        y = (lambda x, *d: x.permute(*d))(y, 0, 2, 1) + u * Dskip[None, None, :]
        return y

    def _B_ref(x, w1, b1, w2):
        h = torch.einsum("bsd,df->bsf", x, w1) + b1
        sp = torch.log1p(torch.exp(-torch.abs(h))) + torch.where(h > 0, h, torch.zeros_like(h))
        act = h * torch.tanh(sp)
        return torch.einsum("bsf,fd->bsd", act, w2)

    x = A_u
    h = x + _A_ref(_layernorm(x, axis=-1), A_A_re, A_A_im, A_B_re, A_B_im, A_C_re, A_C_im, A_log_dt, A_Dskip)
    h2 = h + _B_ref(_layernorm(h, axis=-1), B_w1, B_b1, B_w2)
    return h2
```

```asm
; @launch grid=(256,1,1) block=(512,1,1) lds=163840
.amdgcn_target "amdgcn-amd-amdhsa--gfx950"
.text
.globl sequential_preLN__ssm_conv_s4__dense_activation_mish__prompt_kernel
.p2align 8
.type sequential_preLN__ssm_conv_s4__dense_activation_mish__prompt_kernel,@function
sequential_preLN__ssm_conv_s4__dense_activation_mish__prompt_kernel:
    s_cmp_ge_u32 s2, 256
    s_cbranch_scc1 P_END
    s_load_dwordx16 s[64:79], s[0:1], 0
    s_load_dwordx16 s[80:95], s[0:1], 64
    v_and_b32 v1, 63, v0
    v_lshrrev_b32 v2, 6, v0
    s_nop 0
    v_readfirstlane_b32 s3, v2
    v_lshlrev_b32 v3, 2, v1
    v_add_u32 v3, 161792, v3
    v_mov_b32 v4, 0
    ds_write_b32 v3, v4
    ds_write_b32 v3, v4 offset:256
    s_and_b32 s24, s3, 3
    s_and_b32 s20, s2, 7
    s_lshr_b32 s21, s2, 3
    s_lshr_b32 s22, s20, 1
    s_lshl_b32 s22, s22, 2
    s_and_b32 s23, s21, 3
    s_add_u32 s22, s22, s23
    s_and_b32 s23, s20, 1
    s_lshl_b32 s23, s23, 3
    s_lshr_b32 s25, s21, 2
    s_add_u32 s23, s23, s25
    s_mul_i32 s48, s20, 20
    s_add_u32 s48, s48, s21
    s_mul_i32 s25, s20, 12
    s_add_u32 s25, s25, s21
    s_sub_u32 s25, s25, 20
    s_cmp_ge_u32 s21, 20
    s_cselect_b32 s48, s25, s48
    s_waitcnt lgkmcnt(0)
    s_barrier
    s_mov_b32 s8, s94
    s_mov_b32 s9, s95
    s_mov_b32 s10, 0xdf0000
    s_mov_b32 s11, 0x20000
    s_mov_b32 s60, s92
    s_mov_b32 s61, s93
    s_mov_b32 s62, 0x100
    s_mov_b32 s63, 0x20000
    s_lshr_b32 s47, s3, 2
    s_cmp_ge_u32 s21, 20
    s_cbranch_scc1 NONCONV
    s_cmp_eq_u32 s47, 1
    s_cbranch_scc1 L_CONV
    s_lshl_b32 s25, s48, 2
    s_add_u32 s25, s25, s24
    s_lshl_b32 s26, s25, 8
    v_lshlrev_b32 v3, 1, v1
    s_mov_b32 s12, s66
    s_mov_b32 s13, s67
    s_mov_b32 s14, 0x28000
    s_mov_b32 s15, 0x20000
    buffer_load_ushort v10, v3, s[12:15], s26 offen
    buffer_load_ushort v56, v3, s[12:15], s26 offen offset:128
    s_mov_b32 s12, s68
    s_mov_b32 s13, s69
    s_mov_b32 s14, 0x28000
    s_mov_b32 s15, 0x20000
    buffer_load_ushort v11, v3, s[12:15], s26 offen
    buffer_load_ushort v57, v3, s[12:15], s26 offen offset:128
    s_mov_b32 s12, s70
    s_mov_b32 s13, s71
    s_mov_b32 s14, 0x28000
    s_mov_b32 s15, 0x20000
    buffer_load_ushort v12, v3, s[12:15], s26 offen
    buffer_load_ushort v58, v3, s[12:15], s26 offen offset:128
    s_mov_b32 s12, s72
    s_mov_b32 s13, s73
    s_mov_b32 s14, 0x28000
    s_mov_b32 s15, 0x20000
    buffer_load_ushort v13, v3, s[12:15], s26 offen
    buffer_load_ushort v59, v3, s[12:15], s26 offen offset:128
    s_mov_b32 s12, s74
    s_mov_b32 s13, s75
    s_mov_b32 s14, 0x28000
    s_mov_b32 s15, 0x20000
    buffer_load_ushort v14, v3, s[12:15], s26 offen
    buffer_load_ushort v60, v3, s[12:15], s26 offen offset:128
    s_mov_b32 s12, s76
    s_mov_b32 s13, s77
    s_mov_b32 s14, 0x28000
    s_mov_b32 s15, 0x20000
    buffer_load_ushort v15, v3, s[12:15], s26 offen
    buffer_load_ushort v61, v3, s[12:15], s26 offen offset:128
    s_mov_b32 s12, s78
    s_mov_b32 s13, s79
    s_mov_b32 s14, 0x500
    s_mov_b32 s15, 0x20000
    s_lshl_b32 s27, s25, 1
    v_mov_b32 v4, s27
    buffer_load_ushort v16, v4, s[12:15], 0 offen
    s_mul_i32 s28, s24, 28832
    s_mul_i32 s29, s24, 2816
    s_add_u32 s29, s29, 115328
    s_sub_u32 s30, s29, 68096
    v_lshlrev_b32 v2, 3, v1
    v_sub_u32 v2, 2047, v2
    v_cvt_f32_u32 v3, v2
    v_mov_b32 v4, 4
    v_mov_b32 v7, s30
    v_add_f32 v64, 0x80000000, v3
    v_add_f32 v65, 0xbf800000, v3
    v_add_f32 v66, 0xc0000000, v3
    v_add_f32 v67, 0xc0400000, v3
    v_add_f32 v68, 0xc0800000, v3
    v_add_f32 v69, 0xc0a00000, v3
    v_add_f32 v70, 0xc0c00000, v3
    v_add_f32 v71, 0xc0e00000, v3
    v_add_f32 v72, 0xc1000000, v3
    v_add_f32 v73, 0xc1100000, v3
    v_add_f32 v74, 0xc1200000, v3
    v_cvt_pk_bf16_f32 v64, v64, v65
    v_mad_u32_u16 v112, v64, v4, v7 op_sel:[0,0,0,0]
    v_mad_u32_u16 v113, v64, v4, v7 op_sel:[1,0,0,0]
    v_cvt_pk_bf16_f32 v66, v66, v67
    v_mad_u32_u16 v114, v66, v4, v7 op_sel:[0,0,0,0]
    v_mad_u32_u16 v115, v66, v4, v7 op_sel:[1,0,0,0]
    v_cvt_pk_bf16_f32 v68, v68, v69
    v_mad_u32_u16 v116, v68, v4, v7 op_sel:[0,0,0,0]
    v_mad_u32_u16 v117, v68, v4, v7 op_sel:[1,0,0,0]
    v_cvt_pk_bf16_f32 v70, v70, v71
    v_mad_u32_u16 v118, v70, v4, v7 op_sel:[0,0,0,0]
    v_mad_u32_u16 v119, v70, v4, v7 op_sel:[1,0,0,0]
    v_cvt_pk_bf16_f32 v72, v72, v73
    v_mad_u32_u16 v120, v72, v4, v7 op_sel:[0,0,0,0]
    v_mad_u32_u16 v121, v72, v4, v7 op_sel:[1,0,0,0]
    v_cvt_pk_bf16_f32 v74, v74, v74
    v_mad_u32_u16 v122, v74, v4, v7 op_sel:[0,0,0,0]
    v_add_f32 v64, 0xc4000000, v3
    v_add_f32 v65, 0xc4004000, v3
    v_add_f32 v66, 0xc4008000, v3
    v_add_f32 v67, 0xc400c000, v3
    v_add_f32 v68, 0xc4010000, v3
    v_add_f32 v69, 0xc4014000, v3
    v_add_f32 v70, 0xc4018000, v3
    v_add_f32 v71, 0xc401c000, v3
    v_add_f32 v72, 0xc4020000, v3
    v_add_f32 v73, 0xc4024000, v3
    v_add_f32 v74, 0xc4028000, v3
    v_cvt_pk_bf16_f32 v64, v64, v65
    v_mad_u32_u16 v123, v64, v4, v7 op_sel:[0,0,0,0]
    v_mad_u32_u16 v124, v64, v4, v7 op_sel:[1,0,0,0]
    v_cvt_pk_bf16_f32 v66, v66, v67
    v_mad_u32_u16 v125, v66, v4, v7 op_sel:[0,0,0,0]
    v_mad_u32_u16 v126, v66, v4, v7 op_sel:[1,0,0,0]
    v_cvt_pk_bf16_f32 v68, v68, v69
    v_mad_u32_u16 v127, v68, v4, v7 op_sel:[0,0,0,0]
    v_mad_u32_u16 v128, v68, v4, v7 op_sel:[1,0,0,0]
    v_cvt_pk_bf16_f32 v70, v70, v71
    v_mad_u32_u16 v129, v70, v4, v7 op_sel:[0,0,0,0]
    v_mad_u32_u16 v130, v70, v4, v7 op_sel:[1,0,0,0]
    v_cvt_pk_bf16_f32 v72, v72, v73
    v_mad_u32_u16 v131, v72, v4, v7 op_sel:[0,0,0,0]
    v_mad_u32_u16 v132, v72, v4, v7 op_sel:[1,0,0,0]
    v_cvt_pk_bf16_f32 v74, v74, v74
    v_mad_u32_u16 v133, v74, v4, v7 op_sel:[0,0,0,0]
    v_add_f32 v64, 0xc4800000, v3
    v_add_f32 v65, 0xc4802000, v3
    v_add_f32 v66, 0xc4804000, v3
    v_add_f32 v67, 0xc4806000, v3
    v_add_f32 v68, 0xc4808000, v3
    v_add_f32 v69, 0xc480a000, v3
    v_add_f32 v70, 0xc480c000, v3
    v_add_f32 v71, 0xc480e000, v3
    v_add_f32 v72, 0xc4810000, v3
    v_add_f32 v73, 0xc4812000, v3
    v_add_f32 v74, 0xc4814000, v3
    v_cvt_pk_bf16_f32 v64, v64, v65
    v_mad_u32_u16 v134, v64, v4, v7 op_sel:[0,0,0,0]
    v_mad_u32_u16 v135, v64, v4, v7 op_sel:[1,0,0,0]
    v_cvt_pk_bf16_f32 v66, v66, v67
    v_mad_u32_u16 v136, v66, v4, v7 op_sel:[0,0,0,0]
    v_mad_u32_u16 v137, v66, v4, v7 op_sel:[1,0,0,0]
    v_cvt_pk_bf16_f32 v68, v68, v69
    v_mad_u32_u16 v138, v68, v4, v7 op_sel:[0,0,0,0]
    v_mad_u32_u16 v139, v68, v4, v7 op_sel:[1,0,0,0]
    v_cvt_pk_bf16_f32 v70, v70, v71
    v_mad_u32_u16 v140, v70, v4, v7 op_sel:[0,0,0,0]
    v_mad_u32_u16 v141, v70, v4, v7 op_sel:[1,0,0,0]
    v_cvt_pk_bf16_f32 v72, v72, v73
    v_mad_u32_u16 v142, v72, v4, v7 op_sel:[0,0,0,0]
    v_mad_u32_u16 v143, v72, v4, v7 op_sel:[1,0,0,0]
    v_cvt_pk_bf16_f32 v74, v74, v74
    v_mad_u32_u16 v144, v74, v4, v7 op_sel:[0,0,0,0]
    v_add_f32 v64, 0xc4c00000, v3
    v_add_f32 v65, 0xc4c02000, v3
    v_add_f32 v66, 0xc4c04000, v3
    v_add_f32 v67, 0xc4c06000, v3
    v_add_f32 v68, 0xc4c08000, v3
    v_add_f32 v69, 0xc4c0a000, v3
    v_add_f32 v70, 0xc4c0c000, v3
    v_add_f32 v71, 0xc4c0e000, v3
    v_add_f32 v72, 0xc4c10000, v3
    v_add_f32 v73, 0xc4c12000, v3
    v_add_f32 v74, 0xc4c14000, v3
    v_max_f32 v72, 0, v72
    v_max_f32 v73, 0, v73
    v_max_f32 v74, 0, v74
    v_cvt_u32_f32 v80, v64
    v_cvt_u32_f32 v81, v65
    v_cvt_u32_f32 v82, v66
    v_cvt_u32_f32 v83, v67
    v_cvt_u32_f32 v84, v68
    v_cvt_u32_f32 v85, v69
    v_cvt_u32_f32 v86, v70
    v_cvt_u32_f32 v87, v71
    v_cvt_u32_f32 v88, v72
    v_cvt_u32_f32 v89, v73
    v_cvt_u32_f32 v90, v74
    v_cvt_pk_bf16_f32 v64, v64, v65
    v_mad_u32_u16 v145, v64, v4, v7 op_sel:[0,0,0,0]
    v_mad_u32_u16 v146, v64, v4, v7 op_sel:[1,0,0,0]
    v_cvt_pk_bf16_f32 v66, v66, v67
    v_mad_u32_u16 v147, v66, v4, v7 op_sel:[0,0,0,0]
    v_mad_u32_u16 v148, v66, v4, v7 op_sel:[1,0,0,0]
    v_cvt_pk_bf16_f32 v68, v68, v69
    v_mad_u32_u16 v149, v68, v4, v7 op_sel:[0,0,0,0]
    v_mad_u32_u16 v150, v68, v4, v7 op_sel:[1,0,0,0]
    v_cvt_pk_bf16_f32 v70, v70, v71
    v_mad_u32_u16 v151, v70, v4, v7 op_sel:[0,0,0,0]
    v_mad_u32_u16 v152, v70, v4, v7 op_sel:[1,0,0,0]
    v_cvt_pk_bf16_f32 v72, v72, v73
    v_mad_u32_u16 v153, v72, v4, v7 op_sel:[0,0,0,0]
    v_mad_u32_u16 v154, v72, v4, v7 op_sel:[1,0,0,0]
    v_cvt_pk_bf16_f32 v74, v74, v74
    v_mad_u32_u16 v155, v74, v4, v7 op_sel:[0,0,0,0]
    v_cmp_gt_u32 vcc, 128, v80
    v_lshl_add_u32 v80, v80, 2, s29
    s_nop 0
    v_cndmask_b32 v145, v145, v80, vcc
    v_cmp_gt_u32 vcc, 128, v81
    v_lshl_add_u32 v81, v81, 2, s29
    s_nop 0
    v_cndmask_b32 v146, v146, v81, vcc
    v_cmp_gt_u32 vcc, 128, v82
    v_lshl_add_u32 v82, v82, 2, s29
    s_nop 0
    v_cndmask_b32 v147, v147, v82, vcc
    v_cmp_gt_u32 vcc, 128, v83
    v_lshl_add_u32 v83, v83, 2, s29
    s_nop 0
    v_cndmask_b32 v148, v148, v83, vcc
    v_cmp_gt_u32 vcc, 128, v84
    v_lshl_add_u32 v84, v84, 2, s29
    s_nop 0
    v_cndmask_b32 v149, v149, v84, vcc
    v_cmp_gt_u32 vcc, 128, v85
    v_lshl_add_u32 v85, v85, 2, s29
    s_nop 0
    v_cndmask_b32 v150, v150, v85, vcc
    v_cmp_gt_u32 vcc, 128, v86
    v_lshl_add_u32 v86, v86, 2, s29
    s_nop 0
    v_cndmask_b32 v151, v151, v86, vcc
    v_cmp_gt_u32 vcc, 128, v87
    v_lshl_add_u32 v87, v87, 2, s29
    s_nop 0
    v_cndmask_b32 v152, v152, v87, vcc
    v_cmp_gt_u32 vcc, 128, v88
    v_lshl_add_u32 v88, v88, 2, s29
    s_nop 0
    v_cndmask_b32 v153, v153, v88, vcc
    v_cmp_gt_u32 vcc, 128, v89
    v_lshl_add_u32 v89, v89, 2, s29
    s_nop 0
    v_cndmask_b32 v154, v154, v89, vcc
    v_cmp_gt_u32 vcc, 128, v90
    v_lshl_add_u32 v90, v90, 2, s29
    s_nop 0
    v_cndmask_b32 v155, v155, v90, vcc
    v_and_b32 v8, 15, v1
    v_lshrrev_b32 v9, 4, v1
    v_mul_u32_u24 v97, 544, v8
    v_lshl_add_u32 v97, v9, 4, v97
    v_add_u32 v97, s28, v97
    v_add_u32 v96, 11424, v97
    v_mov_b32 v64, v8
    v_mov_b32 v65, 8
    v_add_u32 v66, 248, v8
    v_cmp_le_u32 vcc, 8, v8
    s_nop 1
    v_cndmask_b32 v64, v64, v66, vcc
    v_mov_b32 v67, 4
    v_cndmask_b32 v65, v65, v67, vcc
    v_add_u32 v66, 372, v8
    v_cmp_le_u32 vcc, 12, v8
    s_nop 1
    v_cndmask_b32 v64, v64, v66, vcc
    v_mov_b32 v67, 2
    v_cndmask_b32 v65, v65, v67, vcc
    v_add_u32 v66, 434, v8
    v_cmp_le_u32 vcc, 14, v8
    s_nop 1
    v_cndmask_b32 v64, v64, v66, vcc
    v_lshlrev_b32 v66, 5, v8
    v_add_u32 v66, 512, v66
    v_mov_b32 v67, 672
    v_cmp_lt_u32 vcc, 4, v8
    s_nop 1
    v_cndmask_b32 v66, v66, v67, vcc
    v_lshlrev_b32 v67, 2, v9
    v_mul_u32_u24 v68, v65, v67
    v_add_u32 v64, v64, v68
    v_add_u32 v66, v66, v67
    v_mov_b32 v68, s29
    v_lshl_add_u32 v100, v64, 2, v68
    v_lshl_add_u32 v98, v66, 2, v68
    v_lshlrev_b32 v65, 2, v65
    v_lshlrev_b32 v69, 4, v65
    v_add_u32 v101, v100, v65
    v_add_u32 v102, v101, v65
    v_add_u32 v103, v102, v65
    v_add_u32 v104, v100, v69
    v_add_u32 v105, v101, v69
    v_add_u32 v106, v102, v69
    v_add_u32 v107, v103, v69
    v_lshlrev_b32 v99, 4, v1
    v_add_u32 v99, s28, v99
    v_and_b32 v64, 15, v1
    v_lshrrev_b32 v65, 2, v64
    v_and_b32 v64, 3, v64
    v_mul_u32_u24 v65, 4160, v65
    v_lshl_add_u32 v108, v64, 3, v65
    v_add_u32 v108, s28, v108
    v_lshlrev_b32 v6, 2, v1
    v_add_u32 v6, s28, v6
    v_add_u32 v5, 11424, v6
    s_waitcnt vmcnt(0)
    v_mov_b32 v52, 161960
    v_mov_b32 v53, 1
    s_mov_b64 exec, 1
    ds_add_u32 v52, v53
    s_mov_b64 exec, -1
    v_lshlrev_b32 v16, 16, v16
    v_mul_f32 v16, 0x3fb8aa3b, v16
    v_exp_f32 v16, v16
    s_nop 0
    v_cvt_pk_bf16_f32 v16, v16, v16
    v_lshlrev_b32 v62, 16, v16
    v_lshlrev_b32 v64, 16, v56
    v_lshlrev_b32 v65, 16, v57
    v_lshlrev_b32 v66, 16, v58
    v_lshlrev_b32 v67, 16, v59
    v_lshlrev_b32 v68, 16, v60
    v_lshlrev_b32 v69, 16, v61
    v_lshlrev_b32 v10, 16, v10
    v_lshlrev_b32 v11, 16, v11
    v_lshlrev_b32 v12, 16, v12
    v_lshlrev_b32 v13, 16, v13
    v_lshlrev_b32 v14, 16, v14
    v_lshlrev_b32 v15, 16, v15
    v_mul_f32 v10, v62, v10
    v_mul_f32 v64, v62, v64
    v_mul_f32 v11, v62, v11
    v_mul_f32 v65, v62, v65
    v_mul_f32 v10, 0x3fb8aa3b, v10
    v_mul_f32 v64, 0x3fb8aa3b, v64
    v_mul_f32 v11, 0x3e22f983, v11
    v_mul_f32 v65, 0x3e22f983, v65
    v_mul_f32 v12, v62, v12
    v_mul_f32 v66, v62, v66
    v_mul_f32 v13, v62, v13
    v_mul_f32 v67, v62, v67
    v_pk_mul_f32 v[18:19], v[14:15], v[12:13] op_sel:[1,1] op_sel_hi:[1,0] neg_lo:[1,0]
    v_pk_mul_f32 v[72:73], v[68:69], v[66:67] op_sel:[1,1] op_sel_hi:[1,0] neg_lo:[1,0]
    v_pk_fma_f32 v[20:21], v[14:15], v[12:13], v[18:19] op_sel:[0,0,0] op_sel_hi:[0,1,1]
    v_pk_fma_f32 v[74:75], v[68:69], v[66:67], v[72:73] op_sel:[0,0,0] op_sel_hi:[0,1,1]
    v_mul_f32 v36, 0x41000000, v10
    v_mul_f32 v174, 0x41000000, v64
    v_mul_f32 v37, 0x41000000, v11
    v_mul_f32 v175, 0x41000000, v65
    v_exp_f32 v36, v36
    v_exp_f32 v174, v174
    v_fract_f32 v37, v37
    v_fract_f32 v175, v175
    v_cos_f32 v18, v37
    v_cos_f32 v72, v175
    v_sin_f32 v37, v37
    v_sin_f32 v175, v175
    v_mul_f32 v37, v36, v37
    v_mul_f32 v175, v174, v175
    v_mul_f32 v36, v36, v18
    v_mul_f32 v174, v174, v72
    v_mul_f32 v22, 0x3f800000, v10
    v_mul_f32 v160, 0x3f800000, v64
    v_mul_f32 v23, 0x3f800000, v11
    v_mul_f32 v161, 0x3f800000, v65
    v_exp_f32 v22, v22
    v_exp_f32 v160, v160
    v_fract_f32 v23, v23
    v_fract_f32 v161, v161
    v_cos_f32 v18, v23
    v_cos_f32 v72, v161
    v_sin_f32 v23, v23
    v_sin_f32 v161, v161
    v_mul_f32 v23, v22, v23
    v_mul_f32 v161, v160, v161
    v_mul_f32 v22, v22, v18
    v_mul_f32 v160, v160, v72
    v_mul_f32 v38, 0x43800000, v10
    v_mul_f32 v176, 0x43800000, v64
    v_mul_f32 v39, 0x43800000, v11
    v_mul_f32 v177, 0x43800000, v65
    v_exp_f32 v38, v38
    v_exp_f32 v176, v176
    v_fract_f32 v39, v39
    v_fract_f32 v177, v177
    v_cos_f32 v18, v39
    v_cos_f32 v72, v177
    v_sin_f32 v39, v39
    v_sin_f32 v177, v177
    v_mul_f32 v39, v38, v39
    v_mul_f32 v177, v176, v177
    v_mul_f32 v38, v38, v18
    v_mul_f32 v176, v176, v72
    v_mul_f32 v40, 0x44000000, v10
    v_mul_f32 v178, 0x44000000, v64
    v_mul_f32 v41, 0x44000000, v11
    v_mul_f32 v179, 0x44000000, v65
    v_exp_f32 v40, v40
    v_exp_f32 v178, v178
    v_fract_f32 v41, v41
    v_fract_f32 v179, v179
    v_cos_f32 v18, v41
    v_cos_f32 v72, v179
    v_sin_f32 v41, v41
    v_sin_f32 v179, v179
    v_mul_f32 v41, v40, v41
    v_mul_f32 v179, v178, v179
    v_mul_f32 v40, v40, v18
    v_mul_f32 v178, v178, v72
    v_mul_f32 v42, 0x44800000, v10
    v_mul_f32 v180, 0x44800000, v64
    v_mul_f32 v43, 0x44800000, v11
    v_mul_f32 v181, 0x44800000, v65
    v_exp_f32 v42, v42
    v_exp_f32 v180, v180
    v_fract_f32 v43, v43
    v_fract_f32 v181, v181
    v_cos_f32 v18, v43
    v_cos_f32 v72, v181
    v_sin_f32 v43, v43
    v_sin_f32 v181, v181
    v_mul_f32 v43, v42, v43
    v_mul_f32 v181, v180, v181
    v_mul_f32 v42, v42, v18
    v_mul_f32 v180, v180, v72
    v_pk_mul_f32 v[18:19], v[22:23], v[22:23] op_sel:[1,1] op_sel_hi:[1,0] neg_lo:[1,0]
    v_pk_mul_f32 v[72:73], v[160:161], v[160:161] op_sel:[1,1] op_sel_hi:[1,0] neg_lo:[1,0]
    v_pk_fma_f32 v[24:25], v[22:23], v[22:23], v[18:19] op_sel:[0,0,0] op_sel_hi:[0,1,1]
    v_pk_fma_f32 v[162:163], v[160:161], v[160:161], v[72:73] op_sel:[0,0,0] op_sel_hi:[0,1,1]
    v_pk_mul_f32 v[18:19], v[24:25], v[22:23] op_sel:[1,1] op_sel_hi:[1,0] neg_lo:[1,0]
    v_pk_mul_f32 v[72:73], v[162:163], v[160:161] op_sel:[1,1] op_sel_hi:[1,0] neg_lo:[1,0]
    v_pk_fma_f32 v[26:27], v[24:25], v[22:23], v[18:19] op_sel:[0,0,0] op_sel_hi:[0,1,1]
    v_pk_fma_f32 v[164:165], v[162:163], v[160:161], v[72:73] op_sel:[0,0,0] op_sel_hi:[0,1,1]
    v_pk_mul_f32 v[18:19], v[24:25], v[24:25] op_sel:[1,1] op_sel_hi:[1,0] neg_lo:[1,0]
    v_pk_mul_f32 v[72:73], v[162:163], v[162:163] op_sel:[1,1] op_sel_hi:[1,0] neg_lo:[1,0]
    v_pk_fma_f32 v[28:29], v[24:25], v[24:25], v[18:19] op_sel:[0,0,0] op_sel_hi:[0,1,1]
    v_pk_fma_f32 v[166:167], v[162:163], v[162:163], v[72:73] op_sel:[0,0,0] op_sel_hi:[0,1,1]
    v_pk_mul_f32 v[18:19], v[28:29], v[22:23] op_sel:[1,1] op_sel_hi:[1,0] neg_lo:[1,0]
    v_pk_mul_f32 v[72:73], v[166:167], v[160:161] op_sel:[1,1] op_sel_hi:[1,0] neg_lo:[1,0]
    v_pk_fma_f32 v[30:31], v[28:29], v[22:23], v[18:19] op_sel:[0,0,0] op_sel_hi:[0,1,1]
    v_pk_fma_f32 v[168:169], v[166:167], v[160:161], v[72:73] op_sel:[0,0,0] op_sel_hi:[0,1,1]
    v_pk_mul_f32 v[18:19], v[26:27], v[26:27] op_sel:[1,1] op_sel_hi:[1,0] neg_lo:[1,0]
    v_pk_mul_f32 v[72:73], v[164:165], v[164:165] op_sel:[1,1] op_sel_hi:[1,0] neg_lo:[1,0]
    v_pk_fma_f32 v[32:33], v[26:27], v[26:27], v[18:19] op_sel:[0,0,0] op_sel_hi:[0,1,1]
    v_pk_fma_f32 v[170:171], v[164:165], v[164:165], v[72:73] op_sel:[0,0,0] op_sel_hi:[0,1,1]
    v_pk_mul_f32 v[18:19], v[28:29], v[26:27] op_sel:[1,1] op_sel_hi:[1,0] neg_lo:[1,0]
    v_pk_mul_f32 v[72:73], v[166:167], v[164:165] op_sel:[1,1] op_sel_hi:[1,0] neg_lo:[1,0]
    v_pk_fma_f32 v[34:35], v[28:29], v[26:27], v[18:19] op_sel:[0,0,0] op_sel_hi:[0,1,1]
    v_pk_fma_f32 v[172:173], v[166:167], v[164:165], v[72:73] op_sel:[0,0,0] op_sel_hi:[0,1,1]
    v_pk_mul_f32 v[18:19], v[40:41], v[38:39] op_sel:[1,1] op_sel_hi:[1,0] neg_lo:[1,0]
    v_pk_mul_f32 v[72:73], v[178:179], v[176:177] op_sel:[1,1] op_sel_hi:[1,0] neg_lo:[1,0]
    v_pk_fma_f32 v[44:45], v[40:41], v[38:39], v[18:19] op_sel:[0,0,0] op_sel_hi:[0,1,1]
    v_pk_fma_f32 v[182:183], v[178:179], v[176:177], v[72:73] op_sel:[0,0,0] op_sel_hi:[0,1,1]
    v_mov_b32 v48, 0x3f80
    v_mov_b32 v186, 0x3f80
    ds_write_b32 v6, v48 offset:0
    ds_write_b32 v6, v186 offset:256
    v_cvt_pk_bf16_f32 v49, v22, -v23
    v_cvt_pk_bf16_f32 v187, v160, -v161
    ds_write_b32 v6, v49 offset:544
    ds_write_b32 v6, v187 offset:800
    v_cvt_pk_bf16_f32 v50, v24, -v25
    v_cvt_pk_bf16_f32 v188, v162, -v163
    ds_write_b32 v6, v50 offset:1088
    ds_write_b32 v6, v188 offset:1344
    v_cvt_pk_bf16_f32 v51, v26, -v27
    v_cvt_pk_bf16_f32 v189, v164, -v165
    ds_write_b32 v6, v51 offset:1632
    ds_write_b32 v6, v189 offset:1888
    v_cvt_pk_bf16_f32 v48, v28, -v29
    v_cvt_pk_bf16_f32 v186, v166, -v167
    ds_write_b32 v6, v48 offset:2176
    ds_write_b32 v6, v186 offset:2432
    v_cvt_pk_bf16_f32 v49, v30, -v31
    v_cvt_pk_bf16_f32 v187, v168, -v169
    ds_write_b32 v6, v49 offset:2720
    ds_write_b32 v6, v187 offset:2976
    v_cvt_pk_bf16_f32 v50, v32, -v33
    v_cvt_pk_bf16_f32 v188, v170, -v171
    ds_write_b32 v6, v50 offset:3264
    ds_write_b32 v6, v188 offset:3520
    v_cvt_pk_bf16_f32 v51, v34, -v35
    v_cvt_pk_bf16_f32 v189, v172, -v173
    ds_write_b32 v6, v51 offset:3808
    ds_write_b32 v6, v189 offset:4064
    v_cvt_pk_bf16_f32 v48, v38, -v39
    v_cvt_pk_bf16_f32 v186, v176, -v177
    ds_write_b32 v6, v48 offset:4352
    ds_write_b32 v6, v186 offset:4608
    v_pk_mul_f32 v[18:19], v[38:39], v[24:25] op_sel:[1,1] op_sel_hi:[1,0] neg_lo:[1,0]
    v_pk_mul_f32 v[72:73], v[176:177], v[162:163] op_sel:[1,1] op_sel_hi:[1,0] neg_lo:[1,0]
    v_pk_fma_f32 v[46:47], v[38:39], v[24:25], v[18:19] op_sel:[0,0,0] op_sel_hi:[0,1,1]
    v_pk_fma_f32 v[184:185], v[176:177], v[162:163], v[72:73] op_sel:[0,0,0] op_sel_hi:[0,1,1]
    v_cvt_pk_bf16_f32 v49, v46, -v47
    v_cvt_pk_bf16_f32 v187, v184, -v185
    ds_write_b32 v6, v49 offset:4896
    ds_write_b32 v6, v187 offset:5152
    v_pk_mul_f32 v[18:19], v[38:39], v[28:29] op_sel:[1,1] op_sel_hi:[1,0] neg_lo:[1,0]
    v_pk_mul_f32 v[72:73], v[176:177], v[166:167] op_sel:[1,1] op_sel_hi:[1,0] neg_lo:[1,0]
    v_pk_fma_f32 v[46:47], v[38:39], v[28:29], v[18:19] op_sel:[0,0,0] op_sel_hi:[0,1,1]
    v_pk_fma_f32 v[184:185], v[176:177], v[166:167], v[72:73] op_sel:[0,0,0] op_sel_hi:[0,1,1]
    v_cvt_pk_bf16_f32 v50, v46, -v47
    v_cvt_pk_bf16_f32 v188, v184, -v185
    ds_write_b32 v6, v50 offset:5440
    ds_write_b32 v6, v188 offset:5696
    v_pk_mul_f32 v[18:19], v[38:39], v[32:33] op_sel:[1,1] op_sel_hi:[1,0] neg_lo:[1,0]
    v_pk_mul_f32 v[72:73], v[176:177], v[170:171] op_sel:[1,1] op_sel_hi:[1,0] neg_lo:[1,0]
    v_pk_fma_f32 v[46:47], v[38:39], v[32:33], v[18:19] op_sel:[0,0,0] op_sel_hi:[0,1,1]
    v_pk_fma_f32 v[184:185], v[176:177], v[170:171], v[72:73] op_sel:[0,0,0] op_sel_hi:[0,1,1]
    v_cvt_pk_bf16_f32 v51, v46, -v47
    v_cvt_pk_bf16_f32 v189, v184, -v185
    ds_write_b32 v6, v51 offset:5984
    ds_write_b32 v6, v189 offset:6240
    v_cvt_pk_bf16_f32 v48, v40, -v41
    v_cvt_pk_bf16_f32 v186, v178, -v179
    ds_write_b32 v6, v48 offset:6528
    ds_write_b32 v6, v186 offset:6784
    v_pk_mul_f32 v[18:19], v[40:41], v[28:29] op_sel:[1,1] op_sel_hi:[1,0] neg_lo:[1,0]
    v_pk_mul_f32 v[72:73], v[178:179], v[166:167] op_sel:[1,1] op_sel_hi:[1,0] neg_lo:[1,0]
    v_pk_fma_f32 v[46:47], v[40:41], v[28:29], v[18:19] op_sel:[0,0,0] op_sel_hi:[0,1,1]
    v_pk_fma_f32 v[184:185], v[178:179], v[166:167], v[72:73] op_sel:[0,0,0] op_sel_hi:[0,1,1]
    v_cvt_pk_bf16_f32 v49, v46, -v47
    v_cvt_pk_bf16_f32 v187, v184, -v185
    ds_write_b32 v6, v49 offset:7072
    ds_write_b32 v6, v187 offset:7328
    v_cvt_pk_bf16_f32 v50, v44, -v45
    v_cvt_pk_bf16_f32 v188, v182, -v183
    ds_write_b32 v6, v50 offset:7616
    ds_write_b32 v6, v188 offset:7872
    v_pk_mul_f32 v[18:19], v[44:45], v[28:29] op_sel:[1,1] op_sel_hi:[1,0] neg_lo:[1,0]
    v_pk_mul_f32 v[72:73], v[182:183], v[166:167] op_sel:[1,1] op_sel_hi:[1,0] neg_lo:[1,0]
    v_pk_fma_f32 v[46:47], v[44:45], v[28:29], v[18:19] op_sel:[0,0,0] op_sel_hi:[0,1,1]
    v_pk_fma_f32 v[184:185], v[182:183], v[166:167], v[72:73] op_sel:[0,0,0] op_sel_hi:[0,1,1]
    v_cvt_pk_bf16_f32 v51, v46, -v47
    v_cvt_pk_bf16_f32 v189, v184, -v185
    ds_write_b32 v6, v51 offset:8160
    ds_write_b32 v6, v189 offset:8416
    v_cvt_pk_bf16_f32 v48, v42, -v43
    v_cvt_pk_bf16_f32 v186, v180, -v181
    ds_write_b32 v6, v48 offset:8704
    ds_write_b32 v6, v186 offset:8960
    v_pk_mul_f32 v[18:19], v[42:43], v[38:39] op_sel:[1,1] op_sel_hi:[1,0] neg_lo:[1,0]
    v_pk_mul_f32 v[72:73], v[180:181], v[176:177] op_sel:[1,1] op_sel_hi:[1,0] neg_lo:[1,0]
    v_pk_fma_f32 v[46:47], v[42:43], v[38:39], v[18:19] op_sel:[0,0,0] op_sel_hi:[0,1,1]
    v_pk_fma_f32 v[184:185], v[180:181], v[176:177], v[72:73] op_sel:[0,0,0] op_sel_hi:[0,1,1]
    v_cvt_pk_bf16_f32 v49, v46, -v47
    v_cvt_pk_bf16_f32 v187, v184, -v185
    ds_write_b32 v6, v49 offset:9248
    ds_write_b32 v6, v187 offset:9504
    v_pk_mul_f32 v[18:19], v[42:43], v[40:41] op_sel:[1,1] op_sel_hi:[1,0] neg_lo:[1,0]
    v_pk_mul_f32 v[72:73], v[180:181], v[178:179] op_sel:[1,1] op_sel_hi:[1,0] neg_lo:[1,0]
    v_pk_fma_f32 v[46:47], v[42:43], v[40:41], v[18:19] op_sel:[0,0,0] op_sel_hi:[0,1,1]
    v_pk_fma_f32 v[184:185], v[180:181], v[178:179], v[72:73] op_sel:[0,0,0] op_sel_hi:[0,1,1]
    v_cvt_pk_bf16_f32 v50, v46, -v47
    v_cvt_pk_bf16_f32 v188, v184, -v185
    ds_write_b32 v6, v50 offset:9792
    ds_write_b32 v6, v188 offset:10048
    v_pk_mul_f32 v[18:19], v[42:43], v[44:45] op_sel:[1,1] op_sel_hi:[1,0] neg_lo:[1,0]
    v_pk_mul_f32 v[72:73], v[180:181], v[182:183] op_sel:[1,1] op_sel_hi:[1,0] neg_lo:[1,0]
    v_pk_fma_f32 v[46:47], v[42:43], v[44:45], v[18:19] op_sel:[0,0,0] op_sel_hi:[0,1,1]
    v_pk_fma_f32 v[184:185], v[180:181], v[182:183], v[72:73] op_sel:[0,0,0] op_sel_hi:[0,1,1]
    v_cvt_pk_bf16_f32 v51, v46, -v47
    v_cvt_pk_bf16_f32 v189, v184, -v185
    ds_write_b32 v6, v51 offset:10336
    ds_write_b32 v6, v189 offset:10592
    v_pk_mul_f32 v[18:19], v[42:43], v[42:43] op_sel:[1,1] op_sel_hi:[1,0] neg_lo:[1,0]
    v_pk_mul_f32 v[72:73], v[180:181], v[180:181] op_sel:[1,1] op_sel_hi:[1,0] neg_lo:[1,0]
    v_pk_fma_f32 v[46:47], v[42:43], v[42:43], v[18:19] op_sel:[0,0,0] op_sel_hi:[0,1,1]
    v_pk_fma_f32 v[184:185], v[180:181], v[180:181], v[72:73] op_sel:[0,0,0] op_sel_hi:[0,1,1]
    v_cvt_pk_bf16_f32 v48, v46, -v47
    v_cvt_pk_bf16_f32 v186, v184, -v185
    ds_write_b32 v6, v48 offset:10880
    ds_write_b32 v6, v186 offset:11136
    v_cvt_pk_bf16_f32 v49, v20, v21
    v_cvt_pk_bf16_f32 v187, v74, v75
    ds_write_b32 v5, v49 offset:0
    ds_write_b32 v5, v187 offset:256
    v_pk_mul_f32 v[18:19], v[20:21], v[36:37] op_sel:[1,1] op_sel_hi:[1,0] neg_lo:[1,0]
    v_pk_mul_f32 v[72:73], v[74:75], v[174:175] op_sel:[1,1] op_sel_hi:[1,0] neg_lo:[1,0]
    v_pk_fma_f32 v[20:21], v[20:21], v[36:37], v[18:19] op_sel:[0,0,0] op_sel_hi:[0,1,1]
    v_pk_fma_f32 v[74:75], v[74:75], v[174:175], v[72:73] op_sel:[0,0,0] op_sel_hi:[0,1,1]
    v_cvt_pk_bf16_f32 v50, v20, v21
    v_cvt_pk_bf16_f32 v188, v74, v75
    ds_write_b32 v5, v50 offset:544
    ds_write_b32 v5, v188 offset:800
    v_pk_mul_f32 v[18:19], v[20:21], v[36:37] op_sel:[1,1] op_sel_hi:[1,0] neg_lo:[1,0]
    v_pk_mul_f32 v[72:73], v[74:75], v[174:175] op_sel:[1,1] op_sel_hi:[1,0] neg_lo:[1,0]
    v_pk_fma_f32 v[20:21], v[20:21], v[36:37], v[18:19] op_sel:[0,0,0] op_sel_hi:[0,1,1]
    v_pk_fma_f32 v[74:75], v[74:75], v[174:175], v[72:73] op_sel:[0,0,0] op_sel_hi:[0,1,1]
    v_cvt_pk_bf16_f32 v51, v20, v21
    v_cvt_pk_bf16_f32 v189, v74, v75
    ds_write_b32 v5, v51 offset:1088
    ds_write_b32 v5, v189 offset:1344
    v_pk_mul_f32 v[18:19], v[20:21], v[36:37] op_sel:[1,1] op_sel_hi:[1,0] neg_lo:[1,0]
    v_pk_mul_f32 v[72:73], v[74:75], v[174:175] op_sel:[1,1] op_sel_hi:[1,0] neg_lo:[1,0]
    v_pk_fma_f32 v[20:21], v[20:21], v[36:37], v[18:19] op_sel:[0,0,0] op_sel_hi:[0,1,1]
    v_pk_fma_f32 v[74:75], v[74:75], v[174:175], v[72:73] op_sel:[0,0,0] op_sel_hi:[0,1,1]
    v_cvt_pk_bf16_f32 v48, v20, v21
    v_cvt_pk_bf16_f32 v186, v74, v75
    ds_write_b32 v5, v48 offset:1632
    ds_write_b32 v5, v186 offset:1888
    v_pk_mul_f32 v[18:19], v[20:21], v[36:37] op_sel:[1,1] op_sel_hi:[1,0] neg_lo:[1,0]
    v_pk_mul_f32 v[72:73], v[74:75], v[174:175] op_sel:[1,1] op_sel_hi:[1,0] neg_lo:[1,0]
    v_pk_fma_f32 v[20:21], v[20:21], v[36:37], v[18:19] op_sel:[0,0,0] op_sel_hi:[0,1,1]
    v_pk_fma_f32 v[74:75], v[74:75], v[174:175], v[72:73] op_sel:[0,0,0] op_sel_hi:[0,1,1]
    v_cvt_pk_bf16_f32 v49, v20, v21
    v_cvt_pk_bf16_f32 v187, v74, v75
    ds_write_b32 v5, v49 offset:2176
    ds_write_b32 v5, v187 offset:2432
    v_pk_mul_f32 v[18:19], v[20:21], v[36:37] op_sel:[1,1] op_sel_hi:[1,0] neg_lo:[1,0]
    v_pk_mul_f32 v[72:73], v[74:75], v[174:175] op_sel:[1,1] op_sel_hi:[1,0] neg_lo:[1,0]
    v_pk_fma_f32 v[20:21], v[20:21], v[36:37], v[18:19] op_sel:[0,0,0] op_sel_hi:[0,1,1]
    v_pk_fma_f32 v[74:75], v[74:75], v[174:175], v[72:73] op_sel:[0,0,0] op_sel_hi:[0,1,1]
    v_cvt_pk_bf16_f32 v50, v20, v21
    v_cvt_pk_bf16_f32 v188, v74, v75
    ds_write_b32 v5, v50 offset:2720
    ds_write_b32 v5, v188 offset:2976
    v_pk_mul_f32 v[18:19], v[20:21], v[36:37] op_sel:[1,1] op_sel_hi:[1,0] neg_lo:[1,0]
    v_pk_mul_f32 v[72:73], v[74:75], v[174:175] op_sel:[1,1] op_sel_hi:[1,0] neg_lo:[1,0]
    v_pk_fma_f32 v[20:21], v[20:21], v[36:37], v[18:19] op_sel:[0,0,0] op_sel_hi:[0,1,1]
    v_pk_fma_f32 v[74:75], v[74:75], v[174:175], v[72:73] op_sel:[0,0,0] op_sel_hi:[0,1,1]
    v_cvt_pk_bf16_f32 v51, v20, v21
    v_cvt_pk_bf16_f32 v189, v74, v75
    ds_write_b32 v5, v51 offset:3264
    ds_write_b32 v5, v189 offset:3520
    v_pk_mul_f32 v[18:19], v[20:21], v[36:37] op_sel:[1,1] op_sel_hi:[1,0] neg_lo:[1,0]
    v_pk_mul_f32 v[72:73], v[74:75], v[174:175] op_sel:[1,1] op_sel_hi:[1,0] neg_lo:[1,0]
    v_pk_fma_f32 v[20:21], v[20:21], v[36:37], v[18:19] op_sel:[0,0,0] op_sel_hi:[0,1,1]
    v_pk_fma_f32 v[74:75], v[74:75], v[174:175], v[72:73] op_sel:[0,0,0] op_sel_hi:[0,1,1]
    v_cvt_pk_bf16_f32 v48, v20, v21
    v_cvt_pk_bf16_f32 v186, v74, v75
    ds_write_b32 v5, v48 offset:3808
    ds_write_b32 v5, v186 offset:4064
    v_pk_mul_f32 v[18:19], v[20:21], v[36:37] op_sel:[1,1] op_sel_hi:[1,0] neg_lo:[1,0]
    v_pk_mul_f32 v[72:73], v[74:75], v[174:175] op_sel:[1,1] op_sel_hi:[1,0] neg_lo:[1,0]
    v_pk_fma_f32 v[20:21], v[20:21], v[36:37], v[18:19] op_sel:[0,0,0] op_sel_hi:[0,1,1]
    v_pk_fma_f32 v[74:75], v[74:75], v[174:175], v[72:73] op_sel:[0,0,0] op_sel_hi:[0,1,1]
    v_cvt_pk_bf16_f32 v49, v20, v21
    v_cvt_pk_bf16_f32 v187, v74, v75
    ds_write_b32 v5, v49 offset:4352
    ds_write_b32 v5, v187 offset:4608
    v_pk_mul_f32 v[18:19], v[20:21], v[36:37] op_sel:[1,1] op_sel_hi:[1,0] neg_lo:[1,0]
    v_pk_mul_f32 v[72:73], v[74:75], v[174:175] op_sel:[1,1] op_sel_hi:[1,0] neg_lo:[1,0]
    v_pk_fma_f32 v[20:21], v[20:21], v[36:37], v[18:19] op_sel:[0,0,0] op_sel_hi:[0,1,1]
    v_pk_fma_f32 v[74:75], v[74:75], v[174:175], v[72:73] op_sel:[0,0,0] op_sel_hi:[0,1,1]
    v_cvt_pk_bf16_f32 v50, v20, v21
    v_cvt_pk_bf16_f32 v188, v74, v75
    ds_write_b32 v5, v50 offset:4896
    ds_write_b32 v5, v188 offset:5152
    v_pk_mul_f32 v[18:19], v[20:21], v[36:37] op_sel:[1,1] op_sel_hi:[1,0] neg_lo:[1,0]
    v_pk_mul_f32 v[72:73], v[74:75], v[174:175] op_sel:[1,1] op_sel_hi:[1,0] neg_lo:[1,0]
    v_pk_fma_f32 v[20:21], v[20:21], v[36:37], v[18:19] op_sel:[0,0,0] op_sel_hi:[0,1,1]
    v_pk_fma_f32 v[74:75], v[74:75], v[174:175], v[72:73] op_sel:[0,0,0] op_sel_hi:[0,1,1]
    v_cvt_pk_bf16_f32 v51, v20, v21
    v_cvt_pk_bf16_f32 v189, v74, v75
    ds_write_b32 v5, v51 offset:5440
    ds_write_b32 v5, v189 offset:5696
    v_pk_mul_f32 v[18:19], v[20:21], v[36:37] op_sel:[1,1] op_sel_hi:[1,0] neg_lo:[1,0]
    v_pk_mul_f32 v[72:73], v[74:75], v[174:175] op_sel:[1,1] op_sel_hi:[1,0] neg_lo:[1,0]
    v_pk_fma_f32 v[20:21], v[20:21], v[36:37], v[18:19] op_sel:[0,0,0] op_sel_hi:[0,1,1]
    v_pk_fma_f32 v[74:75], v[74:75], v[174:175], v[72:73] op_sel:[0,0,0] op_sel_hi:[0,1,1]
    v_cvt_pk_bf16_f32 v48, v20, v21
    v_cvt_pk_bf16_f32 v186, v74, v75
    ds_write_b32 v5, v48 offset:5984
    ds_write_b32 v5, v186 offset:6240
    v_pk_mul_f32 v[18:19], v[20:21], v[36:37] op_sel:[1,1] op_sel_hi:[1,0] neg_lo:[1,0]
    v_pk_mul_f32 v[72:73], v[74:75], v[174:175] op_sel:[1,1] op_sel_hi:[1,0] neg_lo:[1,0]
    v_pk_fma_f32 v[20:21], v[20:21], v[36:37], v[18:19] op_sel:[0,0,0] op_sel_hi:[0,1,1]
    v_pk_fma_f32 v[74:75], v[74:75], v[174:175], v[72:73] op_sel:[0,0,0] op_sel_hi:[0,1,1]
    v_cvt_pk_bf16_f32 v49, v20, v21
    v_cvt_pk_bf16_f32 v187, v74, v75
    ds_write_b32 v5, v49 offset:6528
    ds_write_b32 v5, v187 offset:6784
    v_pk_mul_f32 v[18:19], v[20:21], v[36:37] op_sel:[1,1] op_sel_hi:[1,0] neg_lo:[1,0]
    v_pk_mul_f32 v[72:73], v[74:75], v[174:175] op_sel:[1,1] op_sel_hi:[1,0] neg_lo:[1,0]
    v_pk_fma_f32 v[20:21], v[20:21], v[36:37], v[18:19] op_sel:[0,0,0] op_sel_hi:[0,1,1]
    v_pk_fma_f32 v[74:75], v[74:75], v[174:175], v[72:73] op_sel:[0,0,0] op_sel_hi:[0,1,1]
    v_cvt_pk_bf16_f32 v50, v20, v21
    v_cvt_pk_bf16_f32 v188, v74, v75
    ds_write_b32 v5, v50 offset:7072
    ds_write_b32 v5, v188 offset:7328
    v_pk_mul_f32 v[18:19], v[20:21], v[36:37] op_sel:[1,1] op_sel_hi:[1,0] neg_lo:[1,0]
    v_pk_mul_f32 v[72:73], v[74:75], v[174:175] op_sel:[1,1] op_sel_hi:[1,0] neg_lo:[1,0]
    v_pk_fma_f32 v[20:21], v[20:21], v[36:37], v[18:19] op_sel:[0,0,0] op_sel_hi:[0,1,1]
    v_pk_fma_f32 v[74:75], v[74:75], v[174:175], v[72:73] op_sel:[0,0,0] op_sel_hi:[0,1,1]
    v_cvt_pk_bf16_f32 v51, v20, v21
    v_cvt_pk_bf16_f32 v189, v74, v75
    ds_write_b32 v5, v51 offset:7616
    ds_write_b32 v5, v189 offset:7872
    v_pk_mul_f32 v[18:19], v[20:21], v[36:37] op_sel:[1,1] op_sel_hi:[1,0] neg_lo:[1,0]
    v_pk_mul_f32 v[72:73], v[74:75], v[174:175] op_sel:[1,1] op_sel_hi:[1,0] neg_lo:[1,0]
    v_pk_fma_f32 v[20:21], v[20:21], v[36:37], v[18:19] op_sel:[0,0,0] op_sel_hi:[0,1,1]
    v_pk_fma_f32 v[74:75], v[74:75], v[174:175], v[72:73] op_sel:[0,0,0] op_sel_hi:[0,1,1]
    v_cvt_pk_bf16_f32 v48, v20, v21
    v_cvt_pk_bf16_f32 v186, v74, v75
    ds_write_b32 v5, v48 offset:8160
    ds_write_b32 v5, v186 offset:8416
    v_pk_mul_f32 v[18:19], v[20:21], v[36:37] op_sel:[1,1] op_sel_hi:[1,0] neg_lo:[1,0]
    v_pk_mul_f32 v[72:73], v[74:75], v[174:175] op_sel:[1,1] op_sel_hi:[1,0] neg_lo:[1,0]
    v_pk_fma_f32 v[20:21], v[20:21], v[36:37], v[18:19] op_sel:[0,0,0] op_sel_hi:[0,1,1]
    v_pk_fma_f32 v[74:75], v[74:75], v[174:175], v[72:73] op_sel:[0,0,0] op_sel_hi:[0,1,1]
    v_cvt_pk_bf16_f32 v49, v20, v21
    v_cvt_pk_bf16_f32 v187, v74, v75
    ds_write_b32 v5, v49 offset:8704
    ds_write_b32 v5, v187 offset:8960
    v_pk_mul_f32 v[18:19], v[20:21], v[36:37] op_sel:[1,1] op_sel_hi:[1,0] neg_lo:[1,0]
    v_pk_mul_f32 v[72:73], v[74:75], v[174:175] op_sel:[1,1] op_sel_hi:[1,0] neg_lo:[1,0]
    v_pk_fma_f32 v[20:21], v[20:21], v[36:37], v[18:19] op_sel:[0,0,0] op_sel_hi:[0,1,1]
    v_pk_fma_f32 v[74:75], v[74:75], v[174:175], v[72:73] op_sel:[0,0,0] op_sel_hi:[0,1,1]
    v_cvt_pk_bf16_f32 v50, v20, v21
    v_cvt_pk_bf16_f32 v188, v74, v75
    ds_write_b32 v5, v50 offset:9248
    ds_write_b32 v5, v188 offset:9504
    v_pk_mul_f32 v[18:19], v[20:21], v[36:37] op_sel:[1,1] op_sel_hi:[1,0] neg_lo:[1,0]
    v_pk_mul_f32 v[72:73], v[74:75], v[174:175] op_sel:[1,1] op_sel_hi:[1,0] neg_lo:[1,0]
    v_pk_fma_f32 v[20:21], v[20:21], v[36:37], v[18:19] op_sel:[0,0,0] op_sel_hi:[0,1,1]
    v_pk_fma_f32 v[74:75], v[74:75], v[174:175], v[72:73] op_sel:[0,0,0] op_sel_hi:[0,1,1]
    v_cvt_pk_bf16_f32 v51, v20, v21
    v_cvt_pk_bf16_f32 v189, v74, v75
    ds_write_b32 v5, v51 offset:9792
    ds_write_b32 v5, v189 offset:10048
    v_pk_mul_f32 v[18:19], v[20:21], v[36:37] op_sel:[1,1] op_sel_hi:[1,0] neg_lo:[1,0]
    v_pk_mul_f32 v[72:73], v[74:75], v[174:175] op_sel:[1,1] op_sel_hi:[1,0] neg_lo:[1,0]
    v_pk_fma_f32 v[20:21], v[20:21], v[36:37], v[18:19] op_sel:[0,0,0] op_sel_hi:[0,1,1]
    v_pk_fma_f32 v[74:75], v[74:75], v[174:175], v[72:73] op_sel:[0,0,0] op_sel_hi:[0,1,1]
    v_cvt_pk_bf16_f32 v48, v20, v21
    v_cvt_pk_bf16_f32 v186, v74, v75
    ds_write_b32 v5, v48 offset:10336
    ds_write_b32 v5, v186 offset:10592
    v_pk_mul_f32 v[18:19], v[20:21], v[36:37] op_sel:[1,1] op_sel_hi:[1,0] neg_lo:[1,0]
    v_pk_mul_f32 v[72:73], v[74:75], v[174:175] op_sel:[1,1] op_sel_hi:[1,0] neg_lo:[1,0]
    v_pk_fma_f32 v[20:21], v[20:21], v[36:37], v[18:19] op_sel:[0,0,0] op_sel_hi:[0,1,1]
    v_pk_fma_f32 v[74:75], v[74:75], v[174:175], v[72:73] op_sel:[0,0,0] op_sel_hi:[0,1,1]
    v_cvt_pk_bf16_f32 v49, v20, v21
    v_cvt_pk_bf16_f32 v187, v74, v75
    ds_write_b32 v5, v49 offset:10880
    ds_write_b32 v5, v187 offset:11136
    v_pk_mul_f32 v[18:19], v[20:21], v[36:37] op_sel:[1,1] op_sel_hi:[1,0] neg_lo:[1,0]
    v_pk_mul_f32 v[72:73], v[74:75], v[174:175] op_sel:[1,1] op_sel_hi:[1,0] neg_lo:[1,0]
    v_pk_fma_f32 v[20:21], v[20:21], v[36:37], v[18:19] op_sel:[0,0,0] op_sel_hi:[0,1,1]
    v_pk_fma_f32 v[74:75], v[74:75], v[174:175], v[72:73] op_sel:[0,0,0] op_sel_hi:[0,1,1]
    v_cvt_pk_bf16_f32 v50, v20, v21
    v_cvt_pk_bf16_f32 v188, v74, v75
    ds_write_b32 v5, v50 offset:11424
    ds_write_b32 v5, v188 offset:11680
    v_pk_mul_f32 v[18:19], v[20:21], v[36:37] op_sel:[1,1] op_sel_hi:[1,0] neg_lo:[1,0]
    v_pk_mul_f32 v[72:73], v[74:75], v[174:175] op_sel:[1,1] op_sel_hi:[1,0] neg_lo:[1,0]
    v_pk_fma_f32 v[20:21], v[20:21], v[36:37], v[18:19] op_sel:[0,0,0] op_sel_hi:[0,1,1]
    v_pk_fma_f32 v[74:75], v[74:75], v[174:175], v[72:73] op_sel:[0,0,0] op_sel_hi:[0,1,1]
    v_cvt_pk_bf16_f32 v51, v20, v21
    v_cvt_pk_bf16_f32 v189, v74, v75
    ds_write_b32 v5, v51 offset:11968
    ds_write_b32 v5, v189 offset:12224
    v_pk_mul_f32 v[18:19], v[20:21], v[36:37] op_sel:[1,1] op_sel_hi:[1,0] neg_lo:[1,0]
    v_pk_mul_f32 v[72:73], v[74:75], v[174:175] op_sel:[1,1] op_sel_hi:[1,0] neg_lo:[1,0]
    v_pk_fma_f32 v[20:21], v[20:21], v[36:37], v[18:19] op_sel:[0,0,0] op_sel_hi:[0,1,1]
    v_pk_fma_f32 v[74:75], v[74:75], v[174:175], v[72:73] op_sel:[0,0,0] op_sel_hi:[0,1,1]
    v_cvt_pk_bf16_f32 v48, v20, v21
    v_cvt_pk_bf16_f32 v186, v74, v75
    ds_write_b32 v5, v48 offset:12512
    ds_write_b32 v5, v186 offset:12768
    v_pk_mul_f32 v[18:19], v[20:21], v[36:37] op_sel:[1,1] op_sel_hi:[1,0] neg_lo:[1,0]
    v_pk_mul_f32 v[72:73], v[74:75], v[174:175] op_sel:[1,1] op_sel_hi:[1,0] neg_lo:[1,0]
    v_pk_fma_f32 v[20:21], v[20:21], v[36:37], v[18:19] op_sel:[0,0,0] op_sel_hi:[0,1,1]
    v_pk_fma_f32 v[74:75], v[74:75], v[174:175], v[72:73] op_sel:[0,0,0] op_sel_hi:[0,1,1]
    v_cvt_pk_bf16_f32 v49, v20, v21
    v_cvt_pk_bf16_f32 v187, v74, v75
    ds_write_b32 v5, v49 offset:13056
    ds_write_b32 v5, v187 offset:13312
    v_pk_mul_f32 v[18:19], v[20:21], v[36:37] op_sel:[1,1] op_sel_hi:[1,0] neg_lo:[1,0]
    v_pk_mul_f32 v[72:73], v[74:75], v[174:175] op_sel:[1,1] op_sel_hi:[1,0] neg_lo:[1,0]
    v_pk_fma_f32 v[20:21], v[20:21], v[36:37], v[18:19] op_sel:[0,0,0] op_sel_hi:[0,1,1]
    v_pk_fma_f32 v[74:75], v[74:75], v[174:175], v[72:73] op_sel:[0,0,0] op_sel_hi:[0,1,1]
    v_cvt_pk_bf16_f32 v50, v20, v21
    v_cvt_pk_bf16_f32 v188, v74, v75
    ds_write_b32 v5, v50 offset:13600
    ds_write_b32 v5, v188 offset:13856
    v_pk_mul_f32 v[18:19], v[20:21], v[36:37] op_sel:[1,1] op_sel_hi:[1,0] neg_lo:[1,0]
    v_pk_mul_f32 v[72:73], v[74:75], v[174:175] op_sel:[1,1] op_sel_hi:[1,0] neg_lo:[1,0]
    v_pk_fma_f32 v[20:21], v[20:21], v[36:37], v[18:19] op_sel:[0,0,0] op_sel_hi:[0,1,1]
    v_pk_fma_f32 v[74:75], v[74:75], v[174:175], v[72:73] op_sel:[0,0,0] op_sel_hi:[0,1,1]
    v_cvt_pk_bf16_f32 v51, v20, v21
    v_cvt_pk_bf16_f32 v189, v74, v75
    ds_write_b32 v5, v51 offset:14144
    ds_write_b32 v5, v189 offset:14400
    v_pk_mul_f32 v[18:19], v[20:21], v[36:37] op_sel:[1,1] op_sel_hi:[1,0] neg_lo:[1,0]
    v_pk_mul_f32 v[72:73], v[74:75], v[174:175] op_sel:[1,1] op_sel_hi:[1,0] neg_lo:[1,0]
    v_pk_fma_f32 v[20:21], v[20:21], v[36:37], v[18:19] op_sel:[0,0,0] op_sel_hi:[0,1,1]
    v_pk_fma_f32 v[74:75], v[74:75], v[174:175], v[72:73] op_sel:[0,0,0] op_sel_hi:[0,1,1]
    v_cvt_pk_bf16_f32 v48, v20, v21
    v_cvt_pk_bf16_f32 v186, v74, v75
    ds_write_b32 v5, v48 offset:14688
    ds_write_b32 v5, v186 offset:14944
    v_pk_mul_f32 v[18:19], v[20:21], v[36:37] op_sel:[1,1] op_sel_hi:[1,0] neg_lo:[1,0]
    v_pk_mul_f32 v[72:73], v[74:75], v[174:175] op_sel:[1,1] op_sel_hi:[1,0] neg_lo:[1,0]
    v_pk_fma_f32 v[20:21], v[20:21], v[36:37], v[18:19] op_sel:[0,0,0] op_sel_hi:[0,1,1]
    v_pk_fma_f32 v[74:75], v[74:75], v[174:175], v[72:73] op_sel:[0,0,0] op_sel_hi:[0,1,1]
    v_cvt_pk_bf16_f32 v49, v20, v21
    v_cvt_pk_bf16_f32 v187, v74, v75
    ds_write_b32 v5, v49 offset:15232
    ds_write_b32 v5, v187 offset:15488
    v_pk_mul_f32 v[18:19], v[20:21], v[36:37] op_sel:[1,1] op_sel_hi:[1,0] neg_lo:[1,0]
    v_pk_mul_f32 v[72:73], v[74:75], v[174:175] op_sel:[1,1] op_sel_hi:[1,0] neg_lo:[1,0]
    v_pk_fma_f32 v[20:21], v[20:21], v[36:37], v[18:19] op_sel:[0,0,0] op_sel_hi:[0,1,1]
    v_pk_fma_f32 v[74:75], v[74:75], v[174:175], v[72:73] op_sel:[0,0,0] op_sel_hi:[0,1,1]
    v_cvt_pk_bf16_f32 v50, v20, v21
    v_cvt_pk_bf16_f32 v188, v74, v75
    ds_write_b32 v5, v50 offset:15776
    ds_write_b32 v5, v188 offset:16032
    v_pk_mul_f32 v[18:19], v[20:21], v[36:37] op_sel:[1,1] op_sel_hi:[1,0] neg_lo:[1,0]
    v_pk_mul_f32 v[72:73], v[74:75], v[174:175] op_sel:[1,1] op_sel_hi:[1,0] neg_lo:[1,0]
    v_pk_fma_f32 v[20:21], v[20:21], v[36:37], v[18:19] op_sel:[0,0,0] op_sel_hi:[0,1,1]
    v_pk_fma_f32 v[74:75], v[74:75], v[174:175], v[72:73] op_sel:[0,0,0] op_sel_hi:[0,1,1]
    v_cvt_pk_bf16_f32 v51, v20, v21
    v_cvt_pk_bf16_f32 v189, v74, v75
    ds_write_b32 v5, v51 offset:16320
    ds_write_b32 v5, v189 offset:16576
    v_pk_mul_f32 v[18:19], v[20:21], v[36:37] op_sel:[1,1] op_sel_hi:[1,0] neg_lo:[1,0]
    v_pk_mul_f32 v[72:73], v[74:75], v[174:175] op_sel:[1,1] op_sel_hi:[1,0] neg_lo:[1,0]
    v_pk_fma_f32 v[20:21], v[20:21], v[36:37], v[18:19] op_sel:[0,0,0] op_sel_hi:[0,1,1]
    v_pk_fma_f32 v[74:75], v[74:75], v[174:175], v[72:73] op_sel:[0,0,0] op_sel_hi:[0,1,1]
    v_cvt_pk_bf16_f32 v48, v20, v21
    v_cvt_pk_bf16_f32 v186, v74, v75
    ds_write_b32 v5, v48 offset:16864
    ds_write_b32 v5, v186 offset:17120
    v_mov_b32 v24, 0
    v_mov_b32 v25, 0
    v_mov_b32 v26, 0
    v_mov_b32 v27, 0
    v_mov_b32 v28, 0
    v_mov_b32 v29, 0
    v_mov_b32 v30, 0
    v_mov_b32 v31, 0
    v_mov_b32 v32, 0
    v_mov_b32 v33, 0
    v_mov_b32 v34, 0
    v_mov_b32 v35, 0
    v_mov_b32 v36, 0
    v_mov_b32 v37, 0
    v_mov_b32 v38, 0
    v_mov_b32 v39, 0
    s_waitcnt lgkmcnt(0)
    ds_read_b128 v[192:195], v96 offset:0
    ds_read_b128 v[196:199], v96 offset:8704
    ds_read_b128 v[200:203], v97 offset:0
    ds_read_b128 v[204:207], v97 offset:8704
    ds_read_b128 v[208:211], v96 offset:64
    ds_read_b128 v[212:215], v96 offset:8768
    ds_read_b128 v[216:219], v97 offset:64
    ds_read_b128 v[220:223], v97 offset:8768
    ds_read_b128 v[224:227], v96 offset:128
    ds_read_b128 v[228:231], v96 offset:8832
    ds_read_b128 v[232:235], v97 offset:128
    ds_read_b128 v[236:239], v97 offset:8832
    s_waitcnt lgkmcnt(8)
    ds_read_b128 v[240:243], v96 offset:192
    ds_read_b128 v[244:247], v96 offset:8896
    ds_read_b128 v[248:251], v97 offset:192
    ds_read_b128 v[252:255], v97 offset:8896
    v_mfma_f32_16x16x32_bf16 v[24:27], v[192:195], v[200:203], v[24:27]
    v_mfma_f32_16x16x32_bf16 v[28:31], v[192:195], v[204:207], v[28:31]
    v_mfma_f32_16x16x32_bf16 v[32:35], v[196:199], v[200:203], v[32:35]
    v_mfma_f32_16x16x32_bf16 v[36:39], v[196:199], v[204:207], v[36:39]
    s_waitcnt lgkmcnt(8)
    ds_read_b128 v[192:195], v96 offset:256
    ds_read_b128 v[196:199], v96 offset:8960
    ds_read_b128 v[200:203], v97 offset:256
    ds_read_b128 v[204:207], v97 offset:8960
    v_mfma_f32_16x16x32_bf16 v[24:27], v[208:211], v[216:219], v[24:27]
    v_mfma_f32_16x16x32_bf16 v[28:31], v[208:211], v[220:223], v[28:31]
    v_mfma_f32_16x16x32_bf16 v[32:35], v[212:215], v[216:219], v[32:35]
    v_mfma_f32_16x16x32_bf16 v[36:39], v[212:215], v[220:223], v[36:39]
    s_waitcnt lgkmcnt(8)
    ds_read_b128 v[208:211], v96 offset:320
    ds_read_b128 v[212:215], v96 offset:9024
    ds_read_b128 v[216:219], v97 offset:320
    ds_read_b128 v[220:223], v97 offset:9024
    v_mfma_f32_16x16x32_bf16 v[24:27], v[224:227], v[232:235], v[24:27]
    v_mfma_f32_16x16x32_bf16 v[28:31], v[224:227], v[236:239], v[28:31]
    v_mfma_f32_16x16x32_bf16 v[32:35], v[228:231], v[232:235], v[32:35]
    v_mfma_f32_16x16x32_bf16 v[36:39], v[228:231], v[236:239], v[36:39]
    s_waitcnt lgkmcnt(8)
    ds_read_b128 v[224:227], v96 offset:384
    ds_read_b128 v[228:231], v96 offset:9088
    ds_read_b128 v[232:235], v97 offset:384
    ds_read_b128 v[236:239], v97 offset:9088
    v_mfma_f32_16x16x32_bf16 v[24:27], v[240:243], v[248:251], v[24:27]
    v_mfma_f32_16x16x32_bf16 v[28:31], v[240:243], v[252:255], v[28:31]
    v_mfma_f32_16x16x32_bf16 v[32:35], v[244:247], v[248:251], v[32:35]
    v_mfma_f32_16x16x32_bf16 v[36:39], v[244:247], v[252:255], v[36:39]
    s_waitcnt lgkmcnt(8)
    ds_read_b128 v[240:243], v96 offset:448
    ds_read_b128 v[244:247], v96 offset:9152
    ds_read_b128 v[248:251], v97 offset:448
    ds_read_b128 v[252:255], v97 offset:9152
    v_mfma_f32_16x16x32_bf16 v[24:27], v[192:195], v[200:203], v[24:27]
    v_mfma_f32_16x16x32_bf16 v[28:31], v[192:195], v[204:207], v[28:31]
    v_mfma_f32_16x16x32_bf16 v[32:35], v[196:199], v[200:203], v[32:35]
    v_mfma_f32_16x16x32_bf16 v[36:39], v[196:199], v[204:207], v[36:39]
    s_waitcnt lgkmcnt(8)
    v_mfma_f32_16x16x32_bf16 v[24:27], v[208:211], v[216:219], v[24:27]
    v_mfma_f32_16x16x32_bf16 v[28:31], v[208:211], v[220:223], v[28:31]
    v_mfma_f32_16x16x32_bf16 v[32:35], v[212:215], v[216:219], v[32:35]
    v_mfma_f32_16x16x32_bf16 v[36:39], v[212:215], v[220:223], v[36:39]
    s_waitcnt lgkmcnt(4)
    v_mfma_f32_16x16x32_bf16 v[24:27], v[224:227], v[232:235], v[24:27]
    v_mfma_f32_16x16x32_bf16 v[28:31], v[224:227], v[236:239], v[28:31]
    v_mfma_f32_16x16x32_bf16 v[32:35], v[228:231], v[232:235], v[32:35]
    v_mfma_f32_16x16x32_bf16 v[36:39], v[228:231], v[236:239], v[36:39]
    s_waitcnt lgkmcnt(0)
    v_mfma_f32_16x16x32_bf16 v[24:27], v[240:243], v[248:251], v[24:27]
    v_mfma_f32_16x16x32_bf16 v[28:31], v[240:243], v[252:255], v[28:31]
    v_mfma_f32_16x16x32_bf16 v[32:35], v[244:247], v[248:251], v[32:35]
    v_mfma_f32_16x16x32_bf16 v[36:39], v[244:247], v[252:255], v[36:39]
    s_nop 4
    ds_write_b32 v100, v24
    ds_write_b32 v98, v28 offset:0
    ds_write_b32 v101, v25
    ds_write_b32 v98, v29 offset:4
    ds_write_b32 v102, v26
    ds_write_b32 v98, v30 offset:8
    ds_write_b32 v103, v27
    ds_write_b32 v98, v31 offset:12
    ds_write_b32 v104, v32
    ds_write_b32 v98, v36 offset:64
    ds_write_b32 v105, v33
    ds_write_b32 v98, v37 offset:68
    ds_write_b32 v106, v34
    ds_write_b32 v98, v38 offset:72
    ds_write_b32 v107, v35
    ds_write_b32 v98, v39 offset:76
    v_mov_b32 v20, 0
    v_mov_b32 v21, 0
    s_waitcnt lgkmcnt(0)
    ds_write_b64 v108, v[20:21] offset:4096
    ds_read_b32 v160, v112
    ds_read_b32 v161, v113
    ds_read_b32 v162, v114
    ds_read_b32 v163, v115
    ds_read_b32 v164, v116
    ds_read_b32 v165, v117
    ds_read_b32 v166, v118
    ds_read_b32 v167, v119
    ds_read_b32 v168, v120
    ds_read_b32 v169, v121
    ds_read_b32 v170, v122
    ds_read_b32 v171, v123
    ds_read_b32 v172, v124
    ds_read_b32 v173, v125
    ds_read_b32 v174, v126
    ds_read_b32 v175, v127
    ds_read_b32 v176, v128
    ds_read_b32 v177, v129
    ds_read_b32 v178, v130
    ds_read_b32 v179, v131
    ds_read_b32 v180, v132
    ds_read_b32 v181, v133
    ds_read_b32 v182, v134
    ds_read_b32 v183, v135
    ds_read_b32 v184, v136
    ds_read_b32 v185, v137
    ds_read_b32 v186, v138
    ds_read_b32 v187, v139
    ds_read_b32 v188, v140
    ds_read_b32 v189, v141
    ds_read_b32 v190, v142
    ds_read_b32 v191, v143
    ds_read_b32 v192, v144
    ds_read_b32 v193, v145
    ds_read_b32 v194, v146
    ds_read_b32 v195, v147
    ds_read_b32 v196, v148
    ds_read_b32 v197, v149
    ds_read_b32 v198, v150
    ds_read_b32 v199, v151
    ds_read_b32 v200, v152
    ds_read_b32 v201, v153
    ds_read_b32 v202, v154
    ds_read_b32 v203, v155
    v_cmp_eq_u32 vcc, 63, v1
    s_waitcnt lgkmcnt(15)
    v_cvt_pk_bf16_f32 v64, v160, v161
    v_cvt_pk_bf16_f32 v65, v162, v163
    v_cvt_pk_bf16_f32 v66, v164, v165
    v_cvt_pk_bf16_f32 v67, v166, v167
    ds_write_b128 v99, v[64:67] offset:0
    v_cvt_pk_bf16_f32 v68, v161, v162
    v_cvt_pk_bf16_f32 v69, v163, v164
    v_cvt_pk_bf16_f32 v70, v165, v166
    v_cvt_pk_bf16_f32 v71, v167, v168
    ds_write_b128 v99, v[68:71] offset:4160
    v_cvt_pk_bf16_f32 v72, v162, v163
    v_cvt_pk_bf16_f32 v73, v164, v165
    v_cvt_pk_bf16_f32 v74, v166, v167
    v_cvt_pk_bf16_f32 v75, v168, v169
    ds_write_b128 v99, v[72:75] offset:8320
    v_cvt_pk_bf16_f32 v76, v163, v164
    v_cvt_pk_bf16_f32 v77, v165, v166
    v_cvt_pk_bf16_f32 v78, v167, v168
    v_cvt_pk_bf16_f32 v79, v169, v170
    ds_write_b128 v99, v[76:79] offset:12480
    s_waitcnt lgkmcnt(15)
    v_cvt_pk_bf16_f32 v80, v171, v172
    v_cvt_pk_bf16_f32 v81, v173, v174
    v_cvt_pk_bf16_f32 v82, v175, v176
    v_cvt_pk_bf16_f32 v83, v177, v178
    ds_write_b128 v99, v[80:83] offset:1024
    v_cvt_pk_bf16_f32 v84, v172, v173
    v_cvt_pk_bf16_f32 v85, v174, v175
    v_cvt_pk_bf16_f32 v86, v176, v177
    v_cvt_pk_bf16_f32 v87, v178, v179
    ds_write_b128 v99, v[84:87] offset:5184
    v_cvt_pk_bf16_f32 v88, v173, v174
    v_cvt_pk_bf16_f32 v89, v175, v176
    v_cvt_pk_bf16_f32 v90, v177, v178
    v_cvt_pk_bf16_f32 v91, v179, v180
    ds_write_b128 v99, v[88:91] offset:9344
    v_cvt_pk_bf16_f32 v92, v174, v175
    v_cvt_pk_bf16_f32 v93, v176, v177
    v_cvt_pk_bf16_f32 v94, v178, v179
    v_cvt_pk_bf16_f32 v95, v180, v181
    ds_write_b128 v99, v[92:95] offset:13504
    s_waitcnt lgkmcnt(11)
    v_cvt_pk_bf16_f32 v64, v182, v183
    v_cvt_pk_bf16_f32 v65, v184, v185
    v_cvt_pk_bf16_f32 v66, v186, v187
    v_cvt_pk_bf16_f32 v67, v188, v189
    ds_write_b128 v99, v[64:67] offset:2048
    v_cvt_pk_bf16_f32 v68, v183, v184
    v_cvt_pk_bf16_f32 v69, v185, v186
    v_cvt_pk_bf16_f32 v70, v187, v188
    v_cvt_pk_bf16_f32 v71, v189, v190
    ds_write_b128 v99, v[68:71] offset:6208
    v_cvt_pk_bf16_f32 v72, v184, v185
    v_cvt_pk_bf16_f32 v73, v186, v187
    v_cvt_pk_bf16_f32 v74, v188, v189
    v_cvt_pk_bf16_f32 v75, v190, v191
    ds_write_b128 v99, v[72:75] offset:10368
    v_cvt_pk_bf16_f32 v76, v185, v186
    v_cvt_pk_bf16_f32 v77, v187, v188
    v_cvt_pk_bf16_f32 v78, v189, v190
    v_cvt_pk_bf16_f32 v79, v191, v192
    ds_write_b128 v99, v[76:79] offset:14528
    s_waitcnt lgkmcnt(0)
    v_cndmask_b32 v201, v201, v20, vcc
    v_cndmask_b32 v202, v202, v20, vcc
    v_cndmask_b32 v203, v203, v20, vcc
    v_cvt_pk_bf16_f32 v80, v193, v194
    v_cvt_pk_bf16_f32 v81, v195, v196
    v_cvt_pk_bf16_f32 v82, v197, v198
    v_cvt_pk_bf16_f32 v83, v199, v200
    ds_write_b128 v99, v[80:83] offset:3072
    v_cvt_pk_bf16_f32 v84, v194, v195
    v_cvt_pk_bf16_f32 v85, v196, v197
    v_cvt_pk_bf16_f32 v86, v198, v199
    v_cvt_pk_bf16_f32 v87, v200, v201
    ds_write_b128 v99, v[84:87] offset:7232
    v_cvt_pk_bf16_f32 v88, v195, v196
    v_cvt_pk_bf16_f32 v89, v197, v198
    v_cvt_pk_bf16_f32 v90, v199, v200
    v_cvt_pk_bf16_f32 v91, v201, v202
    ds_write_b128 v99, v[88:91] offset:11392
    v_cvt_pk_bf16_f32 v92, v196, v197
    v_cvt_pk_bf16_f32 v93, v198, v199
    v_cvt_pk_bf16_f32 v94, v200, v201
    v_cvt_pk_bf16_f32 v95, v202, v203
    ds_write_b128 v99, v[92:95] offset:15552
    v_and_b32 v7, 15, v1
    v_lshrrev_b32 v8, 4, v1
    v_lshrrev_b32 v9, 1, v8
    v_and_b32 v8, 1, v8
    v_sub_u32 v5, v7, v9
    v_lshlrev_b32 v5, 5, v5
    v_lshl_add_u32 v5, v8, 4, v5
    s_mul_i32 s29, s24, 4608
    s_add_u32 s29, s29, 143872
    v_add_u32 v5, s29, v5
    v_and_b32 v10, 3, v7
    v_sub_u32 v10, 3, v10
    v_mul_u32_u24 v4, 4160, v10
    v_lshrrev_b32 v10, 2, v7
    v_lshlrev_b32 v10, 3, v10
    v_sub_u32 v4, v4, v10
    v_lshlrev_b32 v10, 5, v9
    v_sub_u32 v4, v4, v10
    v_lshl_add_u32 v4, v8, 4, v4
    s_add_u32 s30, s28, 504
    v_add_u32 v4, s30, v4
    v_mov_b32 v96, 0
    v_mov_b32 v97, 0
    v_mov_b32 v98, 0
    v_mov_b32 v99, 0
    v_mov_b32 v100, 0
    v_mov_b32 v101, 0
    v_mov_b32 v102, 0
    v_mov_b32 v103, 0
    v_mov_b32 v104, 0
    v_mov_b32 v105, 0
    v_mov_b32 v106, 0
    v_mov_b32 v107, 0
    v_mov_b32 v108, 0
    v_mov_b32 v109, 0
    v_mov_b32 v110, 0
    v_mov_b32 v111, 0
    v_mov_b32 v112, 0
    v_mov_b32 v113, 0
    v_mov_b32 v114, 0
    v_mov_b32 v115, 0
    v_mov_b32 v116, 0
    v_mov_b32 v117, 0
    v_mov_b32 v118, 0
    v_mov_b32 v119, 0
    v_mov_b32 v120, 0
    v_mov_b32 v121, 0
    v_mov_b32 v122, 0
    v_mov_b32 v123, 0
    v_mov_b32 v124, 0
    v_mov_b32 v125, 0
    v_mov_b32 v126, 0
    v_mov_b32 v127, 0
    s_waitcnt lgkmcnt(0)
    s_barrier
    ds_read_b64 v[128:129], v4 offset:3584
    ds_read_b64 v[130:131], v4 offset:3592
    ds_read_b128 v[160:163], v5 offset:0
    ds_read_b64 v[132:133], v4 offset:3072
    ds_read_b64 v[134:135], v4 offset:3080
    ds_read_b128 v[164:167], v5 offset:512
    ds_read_b64 v[136:137], v4 offset:2560
    ds_read_b64 v[138:139], v4 offset:2568
    ds_read_b128 v[168:171], v5 offset:1024
    ds_read_b64 v[140:141], v4 offset:2048
    ds_read_b64 v[142:143], v4 offset:2056
    ds_read_b128 v[172:175], v5 offset:1536
    ds_read_b64 v[144:145], v4 offset:1536
    ds_read_b64 v[146:147], v4 offset:1544
    ds_read_b128 v[176:179], v5 offset:2048
    ds_read_b64 v[148:149], v4 offset:1024
    ds_read_b64 v[150:151], v4 offset:1032
    ds_read_b128 v[180:183], v5 offset:2560
    ds_read_b64 v[152:153], v4 offset:512
    ds_read_b64 v[154:155], v4 offset:520
    ds_read_b128 v[184:187], v5 offset:3072
    ds_read_b64 v[156:157], v4 offset:0
    ds_read_b64 v[158:159], v4 offset:8
    ds_read_b128 v[188:191], v5 offset:3584
    s_mov_b32 s30, 0
CONV_1:
    s_waitcnt lgkmcnt(0)
    v_subrev_u32 v4, 64, v4
    v_subrev_u32 v5, 64, v5
    v_mfma_f32_16x16x32_bf16 v[96:99], v[128:131], v[160:163], v[96:99]
    ds_read_b64 v[192:193], v4 offset:3584
    v_mfma_f32_16x16x32_bf16 v[100:103], v[128:131], v[164:167], v[100:103]
    ds_read_b64 v[194:195], v4 offset:3592
    v_mfma_f32_16x16x32_bf16 v[104:107], v[128:131], v[168:171], v[104:107]
    ds_read_b128 v[224:227], v5 offset:0
    v_mfma_f32_16x16x32_bf16 v[108:111], v[128:131], v[172:175], v[108:111]
    ds_read_b64 v[196:197], v4 offset:3072
    v_mfma_f32_16x16x32_bf16 v[112:115], v[128:131], v[176:179], v[112:115]
    ds_read_b64 v[198:199], v4 offset:3080
    v_mfma_f32_16x16x32_bf16 v[116:119], v[128:131], v[180:183], v[116:119]
    ds_read_b128 v[228:231], v5 offset:512
    v_mfma_f32_16x16x32_bf16 v[120:123], v[128:131], v[184:187], v[120:123]
    ds_read_b64 v[200:201], v4 offset:2560
    v_mfma_f32_16x16x32_bf16 v[124:127], v[128:131], v[188:191], v[124:127]
    ds_read_b64 v[202:203], v4 offset:2568
    v_mfma_f32_16x16x32_bf16 v[100:103], v[132:135], v[160:163], v[100:103]
    ds_read_b128 v[232:235], v5 offset:1024
    v_mfma_f32_16x16x32_bf16 v[104:107], v[132:135], v[164:167], v[104:107]
    ds_read_b64 v[204:205], v4 offset:2048
    v_mfma_f32_16x16x32_bf16 v[108:111], v[132:135], v[168:171], v[108:111]
    ds_read_b64 v[206:207], v4 offset:2056
    v_mfma_f32_16x16x32_bf16 v[112:115], v[132:135], v[172:175], v[112:115]
    ds_read_b128 v[236:239], v5 offset:1536
    v_mfma_f32_16x16x32_bf16 v[116:119], v[132:135], v[176:179], v[116:119]
    ds_read_b64 v[208:209], v4 offset:1536
    v_mfma_f32_16x16x32_bf16 v[120:123], v[132:135], v[180:183], v[120:123]
    ds_read_b64 v[210:211], v4 offset:1544
    v_mfma_f32_16x16x32_bf16 v[124:127], v[132:135], v[184:187], v[124:127]
    ds_read_b128 v[240:243], v5 offset:2048
    v_mfma_f32_16x16x32_bf16 v[104:107], v[136:139], v[160:163], v[104:107]
    ds_read_b64 v[212:213], v4 offset:1024
    v_mfma_f32_16x16x32_bf16 v[108:111], v[136:139], v[164:167], v[108:111]
    ds_read_b64 v[214:215], v4 offset:1032
    v_mfma_f32_16x16x32_bf16 v[112:115], v[136:139], v[168:171], v[112:115]
    ds_read_b128 v[244:247], v5 offset:2560
    v_mfma_f32_16x16x32_bf16 v[116:119], v[136:139], v[172:175], v[116:119]
    ds_read_b64 v[216:217], v4 offset:512
    v_mfma_f32_16x16x32_bf16 v[120:123], v[136:139], v[176:179], v[120:123]
    ds_read_b64 v[218:219], v4 offset:520
    v_mfma_f32_16x16x32_bf16 v[124:127], v[136:139], v[180:183], v[124:127]
    ds_read_b128 v[248:251], v5 offset:3072
    v_mfma_f32_16x16x32_bf16 v[108:111], v[140:143], v[160:163], v[108:111]
    ds_read_b64 v[220:221], v4 offset:0
    v_mfma_f32_16x16x32_bf16 v[112:115], v[140:143], v[164:167], v[112:115]
    ds_read_b64 v[222:223], v4 offset:8
    v_mfma_f32_16x16x32_bf16 v[116:119], v[140:143], v[168:171], v[116:119]
    ds_read_b128 v[252:255], v5 offset:3584
    v_mfma_f32_16x16x32_bf16 v[120:123], v[140:143], v[172:175], v[120:123]
    v_mfma_f32_16x16x32_bf16 v[124:127], v[140:143], v[176:179], v[124:127]
    v_mfma_f32_16x16x32_bf16 v[112:115], v[144:147], v[160:163], v[112:115]
    v_mfma_f32_16x16x32_bf16 v[116:119], v[144:147], v[164:167], v[116:119]
    v_mfma_f32_16x16x32_bf16 v[120:123], v[144:147], v[168:171], v[120:123]
    v_mfma_f32_16x16x32_bf16 v[124:127], v[144:147], v[172:175], v[124:127]
    v_mfma_f32_16x16x32_bf16 v[116:119], v[148:151], v[160:163], v[116:119]
    v_mfma_f32_16x16x32_bf16 v[120:123], v[148:151], v[164:167], v[120:123]
    v_mfma_f32_16x16x32_bf16 v[124:127], v[148:151], v[168:171], v[124:127]
    v_mfma_f32_16x16x32_bf16 v[120:123], v[152:155], v[160:163], v[120:123]
    v_mfma_f32_16x16x32_bf16 v[124:127], v[152:155], v[164:167], v[124:127]
    v_mfma_f32_16x16x32_bf16 v[124:127], v[156:159], v[160:163], v[124:127]
    s_waitcnt lgkmcnt(0)
    v_subrev_u32 v4, 64, v4
    v_subrev_u32 v5, 64, v5
    v_mfma_f32_16x16x32_bf16 v[96:99], v[192:195], v[224:227], v[96:99]
    ds_read_b64 v[128:129], v4 offset:3584
    v_mfma_f32_16x16x32_bf16 v[100:103], v[192:195], v[228:231], v[100:103]
    ds_read_b64 v[130:131], v4 offset:3592
    v_mfma_f32_16x16x32_bf16 v[104:107], v[192:195], v[232:235], v[104:107]
    ds_read_b128 v[160:163], v5 offset:0
    v_mfma_f32_16x16x32_bf16 v[108:111], v[192:195], v[236:239], v[108:111]
    ds_read_b64 v[132:133], v4 offset:3072
    v_mfma_f32_16x16x32_bf16 v[112:115], v[192:195], v[240:243], v[112:115]
    ds_read_b64 v[134:135], v4 offset:3080
    v_mfma_f32_16x16x32_bf16 v[116:119], v[192:195], v[244:247], v[116:119]
    ds_read_b128 v[164:167], v5 offset:512
    v_mfma_f32_16x16x32_bf16 v[120:123], v[192:195], v[248:251], v[120:123]
    ds_read_b64 v[136:137], v4 offset:2560
    v_mfma_f32_16x16x32_bf16 v[124:127], v[192:195], v[252:255], v[124:127]
    ds_read_b64 v[138:139], v4 offset:2568
    v_mfma_f32_16x16x32_bf16 v[100:103], v[196:199], v[224:227], v[100:103]
    ds_read_b128 v[168:171], v5 offset:1024
    v_mfma_f32_16x16x32_bf16 v[104:107], v[196:199], v[228:231], v[104:107]
    ds_read_b64 v[140:141], v4 offset:2048
    v_mfma_f32_16x16x32_bf16 v[108:111], v[196:199], v[232:235], v[108:111]
    ds_read_b64 v[142:143], v4 offset:2056
    v_mfma_f32_16x16x32_bf16 v[112:115], v[196:199], v[236:239], v[112:115]
    ds_read_b128 v[172:175], v5 offset:1536
    v_mfma_f32_16x16x32_bf16 v[116:119], v[196:199], v[240:243], v[116:119]
    ds_read_b64 v[144:145], v4 offset:1536
    v_mfma_f32_16x16x32_bf16 v[120:123], v[196:199], v[244:247], v[120:123]
    ds_read_b64 v[146:147], v4 offset:1544
    v_mfma_f32_16x16x32_bf16 v[124:127], v[196:199], v[248:251], v[124:127]
    ds_read_b128 v[176:179], v5 offset:2048
    v_mfma_f32_16x16x32_bf16 v[104:107], v[200:203], v[224:227], v[104:107]
    ds_read_b64 v[148:149], v4 offset:1024
    v_mfma_f32_16x16x32_bf16 v[108:111], v[200:203], v[228:231], v[108:111]
    ds_read_b64 v[150:151], v4 offset:1032
    v_mfma_f32_16x16x32_bf16 v[112:115], v[200:203], v[232:235], v[112:115]
    ds_read_b128 v[180:183], v5 offset:2560
    v_mfma_f32_16x16x32_bf16 v[116:119], v[200:203], v[236:239], v[116:119]
    ds_read_b64 v[152:153], v4 offset:512
    v_mfma_f32_16x16x32_bf16 v[120:123], v[200:203], v[240:243], v[120:123]
    ds_read_b64 v[154:155], v4 offset:520
    v_mfma_f32_16x16x32_bf16 v[124:127], v[200:203], v[244:247], v[124:127]
    ds_read_b128 v[184:187], v5 offset:3072
    v_mfma_f32_16x16x32_bf16 v[108:111], v[204:207], v[224:227], v[108:111]
    ds_read_b64 v[156:157], v4 offset:0
    v_mfma_f32_16x16x32_bf16 v[112:115], v[204:207], v[228:231], v[112:115]
    ds_read_b64 v[158:159], v4 offset:8
    v_mfma_f32_16x16x32_bf16 v[116:119], v[204:207], v[232:235], v[116:119]
    ds_read_b128 v[188:191], v5 offset:3584
    v_mfma_f32_16x16x32_bf16 v[120:123], v[204:207], v[236:239], v[120:123]
    v_mfma_f32_16x16x32_bf16 v[124:127], v[204:207], v[240:243], v[124:127]
    v_mfma_f32_16x16x32_bf16 v[112:115], v[208:211], v[224:227], v[112:115]
    v_mfma_f32_16x16x32_bf16 v[116:119], v[208:211], v[228:231], v[116:119]
    v_mfma_f32_16x16x32_bf16 v[120:123], v[208:211], v[232:235], v[120:123]
    v_mfma_f32_16x16x32_bf16 v[124:127], v[208:211], v[236:239], v[124:127]
    v_mfma_f32_16x16x32_bf16 v[116:119], v[212:215], v[224:227], v[116:119]
    v_mfma_f32_16x16x32_bf16 v[120:123], v[212:215], v[228:231], v[120:123]
    v_mfma_f32_16x16x32_bf16 v[124:127], v[212:215], v[232:235], v[124:127]
    v_mfma_f32_16x16x32_bf16 v[120:123], v[216:219], v[224:227], v[120:123]
    v_mfma_f32_16x16x32_bf16 v[124:127], v[216:219], v[228:231], v[124:127]
    v_mfma_f32_16x16x32_bf16 v[124:127], v[220:223], v[224:227], v[124:127]
    s_add_u32 s30, s30, 1
    s_cmp_lt_u32 s30, 3
    s_cbranch_scc1 CONV_1
    s_waitcnt lgkmcnt(0)
    v_subrev_u32 v4, 64, v4
    v_subrev_u32 v5, 64, v5
    v_mfma_f32_16x16x32_bf16 v[96:99], v[128:131], v[160:163], v[96:99]
    ds_read_b64 v[192:193], v4 offset:3584
    v_mfma_f32_16x16x32_bf16 v[100:103], v[128:131], v[164:167], v[100:103]
    ds_read_b64 v[194:195], v4 offset:3592
    v_mfma_f32_16x16x32_bf16 v[104:107], v[128:131], v[168:171], v[104:107]
    ds_read_b128 v[224:227], v5 offset:0
    v_mfma_f32_16x16x32_bf16 v[108:111], v[128:131], v[172:175], v[108:111]
    ds_read_b64 v[196:197], v4 offset:3072
    v_mfma_f32_16x16x32_bf16 v[112:115], v[128:131], v[176:179], v[112:115]
    ds_read_b64 v[198:199], v4 offset:3080
    v_mfma_f32_16x16x32_bf16 v[116:119], v[128:131], v[180:183], v[116:119]
    ds_read_b128 v[228:231], v5 offset:512
    v_mfma_f32_16x16x32_bf16 v[120:123], v[128:131], v[184:187], v[120:123]
    ds_read_b64 v[200:201], v4 offset:2560
    v_mfma_f32_16x16x32_bf16 v[124:127], v[128:131], v[188:191], v[124:127]
    ds_read_b64 v[202:203], v4 offset:2568
    v_mfma_f32_16x16x32_bf16 v[100:103], v[132:135], v[160:163], v[100:103]
    ds_read_b128 v[232:235], v5 offset:1024
    v_mfma_f32_16x16x32_bf16 v[104:107], v[132:135], v[164:167], v[104:107]
    ds_read_b64 v[204:205], v4 offset:2048
    v_mfma_f32_16x16x32_bf16 v[108:111], v[132:135], v[168:171], v[108:111]
    ds_read_b64 v[206:207], v4 offset:2056
    v_mfma_f32_16x16x32_bf16 v[112:115], v[132:135], v[172:175], v[112:115]
    ds_read_b128 v[236:239], v5 offset:1536
    v_mfma_f32_16x16x32_bf16 v[116:119], v[132:135], v[176:179], v[116:119]
    ds_read_b64 v[208:209], v4 offset:1536
    v_mfma_f32_16x16x32_bf16 v[120:123], v[132:135], v[180:183], v[120:123]
    ds_read_b64 v[210:211], v4 offset:1544
    v_mfma_f32_16x16x32_bf16 v[124:127], v[132:135], v[184:187], v[124:127]
    ds_read_b128 v[240:243], v5 offset:2048
    v_mfma_f32_16x16x32_bf16 v[104:107], v[136:139], v[160:163], v[104:107]
    ds_read_b64 v[212:213], v4 offset:1024
    v_mfma_f32_16x16x32_bf16 v[108:111], v[136:139], v[164:167], v[108:111]
    ds_read_b64 v[214:215], v4 offset:1032
    v_mfma_f32_16x16x32_bf16 v[112:115], v[136:139], v[168:171], v[112:115]
    ds_read_b128 v[244:247], v5 offset:2560
    v_mfma_f32_16x16x32_bf16 v[116:119], v[136:139], v[172:175], v[116:119]
    ds_read_b64 v[216:217], v4 offset:512
    v_mfma_f32_16x16x32_bf16 v[120:123], v[136:139], v[176:179], v[120:123]
    ds_read_b64 v[218:219], v4 offset:520
    v_mfma_f32_16x16x32_bf16 v[124:127], v[136:139], v[180:183], v[124:127]
    ds_read_b128 v[248:251], v5 offset:3072
    v_mfma_f32_16x16x32_bf16 v[108:111], v[140:143], v[160:163], v[108:111]
    ds_read_b64 v[220:221], v4 offset:0
    v_mfma_f32_16x16x32_bf16 v[112:115], v[140:143], v[164:167], v[112:115]
    ds_read_b64 v[222:223], v4 offset:8
    v_mfma_f32_16x16x32_bf16 v[116:119], v[140:143], v[168:171], v[116:119]
    ds_read_b128 v[252:255], v5 offset:3584
    v_mfma_f32_16x16x32_bf16 v[120:123], v[140:143], v[172:175], v[120:123]
    v_mfma_f32_16x16x32_bf16 v[124:127], v[140:143], v[176:179], v[124:127]
    v_mfma_f32_16x16x32_bf16 v[112:115], v[144:147], v[160:163], v[112:115]
    v_mfma_f32_16x16x32_bf16 v[116:119], v[144:147], v[164:167], v[116:119]
    v_mfma_f32_16x16x32_bf16 v[120:123], v[144:147], v[168:171], v[120:123]
    v_mfma_f32_16x16x32_bf16 v[124:127], v[144:147], v[172:175], v[124:127]
    v_mfma_f32_16x16x32_bf16 v[116:119], v[148:151], v[160:163], v[116:119]
    v_mfma_f32_16x16x32_bf16 v[120:123], v[148:151], v[164:167], v[120:123]
    v_mfma_f32_16x16x32_bf16 v[124:127], v[148:151], v[168:171], v[124:127]
    v_mfma_f32_16x16x32_bf16 v[120:123], v[152:155], v[160:163], v[120:123]
    v_mfma_f32_16x16x32_bf16 v[124:127], v[152:155], v[164:167], v[124:127]
    v_mfma_f32_16x16x32_bf16 v[124:127], v[156:159], v[160:163], v[124:127]
    s_waitcnt lgkmcnt(0)
    v_mfma_f32_16x16x32_bf16 v[96:99], v[192:195], v[224:227], v[96:99]
    v_mfma_f32_16x16x32_bf16 v[100:103], v[192:195], v[228:231], v[100:103]
    v_mfma_f32_16x16x32_bf16 v[104:107], v[192:195], v[232:235], v[104:107]
    v_mfma_f32_16x16x32_bf16 v[108:111], v[192:195], v[236:239], v[108:111]
    v_mfma_f32_16x16x32_bf16 v[112:115], v[192:195], v[240:243], v[112:115]
    v_mfma_f32_16x16x32_bf16 v[116:119], v[192:195], v[244:247], v[116:119]
    v_mfma_f32_16x16x32_bf16 v[120:123], v[192:195], v[248:251], v[120:123]
    v_mfma_f32_16x16x32_bf16 v[124:127], v[192:195], v[252:255], v[124:127]
    v_mfma_f32_16x16x32_bf16 v[100:103], v[196:199], v[224:227], v[100:103]
    v_mfma_f32_16x16x32_bf16 v[104:107], v[196:199], v[228:231], v[104:107]
    v_mfma_f32_16x16x32_bf16 v[108:111], v[196:199], v[232:235], v[108:111]
    v_mfma_f32_16x16x32_bf16 v[112:115], v[196:199], v[236:239], v[112:115]
    v_mfma_f32_16x16x32_bf16 v[116:119], v[196:199], v[240:243], v[116:119]
    v_mfma_f32_16x16x32_bf16 v[120:123], v[196:199], v[244:247], v[120:123]
    v_mfma_f32_16x16x32_bf16 v[124:127], v[196:199], v[248:251], v[124:127]
    v_mfma_f32_16x16x32_bf16 v[104:107], v[200:203], v[224:227], v[104:107]
    v_mfma_f32_16x16x32_bf16 v[108:111], v[200:203], v[228:231], v[108:111]
    v_mfma_f32_16x16x32_bf16 v[112:115], v[200:203], v[232:235], v[112:115]
    v_mfma_f32_16x16x32_bf16 v[116:119], v[200:203], v[236:239], v[116:119]
    v_mfma_f32_16x16x32_bf16 v[120:123], v[200:203], v[240:243], v[120:123]
    v_mfma_f32_16x16x32_bf16 v[124:127], v[200:203], v[244:247], v[124:127]
    v_mfma_f32_16x16x32_bf16 v[108:111], v[204:207], v[224:227], v[108:111]
    v_mfma_f32_16x16x32_bf16 v[112:115], v[204:207], v[228:231], v[112:115]
    v_mfma_f32_16x16x32_bf16 v[116:119], v[204:207], v[232:235], v[116:119]
    v_mfma_f32_16x16x32_bf16 v[120:123], v[204:207], v[236:239], v[120:123]
    v_mfma_f32_16x16x32_bf16 v[124:127], v[204:207], v[240:243], v[124:127]
    v_mfma_f32_16x16x32_bf16 v[112:115], v[208:211], v[224:227], v[112:115]
    v_mfma_f32_16x16x32_bf16 v[116:119], v[208:211], v[228:231], v[116:119]
    v_mfma_f32_16x16x32_bf16 v[120:123], v[208:211], v[232:235], v[120:123]
    v_mfma_f32_16x16x32_bf16 v[124:127], v[208:211], v[236:239], v[124:127]
    v_mfma_f32_16x16x32_bf16 v[116:119], v[212:215], v[224:227], v[116:119]
    v_mfma_f32_16x16x32_bf16 v[120:123], v[212:215], v[228:231], v[120:123]
    v_mfma_f32_16x16x32_bf16 v[124:127], v[212:215], v[232:235], v[124:127]
    v_mfma_f32_16x16x32_bf16 v[120:123], v[216:219], v[224:227], v[120:123]
    v_mfma_f32_16x16x32_bf16 v[124:127], v[216:219], v[228:231], v[124:127]
    v_mfma_f32_16x16x32_bf16 v[124:127], v[220:223], v[224:227], v[124:127]
    v_lshrrev_b32 v8, 4, v1
    v_lshlrev_b32 v8, 3, v8
    v_lshl_add_u32 v8, v7, 5, v8
    s_sub_u32 s29, s29, 512
    v_add_u32 v8, s29, v8
    v_cvt_pk_bf16_f32 v128, v96, v97
    v_cvt_pk_bf16_f32 v129, v98, v99
    ds_write_b64 v8, v[128:129] offset:0
    v_cvt_pk_bf16_f32 v130, v100, v101
    v_cvt_pk_bf16_f32 v131, v102, v103
    ds_write_b64 v8, v[130:131] offset:512
    v_cvt_pk_bf16_f32 v132, v104, v105
    v_cvt_pk_bf16_f32 v133, v106, v107
    ds_write_b64 v8, v[132:133] offset:1024
    v_cvt_pk_bf16_f32 v134, v108, v109
    v_cvt_pk_bf16_f32 v135, v110, v111
    ds_write_b64 v8, v[134:135] offset:1536
    v_cvt_pk_bf16_f32 v136, v112, v113
    v_cvt_pk_bf16_f32 v137, v114, v115
    ds_write_b64 v8, v[136:137] offset:2048
    v_cvt_pk_bf16_f32 v138, v116, v117
    v_cvt_pk_bf16_f32 v139, v118, v119
    ds_write_b64 v8, v[138:139] offset:2560
    v_cvt_pk_bf16_f32 v140, v120, v121
    v_cvt_pk_bf16_f32 v141, v122, v123
    ds_write_b64 v8, v[140:141] offset:3072
    v_cvt_pk_bf16_f32 v142, v124, v125
    v_cvt_pk_bf16_f32 v143, v126, v127
    ds_write_b64 v8, v[142:143] offset:3584
    s_waitcnt lgkmcnt(0)
    s_barrier
    s_branch C_FFN
L_CONV:
    s_lshl_b32 s25, s24, 8
    v_add_u32 v100, s25, v1
    v_mul_u32_u24 v101, 2560, v100
    s_mov_b32 s16, s64
    s_mov_b32 s17, s65
    s_mov_b32 s18, 0x280000
    s_mov_b32 s19, 0x20000
    s_lshl_b32 s42, s48, 3
    s_add_u32 s6, s80, s42
    s_addc_u32 s7, s81, 0
    s_load_dwordx2 s[36:37], s[6:7], 0
    v_mov_b32 v8, 161960
    s_mov_b32 s101, 0
LW_2:
    s_add_u32 s101, s101, 1
    s_cmp_gt_u32 s101, 4000000
    s_cbranch_scc1 LWX_3
    ds_read_b32 v9, v8
    s_waitcnt lgkmcnt(0)
    v_readfirstlane_b32 s34, v9
    s_nop 0
    s_cmp_ge_u32 s34, 2
    s_cbranch_scc1 LWX_3
    s_branch LW_2
LWX_3:
    s_add_u32 s43, s42, 0
    buffer_load_dwordx2 v[112:113], v101, s[16:19], s43 offen
    s_add_u32 s43, s42, 0
    buffer_load_dwordx2 v[114:115], v101, s[16:19], s43 offen offset:1280
    s_add_u32 s43, s42, 163840
    buffer_load_dwordx2 v[116:117], v101, s[16:19], s43 offen
    s_add_u32 s43, s42, 163840
    buffer_load_dwordx2 v[118:119], v101, s[16:19], s43 offen offset:1280
    s_add_u32 s43, s42, 327680
    buffer_load_dwordx2 v[120:121], v101, s[16:19], s43 offen
    s_add_u32 s43, s42, 327680
    buffer_load_dwordx2 v[122:123], v101, s[16:19], s43 offen offset:1280
    s_add_u32 s43, s42, 491520
    buffer_load_dwordx2 v[124:125], v101, s[16:19], s43 offen
    s_add_u32 s43, s42, 491520
    buffer_load_dwordx2 v[126:127], v101, s[16:19], s43 offen offset:1280
    s_mul_i32 s27, s24, 4608
    s_add_u32 s27, s27, 143360
    v_lshlrev_b32 v10, 3, v1
    v_add_u32 v10, s27, v10
    v_mov_b32 v12, 0
    v_mov_b32 v13, 0
    ds_write_b64 v10, v[12:13]
    v_mov_b32 v14, 0
    s_mov_b32 s101, 0
NONCE_4:
    s_add_u32 s101, s101, 1
    s_cmp_gt_u32 s101, 200000
    s_cbranch_scc1 NONCEX_5
    buffer_load_dword v15, v14, s[60:63], 0 offen sc1
    s_waitcnt vmcnt(0)
    v_readfirstlane_b32 s49, v15
    s_nop 0
    s_cmp_eq_u32 s49, 0
    s_cbranch_scc1 NONCE_4
NONCEX_5:
    v_lshlrev_b32 v11, 5, v100
    s_mov_b32 s101, 0
SP_6:
    s_add_u32 s101, s101, 1
    s_cmp_gt_u32 s101, 200000
    s_cbranch_scc1 SPX_7
    s_mov_b32 s27, 0x0
    buffer_load_dwordx4 v[144:147], v11, s[8:11], s27 offen sc1
    buffer_load_dwordx4 v[148:151], v11, s[8:11], s27 offen offset:16 sc1
    s_mov_b32 s27, 0x800
    buffer_load_dwordx4 v[152:155], v11, s[8:11], s27 offen sc1
    buffer_load_dwordx4 v[156:159], v11, s[8:11], s27 offen offset:16 sc1
    s_mov_b32 s27, 0x1000
    buffer_load_dwordx4 v[160:163], v11, s[8:11], s27 offen sc1
    buffer_load_dwordx4 v[164:167], v11, s[8:11], s27 offen offset:16 sc1
    s_mov_b32 s27, 0x1800
    buffer_load_dwordx4 v[168:171], v11, s[8:11], s27 offen sc1
    buffer_load_dwordx4 v[172:175], v11, s[8:11], s27 offen offset:16 sc1
    s_waitcnt vmcnt(0)
    v_cmp_ne_u32 vcc, s49, v145
    v_cmp_ne_u32 s[34:35], s49, v147
    s_nop 0
    s_or_b64 vcc, vcc, s[34:35]
    v_cmp_ne_u32 s[34:35], s49, v149
    s_nop 0
    s_or_b64 vcc, vcc, s[34:35]
    v_cmp_ne_u32 s[34:35], s49, v151
    s_nop 0
    s_or_b64 vcc, vcc, s[34:35]
    v_cmp_ne_u32 s[34:35], s49, v153
    s_nop 0
    s_or_b64 vcc, vcc, s[34:35]
    v_cmp_ne_u32 s[34:35], s49, v155
    s_nop 0
    s_or_b64 vcc, vcc, s[34:35]
    v_cmp_ne_u32 s[34:35], s49, v157
    s_nop 0
    s_or_b64 vcc, vcc, s[34:35]
    v_cmp_ne_u32 s[34:35], s49, v159
    s_nop 0
    s_or_b64 vcc, vcc, s[34:35]
    v_cmp_ne_u32 s[34:35], s49, v161
    s_nop 0
    s_or_b64 vcc, vcc, s[34:35]
    v_cmp_ne_u32 s[34:35], s49, v163
    s_nop 0
    s_or_b64 vcc, vcc, s[34:35]
    v_cmp_ne_u32 s[34:35], s49, v165
    s_nop 0
    s_or_b64 vcc, vcc, s[34:35]
    v_cmp_ne_u32 s[34:35], s49, v167
    s_nop 0
    s_or_b64 vcc, vcc, s[34:35]
    v_cmp_ne_u32 s[34:35], s49, v169
    s_nop 0
    s_or_b64 vcc, vcc, s[34:35]
    v_cmp_ne_u32 s[34:35], s49, v171
    s_nop 0
    s_or_b64 vcc, vcc, s[34:35]
    v_cmp_ne_u32 s[34:35], s49, v173
    s_nop 0
    s_or_b64 vcc, vcc, s[34:35]
    v_cmp_ne_u32 s[34:35], s49, v175
    s_nop 0
    s_or_b64 vcc, vcc, s[34:35]
    s_cbranch_vccnz SP_6
SPX_7:
    v_lshlrev_b32 v102, 2, v100
    v_add_u32 v102, 143872, v102
    v_lshlrev_b32 v16, 16, v112
    v_and_b32 v17, 0xffff0000, v112
    v_lshlrev_b32 v18, 16, v113
    v_and_b32 v19, 0xffff0000, v113
    v_sub_f32 v16, v16, v144
    v_mul_f32 v16, v16, v146
    v_sub_f32 v17, v17, v144
    v_mul_f32 v17, v17, v146
    v_sub_f32 v18, v18, v144
    v_mul_f32 v18, v18, v146
    v_sub_f32 v19, v19, v144
    v_mul_f32 v19, v19, v146
    v_lshlrev_b32 v20, 16, v114
    v_and_b32 v21, 0xffff0000, v114
    v_lshlrev_b32 v22, 16, v115
    v_and_b32 v23, 0xffff0000, v115
    v_sub_f32 v20, v20, v148
    v_mul_f32 v20, v20, v150
    v_sub_f32 v21, v21, v148
    v_mul_f32 v21, v21, v150
    v_sub_f32 v22, v22, v148
    v_mul_f32 v22, v22, v150
    v_sub_f32 v23, v23, v148
    v_mul_f32 v23, v23, v150
    v_cvt_pk_bf16_f32 v128, v16, v20
    ds_write_b32 v102, v128 offset:0
    v_cvt_pk_bf16_f32 v129, v17, v21
    ds_write_b32 v102, v129 offset:4608
    v_cvt_pk_bf16_f32 v130, v18, v22
    ds_write_b32 v102, v130 offset:9216
    v_cvt_pk_bf16_f32 v131, v19, v23
    ds_write_b32 v102, v131 offset:13824
    v_lshlrev_b32 v16, 16, v116
    v_and_b32 v17, 0xffff0000, v116
    v_lshlrev_b32 v18, 16, v117
    v_and_b32 v19, 0xffff0000, v117
    v_sub_f32 v16, v16, v152
    v_mul_f32 v16, v16, v154
    v_sub_f32 v17, v17, v152
    v_mul_f32 v17, v17, v154
    v_sub_f32 v18, v18, v152
    v_mul_f32 v18, v18, v154
    v_sub_f32 v19, v19, v152
    v_mul_f32 v19, v19, v154
    v_lshlrev_b32 v20, 16, v118
    v_and_b32 v21, 0xffff0000, v118
    v_lshlrev_b32 v22, 16, v119
    v_and_b32 v23, 0xffff0000, v119
    v_sub_f32 v20, v20, v156
    v_mul_f32 v20, v20, v158
    v_sub_f32 v21, v21, v156
    v_mul_f32 v21, v21, v158
    v_sub_f32 v22, v22, v156
    v_mul_f32 v22, v22, v158
    v_sub_f32 v23, v23, v156
    v_mul_f32 v23, v23, v158
    v_cvt_pk_bf16_f32 v132, v16, v20
    ds_write_b32 v102, v132 offset:256
    v_cvt_pk_bf16_f32 v133, v17, v21
    ds_write_b32 v102, v133 offset:4864
    v_cvt_pk_bf16_f32 v134, v18, v22
    ds_write_b32 v102, v134 offset:9472
    v_cvt_pk_bf16_f32 v135, v19, v23
    ds_write_b32 v102, v135 offset:14080
    v_lshlrev_b32 v16, 16, v120
    v_and_b32 v17, 0xffff0000, v120
    v_lshlrev_b32 v18, 16, v121
    v_and_b32 v19, 0xffff0000, v121
    v_sub_f32 v16, v16, v160
    v_mul_f32 v16, v16, v162
    v_sub_f32 v17, v17, v160
    v_mul_f32 v17, v17, v162
    v_sub_f32 v18, v18, v160
    v_mul_f32 v18, v18, v162
    v_sub_f32 v19, v19, v160
    v_mul_f32 v19, v19, v162
    v_lshlrev_b32 v20, 16, v122
    v_and_b32 v21, 0xffff0000, v122
    v_lshlrev_b32 v22, 16, v123
    v_and_b32 v23, 0xffff0000, v123
    v_sub_f32 v20, v20, v164
    v_mul_f32 v20, v20, v166
    v_sub_f32 v21, v21, v164
    v_mul_f32 v21, v21, v166
    v_sub_f32 v22, v22, v164
    v_mul_f32 v22, v22, v166
    v_sub_f32 v23, v23, v164
    v_mul_f32 v23, v23, v166
    v_cvt_pk_bf16_f32 v136, v16, v20
    ds_write_b32 v102, v136 offset:512
    v_cvt_pk_bf16_f32 v137, v17, v21
    ds_write_b32 v102, v137 offset:5120
    v_cvt_pk_bf16_f32 v138, v18, v22
    ds_write_b32 v102, v138 offset:9728
    v_cvt_pk_bf16_f32 v139, v19, v23
    ds_write_b32 v102, v139 offset:14336
    v_lshlrev_b32 v16, 16, v124
    v_and_b32 v17, 0xffff0000, v124
    v_lshlrev_b32 v18, 16, v125
    v_and_b32 v19, 0xffff0000, v125
    v_sub_f32 v16, v16, v168
    v_mul_f32 v16, v16, v170
    v_sub_f32 v17, v17, v168
    v_mul_f32 v17, v17, v170
    v_sub_f32 v18, v18, v168
    v_mul_f32 v18, v18, v170
    v_sub_f32 v19, v19, v168
    v_mul_f32 v19, v19, v170
    v_lshlrev_b32 v20, 16, v126
    v_and_b32 v21, 0xffff0000, v126
    v_lshlrev_b32 v22, 16, v127
    v_and_b32 v23, 0xffff0000, v127
    v_sub_f32 v20, v20, v172
    v_mul_f32 v20, v20, v174
    v_sub_f32 v21, v21, v172
    v_mul_f32 v21, v21, v174
    v_sub_f32 v22, v22, v172
    v_mul_f32 v22, v22, v174
    v_sub_f32 v23, v23, v172
    v_mul_f32 v23, v23, v174
    v_cvt_pk_bf16_f32 v140, v16, v20
    ds_write_b32 v102, v140 offset:768
    v_cvt_pk_bf16_f32 v141, v17, v21
    ds_write_b32 v102, v141 offset:5376
    v_cvt_pk_bf16_f32 v142, v18, v22
    ds_write_b32 v102, v142 offset:9984
    v_cvt_pk_bf16_f32 v143, v19, v23
    ds_write_b32 v102, v143 offset:14592
    v_mov_b32 v64, v112
    v_mov_b32 v65, v113
    v_mov_b32 v66, v114
    v_mov_b32 v67, v115
    v_mov_b32 v68, v116
    v_mov_b32 v69, v117
    v_mov_b32 v70, v118
    v_mov_b32 v71, v119
    v_mov_b32 v72, v120
    v_mov_b32 v73, v121
    v_mov_b32 v74, v122
    v_mov_b32 v75, v123
    v_mov_b32 v76, v124
    v_mov_b32 v77, v125
    v_mov_b32 v78, v126
    v_mov_b32 v79, v127
    v_mov_b32 v80, v128
    v_mov_b32 v81, v129
    v_mov_b32 v82, v130
    v_mov_b32 v83, v131
    v_mov_b32 v84, v132
    v_mov_b32 v85, v133
    v_mov_b32 v86, v134
    v_mov_b32 v87, v135
    v_mov_b32 v88, v136
    v_mov_b32 v89, v137
    v_mov_b32 v90, v138
    v_mov_b32 v91, v139
    v_mov_b32 v92, v140
    v_mov_b32 v93, v141
    v_mov_b32 v94, v142
    v_mov_b32 v95, v143
    v_mov_b32 v8, v100
    v_mov_b32 v10, v102
    s_waitcnt lgkmcnt(0)
    s_barrier
    s_cmp_lg_u32 s24, 0
    s_cbranch_scc1 L_NOGO
    v_mov_b32 v12, 0
    s_mov_b32 s27, 0x28000
    s_mov_b32 s101, 0
POLL_8:
    s_add_u32 s101, s101, 1
    s_cmp_gt_u32 s101, 200000
    s_cbranch_scc1 POLLX_9
    buffer_load_dword v14, v12, s[8:11], s27 offen sc1
    s_waitcnt vmcnt(0)
    v_cmp_ne_u32 vcc, s49, v14
    s_nop 0
    s_cbranch_vccnz POLL_8
POLLX_9:
    v_mov_b32 v12, 161948
    v_mov_b32 v13, 1
    s_mov_b64 exec, 1
    ds_add_u32 v12, v13
    s_mov_b64 exec, -1
L_NOGO:
    v_mbcnt_lo_u32_b32 v1, -1, 0
    v_mbcnt_hi_u32_b32 v1, -1, v1
    v_mul_u32_u24 v2, 4682, v1
    v_lshrrev_b32 v2, 16, v2
    v_mul_u32_u24 v3, 14, v2
    v_sub_u32 v3, v1, v3
    v_lshlrev_b32 v3, 4, v3
    s_mul_i32 s25, s23, 216
    v_add_u32 v3, s25, v3
    v_mul_u32_u24 v2, 3456, v2
    v_add_u32 v2, v2, v3
    s_mov_b32 s12, s84
    s_mov_b32 s13, s85
    s_mov_b32 s14, 0x21c000
    s_mov_b32 s15, 0x20000
    s_mul_i32 s26, s24, 13824
    s_mov_b32 exec_lo, -1
    s_mov_b32 exec_hi, 0x00ffffff
    s_add_u32 s27, s26, 0
    buffer_load_dwordx4 v[96:99], v2, s[12:15], s27 offen
    s_add_u32 s27, s26, 55296
    buffer_load_dwordx4 v[100:103], v2, s[12:15], s27 offen
    s_add_u32 s27, s26, 110592
    buffer_load_dwordx4 v[104:107], v2, s[12:15], s27 offen
    s_add_u32 s27, s26, 165888
    buffer_load_dwordx4 v[108:111], v2, s[12:15], s27 offen
    s_add_u32 s27, s26, 221184
    buffer_load_dwordx4 v[112:115], v2, s[12:15], s27 offen
    s_add_u32 s27, s26, 276480
    buffer_load_dwordx4 v[116:119], v2, s[12:15], s27 offen
    s_add_u32 s27, s26, 331776
    buffer_load_dwordx4 v[120:123], v2, s[12:15], s27 offen
    s_add_u32 s27, s26, 387072
    buffer_load_dwordx4 v[124:127], v2, s[12:15], s27 offen
    s_add_u32 s27, s26, 442368
    buffer_load_dwordx4 v[128:131], v2, s[12:15], s27 offen
    s_add_u32 s27, s26, 497664
    buffer_load_dwordx4 v[132:135], v2, s[12:15], s27 offen
    s_add_u32 s27, s26, 552960
    buffer_load_dwordx4 v[136:139], v2, s[12:15], s27 offen
    s_add_u32 s27, s26, 608256
    buffer_load_dwordx4 v[140:143], v2, s[12:15], s27 offen
    s_add_u32 s27, s26, 663552
    buffer_load_dwordx4 v[144:147], v2, s[12:15], s27 offen
    s_add_u32 s27, s26, 718848
    buffer_load_dwordx4 v[148:151], v2, s[12:15], s27 offen
    s_add_u32 s27, s26, 774144
    buffer_load_dwordx4 v[152:155], v2, s[12:15], s27 offen
    s_add_u32 s27, s26, 829440
    buffer_load_dwordx4 v[156:159], v2, s[12:15], s27 offen
    s_add_u32 s27, s26, 884736
    buffer_load_dwordx4 v[160:163], v2, s[12:15], s27 offen
    s_add_u32 s27, s26, 940032
    buffer_load_dwordx4 v[164:167], v2, s[12:15], s27 offen
    s_add_u32 s27, s26, 995328
    buffer_load_dwordx4 v[168:171], v2, s[12:15], s27 offen
    s_add_u32 s27, s26, 1050624
    buffer_load_dwordx4 v[172:175], v2, s[12:15], s27 offen
    s_add_u32 s27, s26, 1105920
    buffer_load_dwordx4 v[176:179], v2, s[12:15], s27 offen
    s_add_u32 s27, s26, 1161216
    buffer_load_dwordx4 v[180:183], v2, s[12:15], s27 offen
    s_add_u32 s27, s26, 1216512
    buffer_load_dwordx4 v[184:187], v2, s[12:15], s27 offen
    s_add_u32 s27, s26, 1271808
    buffer_load_dwordx4 v[188:191], v2, s[12:15], s27 offen
    s_add_u32 s27, s26, 1327104
    buffer_load_dwordx4 v[192:195], v2, s[12:15], s27 offen
    s_add_u32 s27, s26, 1382400
    buffer_load_dwordx4 v[196:199], v2, s[12:15], s27 offen
    s_add_u32 s27, s26, 1437696
    buffer_load_dwordx4 v[200:203], v2, s[12:15], s27 offen
    s_add_u32 s27, s26, 1492992
    buffer_load_dwordx4 v[204:207], v2, s[12:15], s27 offen
    s_add_u32 s27, s26, 1548288
    buffer_load_dwordx4 v[208:211], v2, s[12:15], s27 offen
    s_add_u32 s27, s26, 1603584
    buffer_load_dwordx4 v[212:215], v2, s[12:15], s27 offen
    s_add_u32 s27, s26, 1658880
    buffer_load_dwordx4 v[216:219], v2, s[12:15], s27 offen
    s_add_u32 s27, s26, 1714176
    buffer_load_dwordx4 v[220:223], v2, s[12:15], s27 offen
    s_add_u32 s27, s26, 1769472
    buffer_load_dwordx4 v[224:227], v2, s[12:15], s27 offen
    s_add_u32 s27, s26, 1824768
    buffer_load_dwordx4 v[228:231], v2, s[12:15], s27 offen
    s_add_u32 s27, s26, 1880064
    buffer_load_dwordx4 v[232:235], v2, s[12:15], s27 offen
    s_add_u32 s27, s26, 1935360
    buffer_load_dwordx4 v[236:239], v2, s[12:15], s27 offen
    s_add_u32 s27, s26, 1990656
    buffer_load_dwordx4 v[240:243], v2, s[12:15], s27 offen
    s_add_u32 s27, s26, 2045952
    buffer_load_dwordx4 v[244:247], v2, s[12:15], s27 offen
    s_add_u32 s27, s26, 2101248
    buffer_load_dwordx4 v[248:251], v2, s[12:15], s27 offen
    s_add_u32 s27, s26, 2156544
    buffer_load_dwordx4 v[252:255], v2, s[12:15], s27 offen
    s_mov_b64 exec, -1
    s_lshl_b32 s38, s36, 16
    s_and_b32 s39, s36, 0xffff0000
    s_lshl_b32 s40, s37, 16
    s_and_b32 s41, s37, 0xffff0000
    v_lshlrev_b32 v16, 16, v64
    v_lshlrev_b32 v20, 16, v66
    v_lshlrev_b32 v48, 16, v80
    v_and_b32 v49, 0xffff0000, v80
    v_fmac_f32 v16, s38, v48
    v_fmac_f32 v20, s38, v49
    v_and_b32 v17, 0xffff0000, v64
    v_and_b32 v21, 0xffff0000, v66
    v_lshlrev_b32 v48, 16, v81
    v_and_b32 v49, 0xffff0000, v81
    v_fmac_f32 v17, s39, v48
    v_fmac_f32 v21, s39, v49
    v_lshlrev_b32 v18, 16, v65
    v_lshlrev_b32 v22, 16, v67
    v_lshlrev_b32 v48, 16, v82
    v_and_b32 v49, 0xffff0000, v82
    v_fmac_f32 v18, s40, v48
    v_fmac_f32 v22, s40, v49
    v_and_b32 v19, 0xffff0000, v65
    v_and_b32 v23, 0xffff0000, v67
    v_lshlrev_b32 v48, 16, v83
    v_and_b32 v49, 0xffff0000, v83
    v_fmac_f32 v19, s41, v48
    v_fmac_f32 v23, s41, v49
    v_lshlrev_b32 v24, 16, v68
    v_lshlrev_b32 v28, 16, v70
    v_lshlrev_b32 v48, 16, v84
    v_and_b32 v49, 0xffff0000, v84
    v_fmac_f32 v24, s38, v48
    v_fmac_f32 v28, s38, v49
    v_and_b32 v25, 0xffff0000, v68
    v_and_b32 v29, 0xffff0000, v70
    v_lshlrev_b32 v48, 16, v85
    v_and_b32 v49, 0xffff0000, v85
    v_fmac_f32 v25, s39, v48
    v_fmac_f32 v29, s39, v49
    v_lshlrev_b32 v26, 16, v69
    v_lshlrev_b32 v30, 16, v71
    v_lshlrev_b32 v48, 16, v86
    v_and_b32 v49, 0xffff0000, v86
    v_fmac_f32 v26, s40, v48
    v_fmac_f32 v30, s40, v49
    v_and_b32 v27, 0xffff0000, v69
    v_and_b32 v31, 0xffff0000, v71
    v_lshlrev_b32 v48, 16, v87
    v_and_b32 v49, 0xffff0000, v87
    v_fmac_f32 v27, s41, v48
    v_fmac_f32 v31, s41, v49
    v_lshlrev_b32 v32, 16, v72
    v_lshlrev_b32 v36, 16, v74
    v_lshlrev_b32 v48, 16, v88
    v_and_b32 v49, 0xffff0000, v88
    v_fmac_f32 v32, s38, v48
    v_fmac_f32 v36, s38, v49
    v_and_b32 v33, 0xffff0000, v72
    v_and_b32 v37, 0xffff0000, v74
    v_lshlrev_b32 v48, 16, v89
    v_and_b32 v49, 0xffff0000, v89
    v_fmac_f32 v33, s39, v48
    v_fmac_f32 v37, s39, v49
    v_lshlrev_b32 v34, 16, v73
    v_lshlrev_b32 v38, 16, v75
    v_lshlrev_b32 v48, 16, v90
    v_and_b32 v49, 0xffff0000, v90
    v_fmac_f32 v34, s40, v48
    v_fmac_f32 v38, s40, v49
    v_and_b32 v35, 0xffff0000, v73
    v_and_b32 v39, 0xffff0000, v75
    v_lshlrev_b32 v48, 16, v91
    v_and_b32 v49, 0xffff0000, v91
    v_fmac_f32 v35, s41, v48
    v_fmac_f32 v39, s41, v49
    v_lshlrev_b32 v40, 16, v76
    v_lshlrev_b32 v44, 16, v78
    v_lshlrev_b32 v48, 16, v92
    v_and_b32 v49, 0xffff0000, v92
    v_fmac_f32 v40, s38, v48
    v_fmac_f32 v44, s38, v49
    v_and_b32 v41, 0xffff0000, v76
    v_and_b32 v45, 0xffff0000, v78
    v_lshlrev_b32 v48, 16, v93
    v_and_b32 v49, 0xffff0000, v93
    v_fmac_f32 v41, s39, v48
    v_fmac_f32 v45, s39, v49
    v_lshlrev_b32 v42, 16, v77
    v_lshlrev_b32 v46, 16, v79
    v_lshlrev_b32 v48, 16, v94
    v_and_b32 v49, 0xffff0000, v94
    v_fmac_f32 v42, s40, v48
    v_fmac_f32 v46, s40, v49
    v_and_b32 v43, 0xffff0000, v77
    v_and_b32 v47, 0xffff0000, v79
    v_lshlrev_b32 v48, 16, v95
    v_and_b32 v49, 0xffff0000, v95
    v_fmac_f32 v43, s41, v48
    v_fmac_f32 v47, s41, v49
    v_mov_b32 v64, v16
    v_mov_b32 v65, v17
    v_mov_b32 v66, v18
    v_mov_b32 v67, v19
    v_mov_b32 v68, v20
    v_mov_b32 v69, v21
    v_mov_b32 v70, v22
    v_mov_b32 v71, v23
    v_mov_b32 v72, v24
    v_mov_b32 v73, v25
    v_mov_b32 v74, v26
    v_mov_b32 v75, v27
    v_mov_b32 v76, v28
    v_mov_b32 v77, v29
    v_mov_b32 v78, v30
    v_mov_b32 v79, v31
    v_mov_b32 v80, v32
    v_mov_b32 v81, v33
    v_mov_b32 v82, v34
    v_mov_b32 v83, v35
    v_mov_b32 v84, v36
    v_mov_b32 v85, v37
    v_mov_b32 v86, v38
    v_mov_b32 v87, v39
    v_mov_b32 v88, v40
    v_mov_b32 v89, v41
    v_mov_b32 v90, v42
    v_mov_b32 v91, v43
    v_mov_b32 v92, v44
    v_mov_b32 v93, v45
    v_mov_b32 v94, v46
    v_mov_b32 v95, v47
    v_mov_b32 v12, 161948
    s_mov_b32 s101, 0
LW_10:
    s_add_u32 s101, s101, 1
    s_cmp_gt_u32 s101, 4000000
    s_cbranch_scc1 LWX_11
    ds_read_b32 v13, v12
    s_waitcnt lgkmcnt(0)
    v_readfirstlane_b32 s34, v13
    s_nop 0
    s_cmp_ge_u32 s34, 1
    s_cbranch_scc1 LWX_11
    s_branch LW_10
LWX_11:
    s_barrier
    v_subrev_u32 v10, 512, v10
    ds_read_b32 v32, v10 offset:0
    ds_read_b32 v33, v10 offset:4608
    ds_read_b32 v34, v10 offset:9216
    ds_read_b32 v35, v10 offset:13824
    ds_read_b32 v36, v10 offset:256
    ds_read_b32 v37, v10 offset:4864
    ds_read_b32 v38, v10 offset:9472
    ds_read_b32 v39, v10 offset:14080
    ds_read_b32 v40, v10 offset:512
    ds_read_b32 v41, v10 offset:5120
    ds_read_b32 v42, v10 offset:9728
    ds_read_b32 v43, v10 offset:14336
    ds_read_b32 v44, v10 offset:768
    ds_read_b32 v45, v10 offset:5376
    ds_read_b32 v46, v10 offset:9984
    ds_read_b32 v47, v10 offset:14592
    s_lshl_b32 s27, s48, 14
    s_add_u32 s27, s27, 0x40000
    v_lshlrev_b32 v11, 4, v8
    s_waitcnt lgkmcnt(12)
    v_lshlrev_b32 v16, 16, v32
    v_and_b32 v20, 0xffff0000, v32
    v_lshlrev_b32 v17, 16, v33
    v_and_b32 v21, 0xffff0000, v33
    v_lshlrev_b32 v18, 16, v34
    v_and_b32 v22, 0xffff0000, v34
    v_lshlrev_b32 v19, 16, v35
    v_and_b32 v23, 0xffff0000, v35
    v_pk_add_f32 v[16:17], v[16:17], v[64:65]
    v_pk_add_f32 v[18:19], v[18:19], v[66:67]
    v_pk_add_f32 v[20:21], v[20:21], v[68:69]
    v_pk_add_f32 v[22:23], v[22:23], v[70:71]
    v_cvt_pk_bf16_f32 v48, v16, v17
    v_cvt_pk_bf16_f32 v49, v18, v19
    v_cvt_pk_bf16_f32 v50, v20, v21
    v_cvt_pk_bf16_f32 v51, v22, v23
    s_add_u32 s28, s27, 0
    buffer_store_dwordx4 v[48:51], v11, s[8:11], s28 offen sc1
    s_waitcnt lgkmcnt(8)
    v_lshlrev_b32 v16, 16, v36
    v_and_b32 v20, 0xffff0000, v36
    v_lshlrev_b32 v17, 16, v37
    v_and_b32 v21, 0xffff0000, v37
    v_lshlrev_b32 v18, 16, v38
    v_and_b32 v22, 0xffff0000, v38
    v_lshlrev_b32 v19, 16, v39
    v_and_b32 v23, 0xffff0000, v39
    v_pk_add_f32 v[16:17], v[16:17], v[72:73]
    v_pk_add_f32 v[18:19], v[18:19], v[74:75]
    v_pk_add_f32 v[20:21], v[20:21], v[76:77]
    v_pk_add_f32 v[22:23], v[22:23], v[78:79]
    v_cvt_pk_bf16_f32 v52, v16, v17
    v_cvt_pk_bf16_f32 v53, v18, v19
    v_cvt_pk_bf16_f32 v54, v20, v21
    v_cvt_pk_bf16_f32 v55, v22, v23
    s_add_u32 s28, s27, 1024
    buffer_store_dwordx4 v[52:55], v11, s[8:11], s28 offen sc1
    s_waitcnt lgkmcnt(4)
    v_lshlrev_b32 v16, 16, v40
    v_and_b32 v20, 0xffff0000, v40
    v_lshlrev_b32 v17, 16, v41
    v_and_b32 v21, 0xffff0000, v41
    v_lshlrev_b32 v18, 16, v42
    v_and_b32 v22, 0xffff0000, v42
    v_lshlrev_b32 v19, 16, v43
    v_and_b32 v23, 0xffff0000, v43
    v_pk_add_f32 v[16:17], v[16:17], v[80:81]
    v_pk_add_f32 v[18:19], v[18:19], v[82:83]
    v_pk_add_f32 v[20:21], v[20:21], v[84:85]
    v_pk_add_f32 v[22:23], v[22:23], v[86:87]
    v_cvt_pk_bf16_f32 v56, v16, v17
    v_cvt_pk_bf16_f32 v57, v18, v19
    v_cvt_pk_bf16_f32 v58, v20, v21
    v_cvt_pk_bf16_f32 v59, v22, v23
    s_add_u32 s28, s27, 2048
    buffer_store_dwordx4 v[56:59], v11, s[8:11], s28 offen sc1
    s_waitcnt lgkmcnt(0)
    v_lshlrev_b32 v16, 16, v44
    v_and_b32 v20, 0xffff0000, v44
    v_lshlrev_b32 v17, 16, v45
    v_and_b32 v21, 0xffff0000, v45
    v_lshlrev_b32 v18, 16, v46
    v_and_b32 v22, 0xffff0000, v46
    v_lshlrev_b32 v19, 16, v47
    v_and_b32 v23, 0xffff0000, v47
    v_pk_add_f32 v[16:17], v[16:17], v[88:89]
    v_pk_add_f32 v[18:19], v[18:19], v[90:91]
    v_pk_add_f32 v[20:21], v[20:21], v[92:93]
    v_pk_add_f32 v[22:23], v[22:23], v[94:95]
    v_cvt_pk_bf16_f32 v60, v16, v17
    v_cvt_pk_bf16_f32 v61, v18, v19
    v_cvt_pk_bf16_f32 v62, v20, v21
    v_cvt_pk_bf16_f32 v63, v22, v23
    s_add_u32 s28, s27, 3072
    buffer_store_dwordx4 v[60:63], v11, s[8:11], s28 offen sc1
    v_mbcnt_lo_u32_b32 v1, -1, 0
    v_mbcnt_hi_u32_b32 v1, -1, v1
    s_mul_i32 s26, s24, 896
    v_lshlrev_b32 v3, 4, v1
    v_add_u32 v3, s26, v3
    v_add_u32 v4, 0x10000, v3
    v_add_u32 v5, 0x20000, v3
    s_mov_b32 exec_lo, -1
    s_mov_b32 exec_hi, 0x00ffffff
    s_waitcnt vmcnt(39)
    ds_write_b128 v3, v[96:99] offset:0
    s_waitcnt vmcnt(38)
    ds_write_b128 v3, v[100:103] offset:3584
    s_waitcnt vmcnt(37)
    ds_write_b128 v3, v[104:107] offset:7168
    s_waitcnt vmcnt(36)
    ds_write_b128 v3, v[108:111] offset:10752
    s_waitcnt vmcnt(35)
    ds_write_b128 v3, v[112:115] offset:14336
    s_waitcnt vmcnt(34)
    ds_write_b128 v3, v[116:119] offset:17920
    s_waitcnt vmcnt(33)
    ds_write_b128 v3, v[120:123] offset:21504
    s_waitcnt vmcnt(32)
    ds_write_b128 v3, v[124:127] offset:25088
    s_waitcnt vmcnt(31)
    ds_write_b128 v3, v[128:131] offset:28672
    s_waitcnt vmcnt(30)
    ds_write_b128 v3, v[132:135] offset:32256
    s_waitcnt vmcnt(29)
    ds_write_b128 v3, v[136:139] offset:35840
    s_waitcnt vmcnt(28)
    ds_write_b128 v3, v[140:143] offset:39424
    s_waitcnt vmcnt(27)
    ds_write_b128 v3, v[144:147] offset:43008
    s_waitcnt vmcnt(26)
    ds_write_b128 v3, v[148:151] offset:46592
    s_waitcnt vmcnt(25)
    ds_write_b128 v3, v[152:155] offset:50176
    s_waitcnt vmcnt(24)
    ds_write_b128 v3, v[156:159] offset:53760
    s_waitcnt vmcnt(23)
    ds_write_b128 v3, v[160:163] offset:57344
    s_waitcnt vmcnt(22)
    ds_write_b128 v3, v[164:167] offset:60928
    s_waitcnt vmcnt(21)
    ds_write_b128 v3, v[168:171] offset:64512
    s_waitcnt vmcnt(20)
    ds_write_b128 v4, v[172:175] offset:2560
    s_waitcnt vmcnt(19)
    ds_write_b128 v4, v[176:179] offset:6144
    s_waitcnt vmcnt(18)
    ds_write_b128 v4, v[180:183] offset:9728
    s_waitcnt vmcnt(17)
    ds_write_b128 v4, v[184:187] offset:13312
    s_waitcnt vmcnt(16)
    ds_write_b128 v4, v[188:191] offset:16896
    s_waitcnt vmcnt(15)
    ds_write_b128 v4, v[192:195] offset:20480
    s_waitcnt vmcnt(14)
    ds_write_b128 v4, v[196:199] offset:24064
    s_waitcnt vmcnt(13)
    ds_write_b128 v4, v[200:203] offset:27648
    s_waitcnt vmcnt(12)
    ds_write_b128 v4, v[204:207] offset:31232
    s_waitcnt vmcnt(11)
    ds_write_b128 v4, v[208:211] offset:34816
    s_waitcnt vmcnt(10)
    ds_write_b128 v4, v[212:215] offset:38400
    s_waitcnt vmcnt(9)
    ds_write_b128 v4, v[216:219] offset:41984
    s_waitcnt vmcnt(8)
    ds_write_b128 v4, v[220:223] offset:45568
    s_waitcnt vmcnt(7)
    ds_write_b128 v4, v[224:227] offset:49152
    s_waitcnt vmcnt(6)
    ds_write_b128 v4, v[228:231] offset:52736
    s_waitcnt vmcnt(5)
    ds_write_b128 v4, v[232:235] offset:56320
    s_waitcnt vmcnt(4)
    ds_write_b128 v4, v[236:239] offset:59904
    s_waitcnt vmcnt(3)
    ds_write_b128 v4, v[240:243] offset:63488
    s_waitcnt vmcnt(2)
    ds_write_b128 v5, v[244:247] offset:1536
    s_waitcnt vmcnt(1)
    ds_write_b128 v5, v[248:251] offset:5120
    s_waitcnt vmcnt(0)
    ds_write_b128 v5, v[252:255] offset:8704
    s_mov_b64 exec, -1
    s_waitcnt lgkmcnt(0)
    v_lshrrev_b32 v2, 2, v1
    v_lshlrev_b32 v2, 4, v2
    v_and_b32 v4, 3, v1
    v_add_u32 v2, v2, v4
    s_lshl_b32 s26, s24, 2
    v_add_u32 v2, s26, v2
    v_mul_u32_u24 v2, 224, v2
    v_add_u32 v2, 216, v2
    v_mov_b32 v4, 0x3f803f80
    v_mov_b32 v5, 0x3f803f80
    ds_write_b64 v2, v[4:5]
    ds_write_b64 v2, v[4:5] offset:57344
    v_add_u32 v2, 114688, v2
    s_mov_b64 exec, 0xffffffff
    ds_write_b64 v2, v[4:5]
    s_mov_b64 exec, -1
    s_waitcnt lgkmcnt(0)
    v_mov_b32 v8, 161920
    v_mov_b32 v9, 1
    s_mov_b64 exec, 1
    ds_add_u32 v8, v9
    s_mov_b64 exec, -1
    s_branch L_G1B
NONCONV:
    s_cmp_lg_u32 s48, 95
    s_cbranch_scc1 NP_12
    s_cmp_lg_u32 s3, 7
    s_cbranch_scc1 NP_12
    s_memrealtime s[34:35]
    v_mov_b32 v36, 0
    s_waitcnt lgkmcnt(0)
    s_or_b32 s49, s34, 0x80000000
    v_mov_b32 v37, s49
    s_mov_b64 exec, 1
    buffer_store_dword v37, v36, s[60:63], 0 offen sc1
    s_mov_b64 exec, -1
NP_12:
    s_cmp_ge_u32 s48, 64
    s_cbranch_scc1 NC_CS
    v_lshrrev_b32 v8, 4, v1
    v_and_b32 v9, 15, v1
    v_mul_u32_u24 v10, 1280, v8
    v_lshl_add_u32 v10, v9, 4, v10
    s_lshl_b32 s25, s48, 5
    s_lshl_b32 s26, s3, 2
    s_add_u32 s25, s25, s26
    s_mul_i32 s26, s25, 1280
    s_mov_b32 s12, s64
    s_mov_b32 s13, s65
    s_mov_b32 s14, 0x280000
    s_mov_b32 s15, 0x20000
    buffer_load_dwordx4 v[12:15], v10, s[12:15], s26 offen offset:0
    buffer_load_dwordx4 v[16:19], v10, s[12:15], s26 offen offset:256
    buffer_load_dwordx4 v[20:23], v10, s[12:15], s26 offen offset:512
    buffer_load_dwordx4 v[24:27], v10, s[12:15], s26 offen offset:768
    buffer_load_dwordx4 v[28:31], v10, s[12:15], s26 offen offset:1024
    v_mov_b32 v34, 0
    buffer_load_dword v35, v34, s[60:63], 0 offen sc1
    s_waitcnt vmcnt(0)
    v_lshlrev_b32 v40, 16, v12
    v_and_b32 v41, 0xffff0000, v12
    v_lshlrev_b32 v42, 16, v13
    v_and_b32 v43, 0xffff0000, v13
    v_lshlrev_b32 v44, 16, v14
    v_and_b32 v45, 0xffff0000, v14
    v_lshlrev_b32 v46, 16, v15
    v_and_b32 v47, 0xffff0000, v15
    v_lshlrev_b32 v48, 16, v16
    v_and_b32 v49, 0xffff0000, v16
    v_lshlrev_b32 v50, 16, v17
    v_and_b32 v51, 0xffff0000, v17
    v_lshlrev_b32 v52, 16, v18
    v_and_b32 v53, 0xffff0000, v18
    v_lshlrev_b32 v54, 16, v19
    v_and_b32 v55, 0xffff0000, v19
    v_lshlrev_b32 v56, 16, v20
    v_and_b32 v57, 0xffff0000, v20
    v_lshlrev_b32 v58, 16, v21
    v_and_b32 v59, 0xffff0000, v21
    v_lshlrev_b32 v60, 16, v22
    v_and_b32 v61, 0xffff0000, v22
    v_lshlrev_b32 v62, 16, v23
    v_and_b32 v63, 0xffff0000, v23
    v_lshlrev_b32 v64, 16, v24
    v_and_b32 v65, 0xffff0000, v24
    v_lshlrev_b32 v66, 16, v25
    v_and_b32 v67, 0xffff0000, v25
    v_lshlrev_b32 v68, 16, v26
    v_and_b32 v69, 0xffff0000, v26
    v_lshlrev_b32 v70, 16, v27
    v_and_b32 v71, 0xffff0000, v27
    v_lshlrev_b32 v72, 16, v28
    v_and_b32 v73, 0xffff0000, v28
    v_lshlrev_b32 v74, 16, v29
    v_and_b32 v75, 0xffff0000, v29
    v_lshlrev_b32 v76, 16, v30
    v_and_b32 v77, 0xffff0000, v30
    v_lshlrev_b32 v78, 16, v31
    v_and_b32 v79, 0xffff0000, v31
    v_pk_add_f32 v[12:13], v[40:41], v[42:43]
    v_pk_add_f32 v[12:13], v[12:13], v[44:45]
    v_pk_add_f32 v[12:13], v[12:13], v[46:47]
    v_pk_add_f32 v[12:13], v[12:13], v[48:49]
    v_pk_add_f32 v[12:13], v[12:13], v[50:51]
    v_pk_add_f32 v[12:13], v[12:13], v[52:53]
    v_pk_add_f32 v[12:13], v[12:13], v[54:55]
    v_pk_add_f32 v[12:13], v[12:13], v[56:57]
    v_pk_add_f32 v[12:13], v[12:13], v[58:59]
    v_pk_add_f32 v[12:13], v[12:13], v[60:61]
    v_pk_add_f32 v[12:13], v[12:13], v[62:63]
    v_pk_add_f32 v[12:13], v[12:13], v[64:65]
    v_pk_add_f32 v[12:13], v[12:13], v[66:67]
    v_pk_add_f32 v[12:13], v[12:13], v[68:69]
    v_pk_add_f32 v[12:13], v[12:13], v[70:71]
    v_pk_add_f32 v[12:13], v[12:13], v[72:73]
    v_pk_add_f32 v[12:13], v[12:13], v[74:75]
    v_pk_add_f32 v[12:13], v[12:13], v[76:77]
    v_pk_add_f32 v[12:13], v[12:13], v[78:79]
    v_add_f32 v12, v12, v13
    s_nop 1
    v_add_f32_dpp v12, v12, v12 row_ror:8 row_mask:0xf bank_mask:0xf
    s_nop 1
    v_add_f32_dpp v12, v12, v12 row_ror:4 row_mask:0xf bank_mask:0xf
    s_nop 1
    v_add_f32_dpp v12, v12, v12 row_ror:2 row_mask:0xf bank_mask:0xf
    s_nop 1
    v_add_f32_dpp v12, v12, v12 row_ror:1 row_mask:0xf bank_mask:0xf
    v_mul_f32 v12, 0x3acccccd, v12
    v_mov_b32 v13, v12
    v_pk_add_f32 v[40:41], v[40:41], v[12:13] neg_lo:[0,1] neg_hi:[0,1]
    v_pk_add_f32 v[42:43], v[42:43], v[12:13] neg_lo:[0,1] neg_hi:[0,1]
    v_pk_add_f32 v[44:45], v[44:45], v[12:13] neg_lo:[0,1] neg_hi:[0,1]
    v_pk_add_f32 v[46:47], v[46:47], v[12:13] neg_lo:[0,1] neg_hi:[0,1]
    v_pk_add_f32 v[48:49], v[48:49], v[12:13] neg_lo:[0,1] neg_hi:[0,1]
    v_pk_add_f32 v[50:51], v[50:51], v[12:13] neg_lo:[0,1] neg_hi:[0,1]
    v_pk_add_f32 v[52:53], v[52:53], v[12:13] neg_lo:[0,1] neg_hi:[0,1]
    v_pk_add_f32 v[54:55], v[54:55], v[12:13] neg_lo:[0,1] neg_hi:[0,1]
    v_pk_add_f32 v[56:57], v[56:57], v[12:13] neg_lo:[0,1] neg_hi:[0,1]
    v_pk_add_f32 v[58:59], v[58:59], v[12:13] neg_lo:[0,1] neg_hi:[0,1]
    v_pk_add_f32 v[60:61], v[60:61], v[12:13] neg_lo:[0,1] neg_hi:[0,1]
    v_pk_add_f32 v[62:63], v[62:63], v[12:13] neg_lo:[0,1] neg_hi:[0,1]
    v_pk_add_f32 v[64:65], v[64:65], v[12:13] neg_lo:[0,1] neg_hi:[0,1]
    v_pk_add_f32 v[66:67], v[66:67], v[12:13] neg_lo:[0,1] neg_hi:[0,1]
    v_pk_add_f32 v[68:69], v[68:69], v[12:13] neg_lo:[0,1] neg_hi:[0,1]
    v_pk_add_f32 v[70:71], v[70:71], v[12:13] neg_lo:[0,1] neg_hi:[0,1]
    v_pk_add_f32 v[72:73], v[72:73], v[12:13] neg_lo:[0,1] neg_hi:[0,1]
    v_pk_add_f32 v[74:75], v[74:75], v[12:13] neg_lo:[0,1] neg_hi:[0,1]
    v_pk_add_f32 v[76:77], v[76:77], v[12:13] neg_lo:[0,1] neg_hi:[0,1]
    v_pk_add_f32 v[78:79], v[78:79], v[12:13] neg_lo:[0,1] neg_hi:[0,1]
    v_pk_mul_f32 v[14:15], v[40:41], v[40:41]
    v_pk_fma_f32 v[14:15], v[42:43], v[42:43], v[14:15]
    v_pk_fma_f32 v[14:15], v[44:45], v[44:45], v[14:15]
    v_pk_fma_f32 v[14:15], v[46:47], v[46:47], v[14:15]
    v_pk_fma_f32 v[14:15], v[48:49], v[48:49], v[14:15]
    v_pk_fma_f32 v[14:15], v[50:51], v[50:51], v[14:15]
    v_pk_fma_f32 v[14:15], v[52:53], v[52:53], v[14:15]
    v_pk_fma_f32 v[14:15], v[54:55], v[54:55], v[14:15]
    v_pk_fma_f32 v[14:15], v[56:57], v[56:57], v[14:15]
    v_pk_fma_f32 v[14:15], v[58:59], v[58:59], v[14:15]
    v_pk_fma_f32 v[14:15], v[60:61], v[60:61], v[14:15]
    v_pk_fma_f32 v[14:15], v[62:63], v[62:63], v[14:15]
    v_pk_fma_f32 v[14:15], v[64:65], v[64:65], v[14:15]
    v_pk_fma_f32 v[14:15], v[66:67], v[66:67], v[14:15]
    v_pk_fma_f32 v[14:15], v[68:69], v[68:69], v[14:15]
    v_pk_fma_f32 v[14:15], v[70:71], v[70:71], v[14:15]
    v_pk_fma_f32 v[14:15], v[72:73], v[72:73], v[14:15]
    v_pk_fma_f32 v[14:15], v[74:75], v[74:75], v[14:15]
    v_pk_fma_f32 v[14:15], v[76:77], v[76:77], v[14:15]
    v_pk_fma_f32 v[14:15], v[78:79], v[78:79], v[14:15]
    v_add_f32 v14, v14, v15
    s_nop 1
    v_add_f32_dpp v14, v14, v14 row_ror:8 row_mask:0xf bank_mask:0xf
    s_nop 1
    v_add_f32_dpp v14, v14, v14 row_ror:4 row_mask:0xf bank_mask:0xf
    s_nop 1
    v_add_f32_dpp v14, v14, v14 row_ror:2 row_mask:0xf bank_mask:0xf
    s_nop 1
    v_add_f32_dpp v14, v14, v14 row_ror:1 row_mask:0xf bank_mask:0xf
    v_mov_b32 v13, 0x3727c5ac
    v_fmac_f32 v13, 0x3acccccd, v14
    v_rsq_f32 v13, v13
    v_readfirstlane_b32 s49, v35
    s_nop 0
    s_cmp_lg_u32 s49, 0
    s_cbranch_scc1 NOK_13
    v_mov_b32 v16, 0
    s_mov_b32 s101, 0
NONCE_14:
    s_add_u32 s101, s101, 1
    s_cmp_gt_u32 s101, 200000
    s_cbranch_scc1 NONCEX_15
    buffer_load_dword v17, v16, s[60:63], 0 offen sc1
    s_waitcnt vmcnt(0)
    v_readfirstlane_b32 s49, v17
    s_nop 0
    s_cmp_eq_u32 s49, 0
    s_cbranch_scc1 NONCE_14
NONCEX_15:
NOK_13:
    v_mov_b32 v14, v13
    v_mov_b32 v13, s49
    v_mov_b32 v15, s49
    v_lshlrev_b32 v8, 4, v8
    s_lshl_b32 s26, s25, 4
    s_add_u32 s26, s26, 0x0
    s_mov_b32 exec_lo, 0x00010001
    s_mov_b32 exec_hi, 0x00010001
    buffer_store_dwordx4 v[12:15], v8, s[8:11], s26 offen sc1
    s_mov_b64 exec, -1
    v_mbcnt_lo_u32_b32 v8, -1, 0
    v_mbcnt_hi_u32_b32 v8, -1, v8
    v_lshlrev_b32 v8, 4, v8
    v_mov_b32 v12, -1
    v_mov_b32 v13, -1
    v_mov_b32 v14, -1
    v_mov_b32 v15, -1
    s_lshl_b32 s25, s48, 3
    s_add_u32 s25, s25, s3
    s_add_u32 s26, s25, 0
    s_lshl_b32 s27, s26, 10
    s_add_u32 s27, s27, 0x40000
    buffer_store_dwordx4 v[12:15], v8, s[8:11], s27 offen sc1
NPF_16:
    s_add_u32 s26, s25, 768
    s_lshl_b32 s27, s26, 10
    s_add_u32 s27, s27, 0x40000
    buffer_store_dwordx4 v[12:15], v8, s[8:11], s27 offen sc1
NPF_17:
    s_add_u32 s26, s25, 1536
    s_lshl_b32 s27, s26, 10
    s_add_u32 s27, s27, 0x40000
    buffer_store_dwordx4 v[12:15], v8, s[8:11], s27 offen sc1
NPF_18:
    s_add_u32 s26, s25, 2304
    s_cmp_ge_u32 s26, 2560
    s_cbranch_scc1 NPF_19
    s_lshl_b32 s27, s26, 10
    s_add_u32 s27, s27, 0x40000
    buffer_store_dwordx4 v[12:15], v8, s[8:11], s27 offen sc1
NPF_19:
    s_waitcnt vmcnt(0)
    s_lshl_b32 s27, s48, 7
    s_add_u32 s27, s27, 0xdd0000
    s_lshl_b32 s34, s3, 2
    s_add_u32 s34, s34, 161792
    v_mov_b32 v16, s34
    v_mov_b32 v17, 1
    ds_write_b32 v16, v17
    v_mov_b32 v16, 161792
    s_waitcnt lgkmcnt(0)
    ds_read_b128 v[18:21], v16 offset:0
    ds_read_b128 v[22:25], v16 offset:16
    s_waitcnt lgkmcnt(0)
    v_cmp_ne_u32 vcc, 1, v18
    v_cmp_ne_u32 s[34:35], 1, v19
    s_nop 0
    s_or_b64 vcc, vcc, s[34:35]
    v_cmp_ne_u32 s[34:35], 1, v20
    s_nop 0
    s_or_b64 vcc, vcc, s[34:35]
    v_cmp_ne_u32 s[34:35], 1, v21
    s_nop 0
    s_or_b64 vcc, vcc, s[34:35]
    v_cmp_ne_u32 s[34:35], 1, v22
    s_nop 0
    s_or_b64 vcc, vcc, s[34:35]
    v_cmp_ne_u32 s[34:35], 1, v23
    s_nop 0
    s_or_b64 vcc, vcc, s[34:35]
    v_cmp_ne_u32 s[34:35], 1, v24
    s_nop 0
    s_or_b64 vcc, vcc, s[34:35]
    v_cmp_ne_u32 s[34:35], 1, v25
    s_nop 0
    s_or_b64 vcc, vcc, s[34:35]
    s_cbranch_vccnz PUB_20
    v_mov_b32 v16, 0
    v_mov_b32 v17, s49
    s_mov_b64 exec, 1
    buffer_store_dword v17, v16, s[8:11], s27 offen sc1
    s_mov_b64 exec, -1
PUB_20:
    v_mbcnt_lo_u32_b32 v1, -1, 0
    v_mbcnt_hi_u32_b32 v1, -1, v1
    s_lshl_b32 s38, s48, 3
    s_add_u32 s38, s38, s3
    s_cmp_lt_u32 s38, 432
    s_cselect_b32 s38, s38, s3
    s_mul_i32 s39, s3, 5120
    v_add_u32 v88, 0, v1
    v_mul_u32_u24 v89, 6554, v88
    v_lshrrev_b32 v89, 16, v89
    v_mul_u32_u24 v90, 10, v89
    v_sub_u32 v90, v88, v90
    v_lshlrev_b32 v90, 4, v90
    v_mul_u32_u24 v89, 1280, v89
    v_add_u32 v90, v90, v89
    v_add_u32 v88, 64, v1
    v_mul_u32_u24 v89, 6554, v88
    v_lshrrev_b32 v89, 16, v89
    v_mul_u32_u24 v91, 10, v89
    v_sub_u32 v91, v88, v91
    v_lshlrev_b32 v91, 4, v91
    v_mul_u32_u24 v89, 1280, v89
    v_add_u32 v91, v91, v89
    v_add_u32 v88, 128, v1
    v_mul_u32_u24 v89, 6554, v88
    v_lshrrev_b32 v89, 16, v89
    v_mul_u32_u24 v92, 10, v89
    v_sub_u32 v92, v88, v92
    v_lshlrev_b32 v92, 4, v92
    v_mul_u32_u24 v89, 1280, v89
    v_add_u32 v92, v92, v89
    v_add_u32 v88, 192, v1
    v_mul_u32_u24 v89, 6554, v88
    v_lshrrev_b32 v89, 16, v89
    v_mul_u32_u24 v93, 10, v89
    v_sub_u32 v93, v88, v93
    v_lshlrev_b32 v93, 4, v93
    v_mul_u32_u24 v89, 1280, v89
    v_add_u32 v93, v93, v89
    v_add_u32 v88, 256, v1
    v_mul_u32_u24 v89, 6554, v88
    v_lshrrev_b32 v89, 16, v89
    v_mul_u32_u24 v94, 10, v89
    v_sub_u32 v94, v88, v94
    v_lshlrev_b32 v94, 4, v94
    v_mul_u32_u24 v89, 1280, v89
    v_add_u32 v94, v94, v89
    s_mov_b32 s16, s88
    s_mov_b32 s17, s89
    s_mov_b32 s18, 0x21c000
    s_mov_b32 s19, 0x20000
    s_lshr_b32 s40, s38, 3
    s_and_b32 s41, s38, 7
    s_mul_i32 s42, s40, 40960
    s_mul_i32 s43, s41, 160
    s_add_u32 s42, s42, s43
    s_add_u32 m0, s39, 0
    s_nop 0
    buffer_load_dwordx4 v90, s[16:19], s42 offen lds
    s_add_u32 m0, s39, 1024
    s_nop 0
    buffer_load_dwordx4 v91, s[16:19], s42 offen lds
    s_add_u32 m0, s39, 2048
    s_nop 0
    buffer_load_dwordx4 v92, s[16:19], s42 offen lds
    s_add_u32 m0, s39, 3072
    s_nop 0
    buffer_load_dwordx4 v93, s[16:19], s42 offen lds
    s_add_u32 m0, s39, 4096
    s_nop 0
    buffer_load_dwordx4 v94, s[16:19], s42 offen lds
    s_mul_i32 s43, s41, 54
    s_add_u32 s43, s43, s40
    s_mul_i32 s43, s43, 5120
    s_add_u32 s42, s43, 0x4f0000
    s_waitcnt vmcnt(0)
    v_and_b32 v8, 15, v1
    v_lshrrev_b32 v9, 4, v1
    v_lshrrev_b32 v15, 2, v8
    v_lshl_add_u32 v15, v9, 2, v15
    v_and_b32 v8, 3, v8
    v_mul_u32_u24 v17, 160, v15
    v_mul_u32_u24 v8, 40, v8
    v_add_u32 v17, v17, v8
    v_add_u32 v17, s39, v17
    v_lshlrev_b32 v5, 4, v1
    ds_read_b64_tr_b16 v[24:25], v17 offset:0
    ds_read_b64_tr_b16 v[26:27], v17 offset:2560
    ds_read_b64_tr_b16 v[28:29], v17 offset:8
    ds_read_b64_tr_b16 v[30:31], v17 offset:2568
    ds_read_b64_tr_b16 v[32:33], v17 offset:16
    ds_read_b64_tr_b16 v[34:35], v17 offset:2576
    ds_read_b64_tr_b16 v[36:37], v17 offset:24
    ds_read_b64_tr_b16 v[38:39], v17 offset:2584
    ds_read_b64_tr_b16 v[40:41], v17 offset:32
    ds_read_b64_tr_b16 v[42:43], v17 offset:2592
    s_waitcnt lgkmcnt(0)
    buffer_store_dwordx4 v[24:27], v5, s[8:11], s42 offen offset:0 sc1
    buffer_store_dwordx4 v[28:31], v5, s[8:11], s42 offen offset:1024 sc1
    buffer_store_dwordx4 v[32:35], v5, s[8:11], s42 offen offset:2048 sc1
    buffer_store_dwordx4 v[36:39], v5, s[8:11], s42 offen offset:3072 sc1
    s_add_u32 s42, s42, 4096
    buffer_store_dwordx4 v[40:43], v5, s[8:11], s42 offen sc1
    s_waitcnt vmcnt(0)
    s_lshl_b32 s27, s48, 6
    s_add_u32 s27, s27, 0x1c000
    s_lshl_b32 s34, s3, 2
    s_add_u32 s34, s34, 161856
    v_mov_b32 v48, s34
    v_mov_b32 v49, 1
    ds_write_b32 v48, v49
    v_mov_b32 v48, 161856
    s_waitcnt lgkmcnt(0)
    ds_read_b128 v[50:53], v48 offset:0
    ds_read_b128 v[54:57], v48 offset:16
    s_waitcnt lgkmcnt(0)
    v_cmp_ne_u32 vcc, 1, v50
    v_cmp_ne_u32 s[34:35], 1, v51
    s_nop 0
    s_or_b64 vcc, vcc, s[34:35]
    v_cmp_ne_u32 s[34:35], 1, v52
    s_nop 0
    s_or_b64 vcc, vcc, s[34:35]
    v_cmp_ne_u32 s[34:35], 1, v53
    s_nop 0
    s_or_b64 vcc, vcc, s[34:35]
    v_cmp_ne_u32 s[34:35], 1, v54
    s_nop 0
    s_or_b64 vcc, vcc, s[34:35]
    v_cmp_ne_u32 s[34:35], 1, v55
    s_nop 0
    s_or_b64 vcc, vcc, s[34:35]
    v_cmp_ne_u32 s[34:35], 1, v56
    s_nop 0
    s_or_b64 vcc, vcc, s[34:35]
    v_cmp_ne_u32 s[34:35], 1, v57
    s_nop 0
    s_or_b64 vcc, vcc, s[34:35]
    s_cbranch_vccnz PUB_21
    v_mov_b32 v48, 0
    v_mov_b32 v49, s49
    s_mov_b64 exec, 1
    buffer_store_dword v49, v48, s[8:11], s27 offen sc1
    s_mov_b64 exec, -1
PUB_21:
    s_branch NC_RDY2
NC_CS:
    v_mov_b32 v16, 0
    s_mov_b32 s101, 0
NONCE_22:
    s_add_u32 s101, s101, 1
    s_cmp_gt_u32 s101, 200000
    s_cbranch_scc1 NONCEX_23
    buffer_load_dword v17, v16, s[60:63], 0 offen sc1
    s_waitcnt vmcnt(0)
    v_readfirstlane_b32 s49, v17
    s_nop 0
    s_cmp_eq_u32 s49, 0
    s_cbranch_scc1 NONCE_22
NONCEX_23:
    v_mbcnt_lo_u32_b32 v8, -1, 0
    v_mbcnt_hi_u32_b32 v8, -1, v8
    v_lshlrev_b32 v8, 4, v8
    v_mov_b32 v12, -1
    v_mov_b32 v13, -1
    v_mov_b32 v14, -1
    v_mov_b32 v15, -1
    s_lshl_b32 s25, s48, 3
    s_add_u32 s25, s25, s3
    s_add_u32 s26, s25, 0
    s_lshl_b32 s27, s26, 10
    s_add_u32 s27, s27, 0x40000
    buffer_store_dwordx4 v[12:15], v8, s[8:11], s27 offen sc1
NPF_24:
    s_add_u32 s26, s25, 768
    s_lshl_b32 s27, s26, 10
    s_add_u32 s27, s27, 0x40000
    buffer_store_dwordx4 v[12:15], v8, s[8:11], s27 offen sc1
NPF_25:
    s_add_u32 s26, s25, 1536
    s_lshl_b32 s27, s26, 10
    s_add_u32 s27, s27, 0x40000
    buffer_store_dwordx4 v[12:15], v8, s[8:11], s27 offen sc1
NPF_26:
    s_add_u32 s26, s25, 2304
    s_cmp_ge_u32 s26, 2560
    s_cbranch_scc1 NPF_27
    s_lshl_b32 s27, s26, 10
    s_add_u32 s27, s27, 0x40000
    buffer_store_dwordx4 v[12:15], v8, s[8:11], s27 offen sc1
NPF_27:
    s_waitcnt vmcnt(0)
    s_lshl_b32 s27, s48, 7
    s_add_u32 s27, s27, 0xdd0000
    s_lshl_b32 s34, s3, 2
    s_add_u32 s34, s34, 161792
    v_mov_b32 v16, s34
    v_mov_b32 v17, 1
    ds_write_b32 v16, v17
    v_mov_b32 v16, 161792
    s_waitcnt lgkmcnt(0)
    ds_read_b128 v[18:21], v16 offset:0
    ds_read_b128 v[22:25], v16 offset:16
    s_waitcnt lgkmcnt(0)
    v_cmp_ne_u32 vcc, 1, v18
    v_cmp_ne_u32 s[34:35], 1, v19
    s_nop 0
    s_or_b64 vcc, vcc, s[34:35]
    v_cmp_ne_u32 s[34:35], 1, v20
    s_nop 0
    s_or_b64 vcc, vcc, s[34:35]
    v_cmp_ne_u32 s[34:35], 1, v21
    s_nop 0
    s_or_b64 vcc, vcc, s[34:35]
    v_cmp_ne_u32 s[34:35], 1, v22
    s_nop 0
    s_or_b64 vcc, vcc, s[34:35]
    v_cmp_ne_u32 s[34:35], 1, v23
    s_nop 0
    s_or_b64 vcc, vcc, s[34:35]
    v_cmp_ne_u32 s[34:35], 1, v24
    s_nop 0
    s_or_b64 vcc, vcc, s[34:35]
    v_cmp_ne_u32 s[34:35], 1, v25
    s_nop 0
    s_or_b64 vcc, vcc, s[34:35]
    s_cbranch_vccnz PUB_28
    v_mov_b32 v16, 0
    v_mov_b32 v17, s49
    s_mov_b64 exec, 1
    buffer_store_dword v17, v16, s[8:11], s27 offen sc1
    s_mov_b64 exec, -1
PUB_28:
    s_cmp_lg_u32 s48, 95
    s_cbranch_scc1 NA_29
    s_cmp_lg_u32 s3, 3
    s_cbranch_scc1 NA_29
    v_mbcnt_lo_u32_b32 v10, -1, 0
    v_mbcnt_hi_u32_b32 v10, -1, v10
    v_lshlrev_b32 v8, 7, v10
    v_and_b32 v9, 31, v10
    v_lshlrev_b32 v9, 7, v9
    v_add_u32 v9, 8192, v9
    s_mov_b32 s27, 0xdd0000
    s_mov_b32 s101, 0
POLL_30:
    s_add_u32 s101, s101, 1
    s_cmp_gt_u32 s101, 200000
    s_cbranch_scc1 POLLX_31
    buffer_load_dword v12, v8, s[8:11], s27 offen sc1
    buffer_load_dword v13, v9, s[8:11], s27 offen sc1
    s_waitcnt vmcnt(0)
    v_cmp_ne_u32 vcc, s49, v12
    v_cmp_ne_u32 s[34:35], s49, v13
    s_nop 0
    s_or_b64 vcc, vcc, s[34:35]
    s_cbranch_vccnz POLL_30
POLLX_31:
    v_mov_b32 v36, 0
    v_mov_b32 v37, s49
    s_mov_b32 s27, 0x28000
    s_mov_b64 exec, 1
    buffer_store_dword v37, v36, s[8:11], s27 offen sc1
    s_mov_b64 exec, -1
NA_29:
    v_mbcnt_lo_u32_b32 v1, -1, 0
    v_mbcnt_hi_u32_b32 v1, -1, v1
    s_sub_u32 s27, s48, 64
    s_cmp_ge_u32 s27, 27
    s_cbranch_scc1 CSD_32
    s_mov_b32 s12, s84
    s_mov_b32 s13, s85
    s_mov_b32 s14, 0x21c000
    s_mov_b32 s15, 0x20000
    s_mul_i32 s28, s3, 276480
    s_lshl_b32 s29, s27, 7
    s_add_u32 s28, s28, s29
    v_lshrrev_b32 v8, 3, v1
    v_mul_u32_u24 v8, 3456, v8
    v_and_b32 v9, 7, v1
    v_lshl_add_u32 v8, v9, 4, v8
    buffer_load_dwordx4 v[64:67], v8, s[12:15], s28 offen
    s_add_u32 s28, s28, 27648
    buffer_load_dwordx4 v[68:71], v8, s[12:15], s28 offen
    s_add_u32 s28, s28, 27648
    buffer_load_dwordx4 v[72:75], v8, s[12:15], s28 offen
    s_add_u32 s28, s28, 27648
    buffer_load_dwordx4 v[76:79], v8, s[12:15], s28 offen
    s_add_u32 s28, s28, 27648
    buffer_load_dwordx4 v[80:83], v8, s[12:15], s28 offen
    s_add_u32 s28, s28, 27648
    buffer_load_dwordx4 v[84:87], v8, s[12:15], s28 offen
    s_add_u32 s28, s28, 27648
    buffer_load_dwordx4 v[88:91], v8, s[12:15], s28 offen
    s_add_u32 s28, s28, 27648
    buffer_load_dwordx4 v[92:95], v8, s[12:15], s28 offen
    s_add_u32 s28, s28, 27648
    buffer_load_dwordx4 v[96:99], v8, s[12:15], s28 offen
    s_add_u32 s28, s28, 27648
    buffer_load_dwordx4 v[100:103], v8, s[12:15], s28 offen
    v_mov_b32 v20, 0
    v_mov_b32 v21, 0
    v_mov_b32 v22, 0
    v_mov_b32 v23, 0
    v_mov_b32 v24, 0
    v_mov_b32 v25, 0
    v_mov_b32 v26, 0
    v_mov_b32 v27, 0
    s_waitcnt vmcnt(9)
    v_lshlrev_b32 v30, 16, v64
    v_and_b32 v31, 0xffff0000, v64
    v_pk_add_f32 v[20:21], v[20:21], v[30:31]
    v_lshlrev_b32 v30, 16, v65
    v_and_b32 v31, 0xffff0000, v65
    v_pk_add_f32 v[22:23], v[22:23], v[30:31]
    v_lshlrev_b32 v30, 16, v66
    v_and_b32 v31, 0xffff0000, v66
    v_pk_add_f32 v[24:25], v[24:25], v[30:31]
    v_lshlrev_b32 v30, 16, v67
    v_and_b32 v31, 0xffff0000, v67
    v_pk_add_f32 v[26:27], v[26:27], v[30:31]
    s_waitcnt vmcnt(8)
    v_lshlrev_b32 v30, 16, v68
    v_and_b32 v31, 0xffff0000, v68
    v_pk_add_f32 v[20:21], v[20:21], v[30:31]
    v_lshlrev_b32 v30, 16, v69
    v_and_b32 v31, 0xffff0000, v69
    v_pk_add_f32 v[22:23], v[22:23], v[30:31]
    v_lshlrev_b32 v30, 16, v70
    v_and_b32 v31, 0xffff0000, v70
    v_pk_add_f32 v[24:25], v[24:25], v[30:31]
    v_lshlrev_b32 v30, 16, v71
    v_and_b32 v31, 0xffff0000, v71
    v_pk_add_f32 v[26:27], v[26:27], v[30:31]
    s_waitcnt vmcnt(7)
    v_lshlrev_b32 v30, 16, v72
    v_and_b32 v31, 0xffff0000, v72
    v_pk_add_f32 v[20:21], v[20:21], v[30:31]
    v_lshlrev_b32 v30, 16, v73
    v_and_b32 v31, 0xffff0000, v73
    v_pk_add_f32 v[22:23], v[22:23], v[30:31]
    v_lshlrev_b32 v30, 16, v74
    v_and_b32 v31, 0xffff0000, v74
    v_pk_add_f32 v[24:25], v[24:25], v[30:31]
    v_lshlrev_b32 v30, 16, v75
    v_and_b32 v31, 0xffff0000, v75
    v_pk_add_f32 v[26:27], v[26:27], v[30:31]
    s_waitcnt vmcnt(6)
    v_lshlrev_b32 v30, 16, v76
    v_and_b32 v31, 0xffff0000, v76
    v_pk_add_f32 v[20:21], v[20:21], v[30:31]
    v_lshlrev_b32 v30, 16, v77
    v_and_b32 v31, 0xffff0000, v77
    v_pk_add_f32 v[22:23], v[22:23], v[30:31]
    v_lshlrev_b32 v30, 16, v78
    v_and_b32 v31, 0xffff0000, v78
    v_pk_add_f32 v[24:25], v[24:25], v[30:31]
    v_lshlrev_b32 v30, 16, v79
    v_and_b32 v31, 0xffff0000, v79
    v_pk_add_f32 v[26:27], v[26:27], v[30:31]
    s_waitcnt vmcnt(5)
    v_lshlrev_b32 v30, 16, v80
    v_and_b32 v31, 0xffff0000, v80
    v_pk_add_f32 v[20:21], v[20:21], v[30:31]
    v_lshlrev_b32 v30, 16, v81
    v_and_b32 v31, 0xffff0000, v81
    v_pk_add_f32 v[22:23], v[22:23], v[30:31]
    v_lshlrev_b32 v30, 16, v82
    v_and_b32 v31, 0xffff0000, v82
    v_pk_add_f32 v[24:25], v[24:25], v[30:31]
    v_lshlrev_b32 v30, 16, v83
    v_and_b32 v31, 0xffff0000, v83
    v_pk_add_f32 v[26:27], v[26:27], v[30:31]
    s_waitcnt vmcnt(4)
    v_lshlrev_b32 v30, 16, v84
    v_and_b32 v31, 0xffff0000, v84
    v_pk_add_f32 v[20:21], v[20:21], v[30:31]
    v_lshlrev_b32 v30, 16, v85
    v_and_b32 v31, 0xffff0000, v85
    v_pk_add_f32 v[22:23], v[22:23], v[30:31]
    v_lshlrev_b32 v30, 16, v86
    v_and_b32 v31, 0xffff0000, v86
    v_pk_add_f32 v[24:25], v[24:25], v[30:31]
    v_lshlrev_b32 v30, 16, v87
    v_and_b32 v31, 0xffff0000, v87
    v_pk_add_f32 v[26:27], v[26:27], v[30:31]
    s_waitcnt vmcnt(3)
    v_lshlrev_b32 v30, 16, v88
    v_and_b32 v31, 0xffff0000, v88
    v_pk_add_f32 v[20:21], v[20:21], v[30:31]
    v_lshlrev_b32 v30, 16, v89
    v_and_b32 v31, 0xffff0000, v89
    v_pk_add_f32 v[22:23], v[22:23], v[30:31]
    v_lshlrev_b32 v30, 16, v90
    v_and_b32 v31, 0xffff0000, v90
    v_pk_add_f32 v[24:25], v[24:25], v[30:31]
    v_lshlrev_b32 v30, 16, v91
    v_and_b32 v31, 0xffff0000, v91
    v_pk_add_f32 v[26:27], v[26:27], v[30:31]
    s_waitcnt vmcnt(2)
    v_lshlrev_b32 v30, 16, v92
    v_and_b32 v31, 0xffff0000, v92
    v_pk_add_f32 v[20:21], v[20:21], v[30:31]
    v_lshlrev_b32 v30, 16, v93
    v_and_b32 v31, 0xffff0000, v93
    v_pk_add_f32 v[22:23], v[22:23], v[30:31]
    v_lshlrev_b32 v30, 16, v94
    v_and_b32 v31, 0xffff0000, v94
    v_pk_add_f32 v[24:25], v[24:25], v[30:31]
    v_lshlrev_b32 v30, 16, v95
    v_and_b32 v31, 0xffff0000, v95
    v_pk_add_f32 v[26:27], v[26:27], v[30:31]
    s_waitcnt vmcnt(1)
    v_lshlrev_b32 v30, 16, v96
    v_and_b32 v31, 0xffff0000, v96
    v_pk_add_f32 v[20:21], v[20:21], v[30:31]
    v_lshlrev_b32 v30, 16, v97
    v_and_b32 v31, 0xffff0000, v97
    v_pk_add_f32 v[22:23], v[22:23], v[30:31]
    v_lshlrev_b32 v30, 16, v98
    v_and_b32 v31, 0xffff0000, v98
    v_pk_add_f32 v[24:25], v[24:25], v[30:31]
    v_lshlrev_b32 v30, 16, v99
    v_and_b32 v31, 0xffff0000, v99
    v_pk_add_f32 v[26:27], v[26:27], v[30:31]
    s_waitcnt vmcnt(0)
    v_lshlrev_b32 v30, 16, v100
    v_and_b32 v31, 0xffff0000, v100
    v_pk_add_f32 v[20:21], v[20:21], v[30:31]
    v_lshlrev_b32 v30, 16, v101
    v_and_b32 v31, 0xffff0000, v101
    v_pk_add_f32 v[22:23], v[22:23], v[30:31]
    v_lshlrev_b32 v30, 16, v102
    v_and_b32 v31, 0xffff0000, v102
    v_pk_add_f32 v[24:25], v[24:25], v[30:31]
    v_lshlrev_b32 v30, 16, v103
    v_and_b32 v31, 0xffff0000, v103
    v_pk_add_f32 v[26:27], v[26:27], v[30:31]
    v_add_f32_dpp v20, v20, v20 row_ror:8 row_mask:0xf bank_mask:0xf
    v_add_f32_dpp v21, v21, v21 row_ror:8 row_mask:0xf bank_mask:0xf
    v_add_f32_dpp v22, v22, v22 row_ror:8 row_mask:0xf bank_mask:0xf
    v_add_f32_dpp v23, v23, v23 row_ror:8 row_mask:0xf bank_mask:0xf
    v_add_f32_dpp v24, v24, v24 row_ror:8 row_mask:0xf bank_mask:0xf
    v_add_f32_dpp v25, v25, v25 row_ror:8 row_mask:0xf bank_mask:0xf
    v_add_f32_dpp v26, v26, v26 row_ror:8 row_mask:0xf bank_mask:0xf
    v_add_f32_dpp v27, v27, v27 row_ror:8 row_mask:0xf bank_mask:0xf
    v_mov_b32 v32, v20
    v_mov_b32 v33, v21
    v_mov_b32 v34, v22
    v_mov_b32 v35, v23
    v_mov_b32 v36, v24
    v_mov_b32 v37, v25
    v_mov_b32 v38, v26
    v_mov_b32 v39, v27
    v_permlane16_swap_b32 v20, v32
    v_permlane16_swap_b32 v21, v33
    v_permlane16_swap_b32 v22, v34
    v_permlane16_swap_b32 v23, v35
    v_permlane16_swap_b32 v24, v36
    v_permlane16_swap_b32 v25, v37
    v_permlane16_swap_b32 v26, v38
    v_permlane16_swap_b32 v27, v39
    v_add_f32 v20, v20, v32
    v_add_f32 v21, v21, v33
    v_add_f32 v22, v22, v34
    v_add_f32 v23, v23, v35
    v_add_f32 v24, v24, v36
    v_add_f32 v25, v25, v37
    v_add_f32 v26, v26, v38
    v_add_f32 v27, v27, v39
    v_mov_b32 v32, v20
    v_mov_b32 v33, v21
    v_mov_b32 v34, v22
    v_mov_b32 v35, v23
    v_mov_b32 v36, v24
    v_mov_b32 v37, v25
    v_mov_b32 v38, v26
    v_mov_b32 v39, v27
    v_permlane32_swap_b32 v20, v32
    v_permlane32_swap_b32 v21, v33
    v_permlane32_swap_b32 v22, v34
    v_permlane32_swap_b32 v23, v35
    v_permlane32_swap_b32 v24, v36
    v_permlane32_swap_b32 v25, v37
    v_permlane32_swap_b32 v26, v38
    v_permlane32_swap_b32 v27, v39
    v_add_f32 v20, v20, v32
    v_add_f32 v21, v21, v33
    v_add_f32 v22, v22, v34
    v_add_f32 v23, v23, v35
    v_add_f32 v24, v24, v36
    v_add_f32 v25, v25, v37
    v_add_f32 v26, v26, v38
    v_add_f32 v27, v27, v39
    s_lshl_b32 s29, s3, 8
    v_lshlrev_b32 v10, 5, v9
    v_add_u32 v10, s29, v10
    s_mov_b64 exec, 0xff
    ds_write_b128 v10, v[20:23]
    ds_write_b128 v10, v[24:27] offset:16
    s_mov_b64 exec, -1
    s_waitcnt lgkmcnt(0)
    v_mov_b32 v12, 161952
    v_mov_b32 v13, 1
    s_mov_b64 exec, 1
    ds_add_u32 v12, v13
    s_mov_b64 exec, -1
    s_cmp_lg_u32 s3, 0
    s_cbranch_scc1 CSD_32
    v_mov_b32 v12, 161952
    s_mov_b32 s101, 0
LW_34:
    s_add_u32 s101, s101, 1
    s_cmp_gt_u32 s101, 4000000
    s_cbranch_scc1 LWX_35
    ds_read_b32 v13, v12
    s_waitcnt lgkmcnt(0)
    v_readfirstlane_b32 s34, v13
    s_nop 0
    s_cmp_ge_u32 s34, 8
    s_cbranch_scc1 LWX_35
    s_branch LW_34
LWX_35:
    v_lshlrev_b32 v10, 2, v1
    ds_read_b32 v20, v10 offset:0
    ds_read_b32 v21, v10 offset:256
    ds_read_b32 v22, v10 offset:512
    ds_read_b32 v23, v10 offset:768
    ds_read_b32 v24, v10 offset:1024
    ds_read_b32 v25, v10 offset:1280
    ds_read_b32 v26, v10 offset:1536
    ds_read_b32 v27, v10 offset:1792
    s_waitcnt lgkmcnt(0)
    v_add_f32 v20, v20, v21
    v_add_f32 v20, v20, v22
    v_add_f32 v20, v20, v23
    v_add_f32 v20, v20, v24
    v_add_f32 v20, v20, v25
    v_add_f32 v20, v20, v26
    v_add_f32 v20, v20, v27
    s_lshl_b32 s28, s27, 8
    s_add_u32 s28, s28, 0x20000
    buffer_store_dword v20, v10, s[8:11], s28 offen sc1
CSD_32:
    v_mov_b32 v16, 0
    s_mov_b32 s101, 0
NONCE_36:
    s_add_u32 s101, s101, 1
    s_cmp_gt_u32 s101, 200000
    s_cbranch_scc1 NONCEX_37
    buffer_load_dword v17, v16, s[60:63], 0 offen sc1
    s_waitcnt vmcnt(0)
    v_readfirstlane_b32 s49, v17
    s_nop 0
    s_cmp_eq_u32 s49, 0
    s_cbranch_scc1 NONCE_36
NONCEX_37:
NC_RDY2:
    s_barrier
    s_cmp_lg_u32 s47, 0
    s_cbranch_scc1 NC_NOACT
    v_mbcnt_lo_u32_b32 v8, -1, 0
    v_mbcnt_hi_u32_b32 v8, -1, v8
    v_lshlrev_b32 v8, 4, v8
    v_mov_b32 v12, -1
    v_mov_b32 v13, -1
    v_mov_b32 v14, -1
    v_mov_b32 v15, -1
    s_lshl_b32 s25, s48, 2
    s_add_u32 s25, s25, s24
    s_add_u32 s26, s25, 0
    s_lshl_b32 s27, s26, 10
    s_add_u32 s27, s27, 0x710000
    buffer_store_dwordx4 v[12:15], v8, s[8:11], s27 offen sc1
NPF_38:
    s_add_u32 s26, s25, 384
    s_lshl_b32 s27, s26, 10
    s_add_u32 s27, s27, 0x710000
    buffer_store_dwordx4 v[12:15], v8, s[8:11], s27 offen sc1
NPF_39:
    s_add_u32 s26, s25, 768
    s_lshl_b32 s27, s26, 10
    s_add_u32 s27, s27, 0x710000
    buffer_store_dwordx4 v[12:15], v8, s[8:11], s27 offen sc1
NPF_40:
    s_add_u32 s26, s25, 1152
    s_lshl_b32 s27, s26, 10
    s_add_u32 s27, s27, 0x710000
    buffer_store_dwordx4 v[12:15], v8, s[8:11], s27 offen sc1
NPF_41:
    s_add_u32 s26, s25, 1536
    s_lshl_b32 s27, s26, 10
    s_add_u32 s27, s27, 0x710000
    buffer_store_dwordx4 v[12:15], v8, s[8:11], s27 offen sc1
NPF_42:
    s_add_u32 s26, s25, 1920
    s_lshl_b32 s27, s26, 10
    s_add_u32 s27, s27, 0x710000
    buffer_store_dwordx4 v[12:15], v8, s[8:11], s27 offen sc1
NPF_43:
    s_add_u32 s26, s25, 2304
    s_lshl_b32 s27, s26, 10
    s_add_u32 s27, s27, 0x710000
    buffer_store_dwordx4 v[12:15], v8, s[8:11], s27 offen sc1
NPF_44:
    s_add_u32 s26, s25, 2688
    s_lshl_b32 s27, s26, 10
    s_add_u32 s27, s27, 0x710000
    buffer_store_dwordx4 v[12:15], v8, s[8:11], s27 offen sc1
NPF_45:
    s_add_u32 s26, s25, 3072
    s_lshl_b32 s27, s26, 10
    s_add_u32 s27, s27, 0x710000
    buffer_store_dwordx4 v[12:15], v8, s[8:11], s27 offen sc1
NPF_46:
    s_add_u32 s26, s25, 3456
    s_lshl_b32 s27, s26, 10
    s_add_u32 s27, s27, 0x710000
    buffer_store_dwordx4 v[12:15], v8, s[8:11], s27 offen sc1
NPF_47:
    s_add_u32 s26, s25, 3840
    s_lshl_b32 s27, s26, 10
    s_add_u32 s27, s27, 0x710000
    buffer_store_dwordx4 v[12:15], v8, s[8:11], s27 offen sc1
NPF_48:
    s_add_u32 s26, s25, 4224
    s_lshl_b32 s27, s26, 10
    s_add_u32 s27, s27, 0x710000
    buffer_store_dwordx4 v[12:15], v8, s[8:11], s27 offen sc1
NPF_49:
    s_add_u32 s26, s25, 4608
    s_lshl_b32 s27, s26, 10
    s_add_u32 s27, s27, 0x710000
    buffer_store_dwordx4 v[12:15], v8, s[8:11], s27 offen sc1
NPF_50:
    s_add_u32 s26, s25, 4992
    s_lshl_b32 s27, s26, 10
    s_add_u32 s27, s27, 0x710000
    buffer_store_dwordx4 v[12:15], v8, s[8:11], s27 offen sc1
NPF_51:
    s_add_u32 s26, s25, 5376
    s_lshl_b32 s27, s26, 10
    s_add_u32 s27, s27, 0x710000
    buffer_store_dwordx4 v[12:15], v8, s[8:11], s27 offen sc1
NPF_52:
    s_add_u32 s26, s25, 5760
    s_lshl_b32 s27, s26, 10
    s_add_u32 s27, s27, 0x710000
    buffer_store_dwordx4 v[12:15], v8, s[8:11], s27 offen sc1
NPF_53:
    s_add_u32 s26, s25, 6144
    s_lshl_b32 s27, s26, 10
    s_add_u32 s27, s27, 0x710000
    buffer_store_dwordx4 v[12:15], v8, s[8:11], s27 offen sc1
NPF_54:
    s_add_u32 s26, s25, 6528
    s_lshl_b32 s27, s26, 10
    s_add_u32 s27, s27, 0x710000
    buffer_store_dwordx4 v[12:15], v8, s[8:11], s27 offen sc1
NPF_55:
NC_NOACT:
    s_waitcnt vmcnt(0)
    s_add_u32 s27, s48, 160
    s_lshl_b32 s27, s27, 7
    s_add_u32 s27, s27, 0x30000
    s_lshl_b32 s34, s3, 2
    s_add_u32 s34, s34, 161824
    v_mov_b32 v20, s34
    v_mov_b32 v21, 1
    ds_write_b32 v20, v21
    v_mov_b32 v20, 161824
    s_waitcnt lgkmcnt(0)
    ds_read_b128 v[22:25], v20 offset:0
    ds_read_b128 v[26:29], v20 offset:16
    s_waitcnt lgkmcnt(0)
    v_cmp_ne_u32 vcc, 1, v22
    v_cmp_ne_u32 s[34:35], 1, v23
    s_nop 0
    s_or_b64 vcc, vcc, s[34:35]
    v_cmp_ne_u32 s[34:35], 1, v24
    s_nop 0
    s_or_b64 vcc, vcc, s[34:35]
    v_cmp_ne_u32 s[34:35], 1, v25
    s_nop 0
    s_or_b64 vcc, vcc, s[34:35]
    v_cmp_ne_u32 s[34:35], 1, v26
    s_nop 0
    s_or_b64 vcc, vcc, s[34:35]
    v_cmp_ne_u32 s[34:35], 1, v27
    s_nop 0
    s_or_b64 vcc, vcc, s[34:35]
    v_cmp_ne_u32 s[34:35], 1, v28
    s_nop 0
    s_or_b64 vcc, vcc, s[34:35]
    v_cmp_ne_u32 s[34:35], 1, v29
    s_nop 0
    s_or_b64 vcc, vcc, s[34:35]
    s_cbranch_vccnz PUB_56
    v_mov_b32 v20, 0
    v_mov_b32 v21, s49
    s_mov_b64 exec, 1
    buffer_store_dword v21, v20, s[8:11], s27 offen sc1
    s_mov_b64 exec, -1
PUB_56:
    s_cmp_eq_u32 s47, 0
    s_cbranch_scc1 C_FFN
    v_mbcnt_lo_u32_b32 v1, -1, 0
    v_mbcnt_hi_u32_b32 v1, -1, v1
    v_mul_u32_u24 v2, 4682, v1
    v_lshrrev_b32 v2, 16, v2
    v_mul_u32_u24 v3, 14, v2
    v_sub_u32 v3, v1, v3
    v_lshlrev_b32 v3, 4, v3
    s_mul_i32 s25, s23, 216
    v_add_u32 v3, s25, v3
    v_mul_u32_u24 v2, 3456, v2
    v_add_u32 v2, v2, v3
    s_mov_b32 s12, s84
    s_mov_b32 s13, s85
    s_mov_b32 s14, 0x21c000
    s_mov_b32 s15, 0x20000
    s_mul_i32 s26, s24, 13824
    s_mov_b32 exec_lo, -1
    s_mov_b32 exec_hi, 0x00ffffff
    s_add_u32 s27, s26, 0
    buffer_load_dwordx4 v[96:99], v2, s[12:15], s27 offen
    s_add_u32 s27, s26, 55296
    buffer_load_dwordx4 v[100:103], v2, s[12:15], s27 offen
    s_add_u32 s27, s26, 110592
    buffer_load_dwordx4 v[104:107], v2, s[12:15], s27 offen
    s_add_u32 s27, s26, 165888
    buffer_load_dwordx4 v[108:111], v2, s[12:15], s27 offen
    s_add_u32 s27, s26, 221184
    buffer_load_dwordx4 v[112:115], v2, s[12:15], s27 offen
    s_add_u32 s27, s26, 276480
    buffer_load_dwordx4 v[116:119], v2, s[12:15], s27 offen
    s_add_u32 s27, s26, 331776
    buffer_load_dwordx4 v[120:123], v2, s[12:15], s27 offen
    s_add_u32 s27, s26, 387072
    buffer_load_dwordx4 v[124:127], v2, s[12:15], s27 offen
    s_add_u32 s27, s26, 442368
    buffer_load_dwordx4 v[128:131], v2, s[12:15], s27 offen
    s_add_u32 s27, s26, 497664
    buffer_load_dwordx4 v[132:135], v2, s[12:15], s27 offen
    s_add_u32 s27, s26, 552960
    buffer_load_dwordx4 v[136:139], v2, s[12:15], s27 offen
    s_add_u32 s27, s26, 608256
    buffer_load_dwordx4 v[140:143], v2, s[12:15], s27 offen
    s_add_u32 s27, s26, 663552
    buffer_load_dwordx4 v[144:147], v2, s[12:15], s27 offen
    s_add_u32 s27, s26, 718848
    buffer_load_dwordx4 v[148:151], v2, s[12:15], s27 offen
    s_add_u32 s27, s26, 774144
    buffer_load_dwordx4 v[152:155], v2, s[12:15], s27 offen
    s_add_u32 s27, s26, 829440
    buffer_load_dwordx4 v[156:159], v2, s[12:15], s27 offen
    s_add_u32 s27, s26, 884736
    buffer_load_dwordx4 v[160:163], v2, s[12:15], s27 offen
    s_add_u32 s27, s26, 940032
    buffer_load_dwordx4 v[164:167], v2, s[12:15], s27 offen
    s_add_u32 s27, s26, 995328
    buffer_load_dwordx4 v[168:171], v2, s[12:15], s27 offen
    s_add_u32 s27, s26, 1050624
    buffer_load_dwordx4 v[172:175], v2, s[12:15], s27 offen
    s_add_u32 s27, s26, 1105920
    buffer_load_dwordx4 v[176:179], v2, s[12:15], s27 offen
    s_add_u32 s27, s26, 1161216
    buffer_load_dwordx4 v[180:183], v2, s[12:15], s27 offen
    s_add_u32 s27, s26, 1216512
    buffer_load_dwordx4 v[184:187], v2, s[12:15], s27 offen
    s_add_u32 s27, s26, 1271808
    buffer_load_dwordx4 v[188:191], v2, s[12:15], s27 offen
    s_add_u32 s27, s26, 1327104
    buffer_load_dwordx4 v[192:195], v2, s[12:15], s27 offen
    s_add_u32 s27, s26, 1382400
    buffer_load_dwordx4 v[196:199], v2, s[12:15], s27 offen
    s_add_u32 s27, s26, 1437696
    buffer_load_dwordx4 v[200:203], v2, s[12:15], s27 offen
    s_add_u32 s27, s26, 1492992
    buffer_load_dwordx4 v[204:207], v2, s[12:15], s27 offen
    s_add_u32 s27, s26, 1548288
    buffer_load_dwordx4 v[208:211], v2, s[12:15], s27 offen
    s_add_u32 s27, s26, 1603584
    buffer_load_dwordx4 v[212:215], v2, s[12:15], s27 offen
    s_add_u32 s27, s26, 1658880
    buffer_load_dwordx4 v[216:219], v2, s[12:15], s27 offen
    s_add_u32 s27, s26, 1714176
    buffer_load_dwordx4 v[220:223], v2, s[12:15], s27 offen
    s_add_u32 s27, s26, 1769472
    buffer_load_dwordx4 v[224:227], v2, s[12:15], s27 offen
    s_add_u32 s27, s26, 1824768
    buffer_load_dwordx4 v[228:231], v2, s[12:15], s27 offen
    s_add_u32 s27, s26, 1880064
    buffer_load_dwordx4 v[232:235], v2, s[12:15], s27 offen
    s_add_u32 s27, s26, 1935360
    buffer_load_dwordx4 v[236:239], v2, s[12:15], s27 offen
    s_add_u32 s27, s26, 1990656
    buffer_load_dwordx4 v[240:243], v2, s[12:15], s27 offen
    s_add_u32 s27, s26, 2045952
    buffer_load_dwordx4 v[244:247], v2, s[12:15], s27 offen
    s_add_u32 s27, s26, 2101248
    buffer_load_dwordx4 v[248:251], v2, s[12:15], s27 offen
    s_add_u32 s27, s26, 2156544
    buffer_load_dwordx4 v[252:255], v2, s[12:15], s27 offen
    s_mov_b64 exec, -1
    s_cmp_lg_u32 s24, 0
    s_cbranch_scc1 NL_NOGO
    v_mov_b32 v12, 0
    s_mov_b32 s27, 0x28000
    s_mov_b32 s101, 0
POLL_57:
    s_add_u32 s101, s101, 1
    s_cmp_gt_u32 s101, 200000
    s_cbranch_scc1 POLLX_58
    buffer_load_dword v14, v12, s[8:11], s27 offen sc1
    s_waitcnt vmcnt(0)
    v_cmp_ne_u32 vcc, s49, v14
    s_nop 0
    s_cbranch_vccnz POLL_57
POLLX_58:
    v_mov_b32 v12, 161948
    v_mov_b32 v13, 1
    s_mov_b64 exec, 1
    ds_add_u32 v12, v13
    s_mov_b64 exec, -1
NL_NOGO:
    v_mbcnt_lo_u32_b32 v1, -1, 0
    v_mbcnt_hi_u32_b32 v1, -1, v1
    s_mul_i32 s26, s24, 896
    v_lshlrev_b32 v3, 4, v1
    v_add_u32 v3, s26, v3
    v_add_u32 v4, 0x10000, v3
    v_add_u32 v5, 0x20000, v3
    s_mov_b32 exec_lo, -1
    s_mov_b32 exec_hi, 0x00ffffff
    s_waitcnt vmcnt(39)
    ds_write_b128 v3, v[96:99] offset:0
    s_waitcnt vmcnt(38)
    ds_write_b128 v3, v[100:103] offset:3584
    s_waitcnt vmcnt(37)
    ds_write_b128 v3, v[104:107] offset:7168
    s_waitcnt vmcnt(36)
    ds_write_b128 v3, v[108:111] offset:10752
    s_waitcnt vmcnt(35)
    ds_write_b128 v3, v[112:115] offset:14336
    s_waitcnt vmcnt(34)
    ds_write_b128 v3, v[116:119] offset:17920
    s_waitcnt vmcnt(33)
    ds_write_b128 v3, v[120:123] offset:21504
    s_waitcnt vmcnt(32)
    ds_write_b128 v3, v[124:127] offset:25088
    s_waitcnt vmcnt(31)
    ds_write_b128 v3, v[128:131] offset:28672
    s_waitcnt vmcnt(30)
    ds_write_b128 v3, v[132:135] offset:32256
    s_waitcnt vmcnt(29)
    ds_write_b128 v3, v[136:139] offset:35840
    s_waitcnt vmcnt(28)
    ds_write_b128 v3, v[140:143] offset:39424
    s_waitcnt vmcnt(27)
    ds_write_b128 v3, v[144:147] offset:43008
    s_waitcnt vmcnt(26)
    ds_write_b128 v3, v[148:151] offset:46592
    s_waitcnt vmcnt(25)
    ds_write_b128 v3, v[152:155] offset:50176
    s_waitcnt vmcnt(24)
    ds_write_b128 v3, v[156:159] offset:53760
    s_waitcnt vmcnt(23)
    ds_write_b128 v3, v[160:163] offset:57344
    s_waitcnt vmcnt(22)
    ds_write_b128 v3, v[164:167] offset:60928
    s_waitcnt vmcnt(21)
    ds_write_b128 v3, v[168:171] offset:64512
    s_waitcnt vmcnt(20)
    ds_write_b128 v4, v[172:175] offset:2560
    s_waitcnt vmcnt(19)
    ds_write_b128 v4, v[176:179] offset:6144
    s_waitcnt vmcnt(18)
    ds_write_b128 v4, v[180:183] offset:9728
    s_waitcnt vmcnt(17)
    ds_write_b128 v4, v[184:187] offset:13312
    s_waitcnt vmcnt(16)
    ds_write_b128 v4, v[188:191] offset:16896
    s_waitcnt vmcnt(15)
    ds_write_b128 v4, v[192:195] offset:20480
    s_waitcnt vmcnt(14)
    ds_write_b128 v4, v[196:199] offset:24064
    s_waitcnt vmcnt(13)
    ds_write_b128 v4, v[200:203] offset:27648
    s_waitcnt vmcnt(12)
    ds_write_b128 v4, v[204:207] offset:31232
    s_waitcnt vmcnt(11)
    ds_write_b128 v4, v[208:211] offset:34816
    s_waitcnt vmcnt(10)
    ds_write_b128 v4, v[212:215] offset:38400
    s_waitcnt vmcnt(9)
    ds_write_b128 v4, v[216:219] offset:41984
    s_waitcnt vmcnt(8)
    ds_write_b128 v4, v[220:223] offset:45568
    s_waitcnt vmcnt(7)
    ds_write_b128 v4, v[224:227] offset:49152
    s_waitcnt vmcnt(6)
    ds_write_b128 v4, v[228:231] offset:52736
    s_waitcnt vmcnt(5)
    ds_write_b128 v4, v[232:235] offset:56320
    s_waitcnt vmcnt(4)
    ds_write_b128 v4, v[236:239] offset:59904
    s_waitcnt vmcnt(3)
    ds_write_b128 v4, v[240:243] offset:63488
    s_waitcnt vmcnt(2)
    ds_write_b128 v5, v[244:247] offset:1536
    s_waitcnt vmcnt(1)
    ds_write_b128 v5, v[248:251] offset:5120
    s_waitcnt vmcnt(0)
    ds_write_b128 v5, v[252:255] offset:8704
    s_mov_b64 exec, -1
    s_waitcnt lgkmcnt(0)
    v_lshrrev_b32 v2, 2, v1
    v_lshlrev_b32 v2, 4, v2
    v_and_b32 v4, 3, v1
    v_add_u32 v2, v2, v4
    s_lshl_b32 s26, s24, 2
    v_add_u32 v2, s26, v2
    v_mul_u32_u24 v2, 224, v2
    v_add_u32 v2, 216, v2
    v_mov_b32 v4, 0x3f803f80
    v_mov_b32 v5, 0x3f803f80
    ds_write_b64 v2, v[4:5]
    ds_write_b64 v2, v[4:5] offset:57344
    v_add_u32 v2, 114688, v2
    s_mov_b64 exec, 0xffffffff
    ds_write_b64 v2, v[4:5]
    s_mov_b64 exec, -1
    s_waitcnt lgkmcnt(0)
    s_branch L_G1
C_FFN:
    v_mbcnt_lo_u32_b32 v1, -1, 0
    v_mbcnt_hi_u32_b32 v1, -1, v1
    v_lshlrev_b32 v3, 4, v1
    v_lshrrev_b32 v7, 4, v1
    v_and_b32 v6, 15, v1
    v_lshlrev_b32 v4, 14, v7
    v_lshl_add_u32 v4, v6, 4, v4
    v_add_u32 v5, 0x10000, v4
    v_lshrrev_b32 v3, 2, v6
    v_lshl_add_u32 v3, v7, 2, v3
    v_mul_u32_u24 v3, 224, v3
    v_and_b32 v2, 3, v6
    v_mul_u32_u24 v2, 8, v2
    v_add_u32 v3, v3, v2
    v_add_u32 v2, 0x10000, v3
    v_add_u32 v1, 0x20000, v3
    s_lshl_b32 s30, s22, 10
    s_lshl_b32 s31, s24, 8
    s_add_u32 s30, s30, s31
    s_add_u32 s26, s30, 0x40000
    s_mul_i32 s25, s23, 224
    v_mov_b32 v8, 0
    v_mov_b32 v9, 0
    v_mov_b32 v10, 0
    v_mov_b32 v11, 0
    v_mov_b32 v12, 0
    v_mov_b32 v13, 0
    v_mov_b32 v14, 0
    v_mov_b32 v15, 0
    v_mov_b32 v16, 0
    v_mov_b32 v17, 0
    v_mov_b32 v18, 0
    v_mov_b32 v19, 0
    v_mov_b32 v20, 0
    v_mov_b32 v21, 0
    v_mov_b32 v22, 0
    v_mov_b32 v23, 0
    v_mov_b32 v24, 0
    v_mov_b32 v25, 0
    v_mov_b32 v26, 0
    v_mov_b32 v27, 0
    v_mov_b32 v28, 0
    v_mov_b32 v29, 0
    v_mov_b32 v30, 0
    v_mov_b32 v31, 0
    v_mov_b32 v32, 0
    v_mov_b32 v33, 0
    v_mov_b32 v34, 0
    v_mov_b32 v35, 0
    v_mov_b32 v36, 0
    v_mov_b32 v37, 0
    v_mov_b32 v38, 0
    v_mov_b32 v39, 0
    v_mov_b32 v40, 0
    v_mov_b32 v41, 0
    v_mov_b32 v42, 0
    v_mov_b32 v43, 0
    v_mov_b32 v44, 0
    v_mov_b32 v45, 0
    v_mov_b32 v46, 0
    v_mov_b32 v47, 0
    v_mov_b32 v48, 0
    v_mov_b32 v49, 0
    v_mov_b32 v50, 0
    v_mov_b32 v51, 0
    v_mov_b32 v52, 0
    v_mov_b32 v53, 0
    v_mov_b32 v54, 0
    v_mov_b32 v55, 0
    v_mov_b32 v56, 0
    v_mov_b32 v57, 0
    v_mov_b32 v58, 0
    v_mov_b32 v59, 0
    v_mov_b32 v60, 0
    v_mov_b32 v61, 0
    v_mov_b32 v62, 0
    v_mov_b32 v63, 0
    v_mov_b32 v156, 0
    v_mov_b32 v157, 0
    v_mov_b32 v158, 0
    v_mov_b32 v159, 0
    v_mov_b32 v160, 0
    v_mov_b32 v161, 0
    v_mov_b32 v162, 0
    v_mov_b32 v163, 0
    s_mov_b32 s12, s86
    s_mov_b32 s13, s87
    s_mov_b32 s14, 0xd80
    s_mov_b32 s15, 0x20000
    s_mov_b32 s100, 0
    v_mov_b32 v252, 161948
    s_mov_b32 s101, 0
LW_59:
    s_add_u32 s101, s101, 1
    s_cmp_gt_u32 s101, 4000000
    s_cbranch_scc1 LWX_60
    ds_read_b32 v253, v252
    s_waitcnt lgkmcnt(0)
    v_readfirstlane_b32 s34, v253
    s_nop 0
    s_cmp_ge_u32 s34, 1
    s_cbranch_scc1 LWX_60
    s_branch LW_59
LWX_60:
SF_61:
    s_add_u32 s100, s100, 1
    s_cmp_gt_u32 s100, 200000
    s_cbranch_scc1 SFX_62
    s_add_u32 s35, s26, 0
    buffer_load_dwordx4 v[168:171], v4, s[8:11], s35 offen sc1
    s_waitcnt vmcnt(0)
    v_max_u32 v252, v168, v170
    v_cmp_eq_u32 vcc, -1, v252
    s_nop 0
    s_cbranch_vccnz SF_61
SFX_62:
    s_add_u32 s33, s26, 0
    buffer_load_dwordx4 v[168:171], v4, s[8:11], s33 offen sc1
    buffer_load_dwordx4 v[172:175], v5, s[8:11], s33 offen sc1
    s_add_u32 s33, s26, 131072
    buffer_load_dwordx4 v[176:179], v4, s[8:11], s33 offen sc1
    buffer_load_dwordx4 v[180:183], v5, s[8:11], s33 offen sc1
    s_add_u32 s33, s26, 262144
    buffer_load_dwordx4 v[184:187], v4, s[8:11], s33 offen sc1
    buffer_load_dwordx4 v[188:191], v5, s[8:11], s33 offen sc1
    s_add_u32 s33, s26, 393216
    buffer_load_dwordx4 v[192:195], v4, s[8:11], s33 offen sc1
    buffer_load_dwordx4 v[196:199], v5, s[8:11], s33 offen sc1
    s_add_u32 s33, s26, 524288
    buffer_load_dwordx4 v[200:203], v4, s[8:11], s33 offen sc1
    buffer_load_dwordx4 v[204:207], v5, s[8:11], s33 offen sc1
    s_add_u32 s33, s26, 655360
    buffer_load_dwordx4 v[208:211], v4, s[8:11], s33 offen sc1
    buffer_load_dwordx4 v[212:215], v5, s[8:11], s33 offen sc1
    s_add_u32 s33, s26, 786432
    buffer_load_dwordx4 v[216:219], v4, s[8:11], s33 offen sc1
    buffer_load_dwordx4 v[220:223], v5, s[8:11], s33 offen sc1
    s_add_u32 s33, s26, 917504
    buffer_load_dwordx4 v[224:227], v4, s[8:11], s33 offen sc1
    buffer_load_dwordx4 v[228:231], v5, s[8:11], s33 offen sc1
    s_add_u32 s33, s26, 1048576
    buffer_load_dwordx4 v[232:235], v4, s[8:11], s33 offen sc1
    buffer_load_dwordx4 v[236:239], v5, s[8:11], s33 offen sc1
    v_mov_b32 v252, 161920
    s_mov_b32 s101, 0
LW_63:
    s_add_u32 s101, s101, 1
    s_cmp_gt_u32 s101, 4000000
    s_cbranch_scc1 LWX_64
    ds_read_b32 v253, v252
    s_waitcnt lgkmcnt(0)
    v_readfirstlane_b32 s34, v253
    s_nop 0
    s_cmp_ge_u32 s34, 4
    s_cbranch_scc1 LWX_64
    s_branch LW_63
LWX_64:
    ds_read_b64_tr_b16 v[64:65], v3 offset:0
    ds_read_b64_tr_b16 v[66:67], v3 offset:3584
    ds_read_b64_tr_b16 v[68:69], v3 offset:32
    ds_read_b64_tr_b16 v[70:71], v3 offset:3616
    ds_read_b64_tr_b16 v[72:73], v3 offset:64
    ds_read_b64_tr_b16 v[74:75], v3 offset:3648
    ds_read_b64_tr_b16 v[76:77], v3 offset:96
    ds_read_b64_tr_b16 v[78:79], v3 offset:3680
    ds_read_b64_tr_b16 v[80:81], v3 offset:128
    ds_read_b64_tr_b16 v[82:83], v3 offset:3712
    ds_read_b64_tr_b16 v[84:85], v3 offset:160
    ds_read_b64_tr_b16 v[86:87], v3 offset:3744
    ds_read_b64_tr_b16 v[88:89], v3 offset:192
    ds_read_b64_tr_b16 v[90:91], v3 offset:3776
    ds_read_b64_tr_b16 v[92:93], v3 offset:7168
    ds_read_b64_tr_b16 v[94:95], v3 offset:10752
    ds_read_b64_tr_b16 v[96:97], v3 offset:7200
    ds_read_b64_tr_b16 v[98:99], v3 offset:10784
    ds_read_b64_tr_b16 v[100:101], v3 offset:7232
    ds_read_b64_tr_b16 v[102:103], v3 offset:10816
    ds_read_b64_tr_b16 v[104:105], v3 offset:7264
    ds_read_b64_tr_b16 v[106:107], v3 offset:10848
    ds_read_b64_tr_b16 v[108:109], v3 offset:7296
    ds_read_b64_tr_b16 v[110:111], v3 offset:10880
    ds_read_b64_tr_b16 v[112:113], v3 offset:7328
    ds_read_b64_tr_b16 v[114:115], v3 offset:10912
    ds_read_b64_tr_b16 v[116:117], v3 offset:7360
    ds_read_b64_tr_b16 v[118:119], v3 offset:10944
    s_waitcnt vmcnt(16)
SVB_65:
    v_max3_u32 v252, v168, v170, v172
    v_max_u32 v252, v252, v174
    v_cmp_eq_u32 vcc, -1, v252
    s_nop 0
    s_cbranch_vccnz SVS_66
    v_swap_b32 v170, v172
    v_swap_b32 v171, v173
SVB_65_AFTER:
    s_waitcnt lgkmcnt(14)
    s_nop 0
    v_mfma_f32_16x16x32_bf16 v[8:11], v[64:67], v[168:171], v[8:11]
    ds_read_b64_tr_b16 v[120:121], v3 offset:14336
    v_mfma_f32_16x16x32_bf16 v[12:15], v[64:67], v[172:175], v[12:15]
    ds_read_b64_tr_b16 v[122:123], v3 offset:17920
    s_add_u32 s33, s26, 1179648
    buffer_load_dwordx4 v[240:243], v4, s[8:11], s33 offen sc1
    v_mfma_f32_16x16x32_bf16 v[16:19], v[68:71], v[168:171], v[16:19]
    ds_read_b64_tr_b16 v[124:125], v3 offset:14368
    v_mfma_f32_16x16x32_bf16 v[20:23], v[68:71], v[172:175], v[20:23]
    ds_read_b64_tr_b16 v[126:127], v3 offset:17952
    v_mfma_f32_16x16x32_bf16 v[24:27], v[72:75], v[168:171], v[24:27]
    ds_read_b64_tr_b16 v[128:129], v3 offset:14400
    buffer_load_dwordx4 v[244:247], v5, s[8:11], s33 offen sc1
    v_mfma_f32_16x16x32_bf16 v[28:31], v[72:75], v[172:175], v[28:31]
    ds_read_b64_tr_b16 v[130:131], v3 offset:17984
    v_mfma_f32_16x16x32_bf16 v[32:35], v[76:79], v[168:171], v[32:35]
    ds_read_b64_tr_b16 v[132:133], v3 offset:14432
    v_mfma_f32_16x16x32_bf16 v[36:39], v[76:79], v[172:175], v[36:39]
    ds_read_b64_tr_b16 v[134:135], v3 offset:18016
    v_mfma_f32_16x16x32_bf16 v[40:43], v[80:83], v[168:171], v[40:43]
    ds_read_b64_tr_b16 v[136:137], v3 offset:14464
    s_waitcnt vmcnt(16)
SVB_67:
    v_max3_u32 v252, v176, v178, v180
    v_max_u32 v252, v252, v182
    v_cmp_eq_u32 vcc, -1, v252
    s_nop 0
    s_cbranch_vccnz SVS_68
    v_swap_b32 v178, v180
    v_swap_b32 v179, v181
SVB_67_AFTER:
    v_mfma_f32_16x16x32_bf16 v[44:47], v[80:83], v[172:175], v[44:47]
    ds_read_b64_tr_b16 v[138:139], v3 offset:18048
    v_mfma_f32_16x16x32_bf16 v[48:51], v[84:87], v[168:171], v[48:51]
    ds_read_b64_tr_b16 v[140:141], v3 offset:14496
    v_mfma_f32_16x16x32_bf16 v[52:55], v[84:87], v[172:175], v[52:55]
    ds_read_b64_tr_b16 v[142:143], v3 offset:18080
    v_mfma_f32_16x16x32_bf16 v[56:59], v[88:91], v[168:171], v[56:59]
    ds_read_b64_tr_b16 v[144:145], v3 offset:14528
    v_mfma_f32_16x16x32_bf16 v[60:63], v[88:91], v[172:175], v[60:63]
    ds_read_b64_tr_b16 v[146:147], v3 offset:18112
    v_mfma_f32_16x16x32_bf16 v[156:159], v[168:171], v[168:171], v[156:159]
    v_mfma_f32_16x16x32_bf16 v[160:163], v[172:175], v[172:175], v[160:163]
    s_waitcnt lgkmcnt(14)
    v_mov_b32 v252, 161944
    v_mov_b32 v253, 1
    s_mov_b64 exec, 1
    ds_add_u32 v252, v253
    s_mov_b64 exec, -1
    v_mfma_f32_16x16x32_bf16 v[8:11], v[92:95], v[176:179], v[8:11]
    ds_read_b64_tr_b16 v[64:65], v3 offset:21504
    v_mfma_f32_16x16x32_bf16 v[12:15], v[92:95], v[180:183], v[12:15]
    ds_read_b64_tr_b16 v[66:67], v3 offset:25088
    s_add_u32 s33, s26, 1310720
    buffer_load_dwordx4 v[168:171], v4, s[8:11], s33 offen sc1
    v_mfma_f32_16x16x32_bf16 v[16:19], v[96:99], v[176:179], v[16:19]
    ds_read_b64_tr_b16 v[68:69], v3 offset:21536
    v_mfma_f32_16x16x32_bf16 v[20:23], v[96:99], v[180:183], v[20:23]
    ds_read_b64_tr_b16 v[70:71], v3 offset:25120
    v_mfma_f32_16x16x32_bf16 v[24:27], v[100:103], v[176:179], v[24:27]
    ds_read_b64_tr_b16 v[72:73], v3 offset:21568
    buffer_load_dwordx4 v[172:175], v5, s[8:11], s33 offen sc1
    v_mfma_f32_16x16x32_bf16 v[28:31], v[100:103], v[180:183], v[28:31]
    ds_read_b64_tr_b16 v[74:75], v3 offset:25152
    v_mfma_f32_16x16x32_bf16 v[32:35], v[104:107], v[176:179], v[32:35]
    ds_read_b64_tr_b16 v[76:77], v3 offset:21600
    v_mfma_f32_16x16x32_bf16 v[36:39], v[104:107], v[180:183], v[36:39]
    ds_read_b64_tr_b16 v[78:79], v3 offset:25184
    v_mfma_f32_16x16x32_bf16 v[40:43], v[108:111], v[176:179], v[40:43]
    ds_read_b64_tr_b16 v[80:81], v3 offset:21632
    s_waitcnt vmcnt(16)
SVB_69:
    v_max3_u32 v252, v184, v186, v188
    v_max_u32 v252, v252, v190
    v_cmp_eq_u32 vcc, -1, v252
    s_nop 0
    s_cbranch_vccnz SVS_70
    v_swap_b32 v186, v188
    v_swap_b32 v187, v189
SVB_69_AFTER:
    v_mfma_f32_16x16x32_bf16 v[44:47], v[108:111], v[180:183], v[44:47]
    ds_read_b64_tr_b16 v[82:83], v3 offset:25216
    v_mfma_f32_16x16x32_bf16 v[48:51], v[112:115], v[176:179], v[48:51]
    ds_read_b64_tr_b16 v[84:85], v3 offset:21664
    v_mfma_f32_16x16x32_bf16 v[52:55], v[112:115], v[180:183], v[52:55]
    ds_read_b64_tr_b16 v[86:87], v3 offset:25248
    v_mfma_f32_16x16x32_bf16 v[56:59], v[116:119], v[176:179], v[56:59]
    ds_read_b64_tr_b16 v[88:89], v3 offset:21696
    v_mfma_f32_16x16x32_bf16 v[60:63], v[116:119], v[180:183], v[60:63]
    ds_read_b64_tr_b16 v[90:91], v3 offset:25280
    v_mfma_f32_16x16x32_bf16 v[156:159], v[176:179], v[176:179], v[156:159]
    v_mfma_f32_16x16x32_bf16 v[160:163], v[180:183], v[180:183], v[160:163]
    s_waitcnt lgkmcnt(14)
    v_mfma_f32_16x16x32_bf16 v[8:11], v[120:123], v[184:187], v[8:11]
    ds_read_b64_tr_b16 v[92:93], v3 offset:28672
    v_mfma_f32_16x16x32_bf16 v[12:15], v[120:123], v[188:191], v[12:15]
    ds_read_b64_tr_b16 v[94:95], v3 offset:32256
    s_add_u32 s33, s26, 1441792
    buffer_load_dwordx4 v[176:179], v4, s[8:11], s33 offen sc1
    v_mfma_f32_16x16x32_bf16 v[16:19], v[124:127], v[184:187], v[16:19]
    ds_read_b64_tr_b16 v[96:97], v3 offset:28704
    v_mfma_f32_16x16x32_bf16 v[20:23], v[124:127], v[188:191], v[20:23]
    ds_read_b64_tr_b16 v[98:99], v3 offset:32288
    v_mfma_f32_16x16x32_bf16 v[24:27], v[128:131], v[184:187], v[24:27]
    ds_read_b64_tr_b16 v[100:101], v3 offset:28736
    buffer_load_dwordx4 v[180:183], v5, s[8:11], s33 offen sc1
    v_mfma_f32_16x16x32_bf16 v[28:31], v[128:131], v[188:191], v[28:31]
    ds_read_b64_tr_b16 v[102:103], v3 offset:32320
    v_mfma_f32_16x16x32_bf16 v[32:35], v[132:135], v[184:187], v[32:35]
    ds_read_b64_tr_b16 v[104:105], v3 offset:28768
    v_mfma_f32_16x16x32_bf16 v[36:39], v[132:135], v[188:191], v[36:39]
    ds_read_b64_tr_b16 v[106:107], v3 offset:32352
    v_mfma_f32_16x16x32_bf16 v[40:43], v[136:139], v[184:187], v[40:43]
    ds_read_b64_tr_b16 v[108:109], v3 offset:28800
    s_waitcnt vmcnt(16)
SVB_71:
    v_max3_u32 v252, v192, v194, v196
    v_max_u32 v252, v252, v198
    v_cmp_eq_u32 vcc, -1, v252
    s_nop 0
    s_cbranch_vccnz SVS_72
    v_swap_b32 v194, v196
    v_swap_b32 v195, v197
SVB_71_AFTER:
    v_mfma_f32_16x16x32_bf16 v[44:47], v[136:139], v[188:191], v[44:47]
    ds_read_b64_tr_b16 v[110:111], v3 offset:32384
    v_mfma_f32_16x16x32_bf16 v[48:51], v[140:143], v[184:187], v[48:51]
    ds_read_b64_tr_b16 v[112:113], v3 offset:28832
    v_mfma_f32_16x16x32_bf16 v[52:55], v[140:143], v[188:191], v[52:55]
    ds_read_b64_tr_b16 v[114:115], v3 offset:32416
    v_mfma_f32_16x16x32_bf16 v[56:59], v[144:147], v[184:187], v[56:59]
    ds_read_b64_tr_b16 v[116:117], v3 offset:28864
    v_mfma_f32_16x16x32_bf16 v[60:63], v[144:147], v[188:191], v[60:63]
    ds_read_b64_tr_b16 v[118:119], v3 offset:32448
    v_mfma_f32_16x16x32_bf16 v[156:159], v[184:187], v[184:187], v[156:159]
    v_mfma_f32_16x16x32_bf16 v[160:163], v[188:191], v[188:191], v[160:163]
    s_waitcnt lgkmcnt(14)
    v_mfma_f32_16x16x32_bf16 v[8:11], v[64:67], v[192:195], v[8:11]
    ds_read_b64_tr_b16 v[120:121], v3 offset:35840
    v_mfma_f32_16x16x32_bf16 v[12:15], v[64:67], v[196:199], v[12:15]
    ds_read_b64_tr_b16 v[122:123], v3 offset:39424
    s_add_u32 s33, s26, 1572864
    buffer_load_dwordx4 v[184:187], v4, s[8:11], s33 offen sc1
    v_mfma_f32_16x16x32_bf16 v[16:19], v[68:71], v[192:195], v[16:19]
    ds_read_b64_tr_b16 v[124:125], v3 offset:35872
    v_mfma_f32_16x16x32_bf16 v[20:23], v[68:71], v[196:199], v[20:23]
    ds_read_b64_tr_b16 v[126:127], v3 offset:39456
    v_mfma_f32_16x16x32_bf16 v[24:27], v[72:75], v[192:195], v[24:27]
    ds_read_b64_tr_b16 v[128:129], v3 offset:35904
    buffer_load_dwordx4 v[188:191], v5, s[8:11], s33 offen sc1
    v_mfma_f32_16x16x32_bf16 v[28:31], v[72:75], v[196:199], v[28:31]
    ds_read_b64_tr_b16 v[130:131], v3 offset:39488
    v_mfma_f32_16x16x32_bf16 v[32:35], v[76:79], v[192:195], v[32:35]
    ds_read_b64_tr_b16 v[132:133], v3 offset:35936
    v_mfma_f32_16x16x32_bf16 v[36:39], v[76:79], v[196:199], v[36:39]
    ds_read_b64_tr_b16 v[134:135], v3 offset:39520
    v_mfma_f32_16x16x32_bf16 v[40:43], v[80:83], v[192:195], v[40:43]
    ds_read_b64_tr_b16 v[136:137], v3 offset:35968
    s_waitcnt vmcnt(16)
SVB_73:
    v_max3_u32 v252, v200, v202, v204
    v_max_u32 v252, v252, v206
    v_cmp_eq_u32 vcc, -1, v252
    s_nop 0
    s_cbranch_vccnz SVS_74
    v_swap_b32 v202, v204
    v_swap_b32 v203, v205
SVB_73_AFTER:
    v_mfma_f32_16x16x32_bf16 v[44:47], v[80:83], v[196:199], v[44:47]
    ds_read_b64_tr_b16 v[138:139], v3 offset:39552
    v_mfma_f32_16x16x32_bf16 v[48:51], v[84:87], v[192:195], v[48:51]
    ds_read_b64_tr_b16 v[140:141], v3 offset:36000
    v_mfma_f32_16x16x32_bf16 v[52:55], v[84:87], v[196:199], v[52:55]
    ds_read_b64_tr_b16 v[142:143], v3 offset:39584
    v_mfma_f32_16x16x32_bf16 v[56:59], v[88:91], v[192:195], v[56:59]
    ds_read_b64_tr_b16 v[144:145], v3 offset:36032
    v_mfma_f32_16x16x32_bf16 v[60:63], v[88:91], v[196:199], v[60:63]
    ds_read_b64_tr_b16 v[146:147], v3 offset:39616
    v_mfma_f32_16x16x32_bf16 v[156:159], v[192:195], v[192:195], v[156:159]
    v_mfma_f32_16x16x32_bf16 v[160:163], v[196:199], v[196:199], v[160:163]
    s_waitcnt lgkmcnt(14)
    v_mfma_f32_16x16x32_bf16 v[8:11], v[92:95], v[200:203], v[8:11]
    ds_read_b64_tr_b16 v[64:65], v3 offset:43008
    v_mfma_f32_16x16x32_bf16 v[12:15], v[92:95], v[204:207], v[12:15]
    ds_read_b64_tr_b16 v[66:67], v3 offset:46592
    s_add_u32 s33, s26, 1703936
    buffer_load_dwordx4 v[192:195], v4, s[8:11], s33 offen sc1
    v_mfma_f32_16x16x32_bf16 v[16:19], v[96:99], v[200:203], v[16:19]
    ds_read_b64_tr_b16 v[68:69], v3 offset:43040
    v_mfma_f32_16x16x32_bf16 v[20:23], v[96:99], v[204:207], v[20:23]
    ds_read_b64_tr_b16 v[70:71], v3 offset:46624
    v_mfma_f32_16x16x32_bf16 v[24:27], v[100:103], v[200:203], v[24:27]
    ds_read_b64_tr_b16 v[72:73], v3 offset:43072
    buffer_load_dwordx4 v[196:199], v5, s[8:11], s33 offen sc1
    v_mfma_f32_16x16x32_bf16 v[28:31], v[100:103], v[204:207], v[28:31]
    ds_read_b64_tr_b16 v[74:75], v3 offset:46656
    v_mfma_f32_16x16x32_bf16 v[32:35], v[104:107], v[200:203], v[32:35]
    ds_read_b64_tr_b16 v[76:77], v3 offset:43104
    v_mfma_f32_16x16x32_bf16 v[36:39], v[104:107], v[204:207], v[36:39]
    ds_read_b64_tr_b16 v[78:79], v3 offset:46688
    v_mfma_f32_16x16x32_bf16 v[40:43], v[108:111], v[200:203], v[40:43]
    ds_read_b64_tr_b16 v[80:81], v3 offset:43136
    s_waitcnt vmcnt(16)
SVB_75:
    v_max3_u32 v252, v208, v210, v212
    v_max_u32 v252, v252, v214
    v_cmp_eq_u32 vcc, -1, v252
    s_nop 0
    s_cbranch_vccnz SVS_76
    v_swap_b32 v210, v212
    v_swap_b32 v211, v213
SVB_75_AFTER:
    v_mfma_f32_16x16x32_bf16 v[44:47], v[108:111], v[204:207], v[44:47]
    ds_read_b64_tr_b16 v[82:83], v3 offset:46720
    v_mfma_f32_16x16x32_bf16 v[48:51], v[112:115], v[200:203], v[48:51]
    ds_read_b64_tr_b16 v[84:85], v3 offset:43168
    v_mfma_f32_16x16x32_bf16 v[52:55], v[112:115], v[204:207], v[52:55]
    ds_read_b64_tr_b16 v[86:87], v3 offset:46752
    v_mfma_f32_16x16x32_bf16 v[56:59], v[116:119], v[200:203], v[56:59]
    ds_read_b64_tr_b16 v[88:89], v3 offset:43200
    v_mfma_f32_16x16x32_bf16 v[60:63], v[116:119], v[204:207], v[60:63]
    ds_read_b64_tr_b16 v[90:91], v3 offset:46784
    v_mfma_f32_16x16x32_bf16 v[156:159], v[200:203], v[200:203], v[156:159]
    v_mfma_f32_16x16x32_bf16 v[160:163], v[204:207], v[204:207], v[160:163]
    s_waitcnt lgkmcnt(14)
    v_mfma_f32_16x16x32_bf16 v[8:11], v[120:123], v[208:211], v[8:11]
    ds_read_b64_tr_b16 v[92:93], v3 offset:50176
    v_mfma_f32_16x16x32_bf16 v[12:15], v[120:123], v[212:215], v[12:15]
    ds_read_b64_tr_b16 v[94:95], v3 offset:53760
    s_add_u32 s33, s26, 1835008
    buffer_load_dwordx4 v[200:203], v4, s[8:11], s33 offen sc1
    v_mfma_f32_16x16x32_bf16 v[16:19], v[124:127], v[208:211], v[16:19]
    ds_read_b64_tr_b16 v[96:97], v3 offset:50208
    v_mfma_f32_16x16x32_bf16 v[20:23], v[124:127], v[212:215], v[20:23]
    ds_read_b64_tr_b16 v[98:99], v3 offset:53792
    v_mfma_f32_16x16x32_bf16 v[24:27], v[128:131], v[208:211], v[24:27]
    ds_read_b64_tr_b16 v[100:101], v3 offset:50240
    buffer_load_dwordx4 v[204:207], v5, s[8:11], s33 offen sc1
    v_mfma_f32_16x16x32_bf16 v[28:31], v[128:131], v[212:215], v[28:31]
    ds_read_b64_tr_b16 v[102:103], v3 offset:53824
    v_mfma_f32_16x16x32_bf16 v[32:35], v[132:135], v[208:211], v[32:35]
    ds_read_b64_tr_b16 v[104:105], v3 offset:50272
    v_mfma_f32_16x16x32_bf16 v[36:39], v[132:135], v[212:215], v[36:39]
    ds_read_b64_tr_b16 v[106:107], v3 offset:53856
    v_mfma_f32_16x16x32_bf16 v[40:43], v[136:139], v[208:211], v[40:43]
    ds_read_b64_tr_b16 v[108:109], v3 offset:50304
    s_waitcnt vmcnt(16)
SVB_77:
    v_max3_u32 v252, v216, v218, v220
    v_max_u32 v252, v252, v222
    v_cmp_eq_u32 vcc, -1, v252
    s_nop 0
    s_cbranch_vccnz SVS_78
    v_swap_b32 v218, v220
    v_swap_b32 v219, v221
SVB_77_AFTER:
    v_mfma_f32_16x16x32_bf16 v[44:47], v[136:139], v[212:215], v[44:47]
    ds_read_b64_tr_b16 v[110:111], v3 offset:53888
    v_mfma_f32_16x16x32_bf16 v[48:51], v[140:143], v[208:211], v[48:51]
    ds_read_b64_tr_b16 v[112:113], v3 offset:50336
    v_mfma_f32_16x16x32_bf16 v[52:55], v[140:143], v[212:215], v[52:55]
    ds_read_b64_tr_b16 v[114:115], v3 offset:53920
    v_mfma_f32_16x16x32_bf16 v[56:59], v[144:147], v[208:211], v[56:59]
    ds_read_b64_tr_b16 v[116:117], v3 offset:50368
    v_mfma_f32_16x16x32_bf16 v[60:63], v[144:147], v[212:215], v[60:63]
    ds_read_b64_tr_b16 v[118:119], v3 offset:53952
    v_mfma_f32_16x16x32_bf16 v[156:159], v[208:211], v[208:211], v[156:159]
    v_mfma_f32_16x16x32_bf16 v[160:163], v[212:215], v[212:215], v[160:163]
    s_waitcnt lgkmcnt(14)
    v_mfma_f32_16x16x32_bf16 v[8:11], v[64:67], v[216:219], v[8:11]
    ds_read_b64_tr_b16 v[120:121], v3 offset:57344
    v_mfma_f32_16x16x32_bf16 v[12:15], v[64:67], v[220:223], v[12:15]
    ds_read_b64_tr_b16 v[122:123], v3 offset:60928
    s_add_u32 s33, s26, 1966080
    buffer_load_dwordx4 v[208:211], v4, s[8:11], s33 offen sc1
    v_mfma_f32_16x16x32_bf16 v[16:19], v[68:71], v[216:219], v[16:19]
    ds_read_b64_tr_b16 v[124:125], v3 offset:57376
    v_mfma_f32_16x16x32_bf16 v[20:23], v[68:71], v[220:223], v[20:23]
    ds_read_b64_tr_b16 v[126:127], v3 offset:60960
    v_mfma_f32_16x16x32_bf16 v[24:27], v[72:75], v[216:219], v[24:27]
    ds_read_b64_tr_b16 v[128:129], v3 offset:57408
    buffer_load_dwordx4 v[212:215], v5, s[8:11], s33 offen sc1
    v_mfma_f32_16x16x32_bf16 v[28:31], v[72:75], v[220:223], v[28:31]
    ds_read_b64_tr_b16 v[130:131], v3 offset:60992
    v_mfma_f32_16x16x32_bf16 v[32:35], v[76:79], v[216:219], v[32:35]
    ds_read_b64_tr_b16 v[132:133], v3 offset:57440
    v_mfma_f32_16x16x32_bf16 v[36:39], v[76:79], v[220:223], v[36:39]
    ds_read_b64_tr_b16 v[134:135], v3 offset:61024
    v_mfma_f32_16x16x32_bf16 v[40:43], v[80:83], v[216:219], v[40:43]
    ds_read_b64_tr_b16 v[136:137], v3 offset:57472
    s_waitcnt vmcnt(16)
SVB_79:
    v_max3_u32 v252, v224, v226, v228
    v_max_u32 v252, v252, v230
    v_cmp_eq_u32 vcc, -1, v252
    s_nop 0
    s_cbranch_vccnz SVS_80
    v_swap_b32 v226, v228
    v_swap_b32 v227, v229
SVB_79_AFTER:
    v_mfma_f32_16x16x32_bf16 v[44:47], v[80:83], v[220:223], v[44:47]
    ds_read_b64_tr_b16 v[138:139], v3 offset:61056
    v_mfma_f32_16x16x32_bf16 v[48:51], v[84:87], v[216:219], v[48:51]
    ds_read_b64_tr_b16 v[140:141], v3 offset:57504
    v_mfma_f32_16x16x32_bf16 v[52:55], v[84:87], v[220:223], v[52:55]
    ds_read_b64_tr_b16 v[142:143], v3 offset:61088
    v_mfma_f32_16x16x32_bf16 v[56:59], v[88:91], v[216:219], v[56:59]
    ds_read_b64_tr_b16 v[144:145], v3 offset:57536
    v_mfma_f32_16x16x32_bf16 v[60:63], v[88:91], v[220:223], v[60:63]
    ds_read_b64_tr_b16 v[146:147], v3 offset:61120
    v_mfma_f32_16x16x32_bf16 v[156:159], v[216:219], v[216:219], v[156:159]
    v_mfma_f32_16x16x32_bf16 v[160:163], v[220:223], v[220:223], v[160:163]
    s_waitcnt lgkmcnt(14)
    v_mfma_f32_16x16x32_bf16 v[8:11], v[92:95], v[224:227], v[8:11]
    ds_read_b64_tr_b16 v[64:65], v3 offset:64512
    v_mfma_f32_16x16x32_bf16 v[12:15], v[92:95], v[228:231], v[12:15]
    ds_read_b64_tr_b16 v[66:67], v2 offset:2560
    s_add_u32 s33, s26, 2097152
    buffer_load_dwordx4 v[216:219], v4, s[8:11], s33 offen sc1
    v_mfma_f32_16x16x32_bf16 v[16:19], v[96:99], v[224:227], v[16:19]
    ds_read_b64_tr_b16 v[68:69], v3 offset:64544
    v_mfma_f32_16x16x32_bf16 v[20:23], v[96:99], v[228:231], v[20:23]
    ds_read_b64_tr_b16 v[70:71], v2 offset:2592
    v_mfma_f32_16x16x32_bf16 v[24:27], v[100:103], v[224:227], v[24:27]
    ds_read_b64_tr_b16 v[72:73], v3 offset:64576
    buffer_load_dwordx4 v[220:223], v5, s[8:11], s33 offen sc1
    v_mfma_f32_16x16x32_bf16 v[28:31], v[100:103], v[228:231], v[28:31]
    ds_read_b64_tr_b16 v[74:75], v2 offset:2624
    v_mfma_f32_16x16x32_bf16 v[32:35], v[104:107], v[224:227], v[32:35]
    ds_read_b64_tr_b16 v[76:77], v3 offset:64608
    v_mfma_f32_16x16x32_bf16 v[36:39], v[104:107], v[228:231], v[36:39]
    ds_read_b64_tr_b16 v[78:79], v2 offset:2656
    v_mfma_f32_16x16x32_bf16 v[40:43], v[108:111], v[224:227], v[40:43]
    ds_read_b64_tr_b16 v[80:81], v3 offset:64640
    s_waitcnt vmcnt(16)
SVB_81:
    v_max3_u32 v252, v232, v234, v236
    v_max_u32 v252, v252, v238
    v_cmp_eq_u32 vcc, -1, v252
    s_nop 0
    s_cbranch_vccnz SVS_82
    v_swap_b32 v234, v236
    v_swap_b32 v235, v237
SVB_81_AFTER:
    v_mfma_f32_16x16x32_bf16 v[44:47], v[108:111], v[228:231], v[44:47]
    ds_read_b64_tr_b16 v[82:83], v2 offset:2688
    v_mfma_f32_16x16x32_bf16 v[48:51], v[112:115], v[224:227], v[48:51]
    ds_read_b64_tr_b16 v[84:85], v3 offset:64672
    v_mfma_f32_16x16x32_bf16 v[52:55], v[112:115], v[228:231], v[52:55]
    ds_read_b64_tr_b16 v[86:87], v2 offset:2720
    v_mfma_f32_16x16x32_bf16 v[56:59], v[116:119], v[224:227], v[56:59]
    ds_read_b64_tr_b16 v[88:89], v3 offset:64704
    v_mfma_f32_16x16x32_bf16 v[60:63], v[116:119], v[228:231], v[60:63]
    ds_read_b64_tr_b16 v[90:91], v2 offset:2752
    v_mfma_f32_16x16x32_bf16 v[156:159], v[224:227], v[224:227], v[156:159]
    v_mfma_f32_16x16x32_bf16 v[160:163], v[228:231], v[228:231], v[160:163]
    s_waitcnt lgkmcnt(14)
    v_mfma_f32_16x16x32_bf16 v[8:11], v[120:123], v[232:235], v[8:11]
    ds_read_b64_tr_b16 v[92:93], v2 offset:6144
    v_mfma_f32_16x16x32_bf16 v[12:15], v[120:123], v[236:239], v[12:15]
    ds_read_b64_tr_b16 v[94:95], v2 offset:9728
    s_add_u32 s33, s26, 2228224
    buffer_load_dwordx4 v[224:227], v4, s[8:11], s33 offen sc1
    v_mfma_f32_16x16x32_bf16 v[16:19], v[124:127], v[232:235], v[16:19]
    ds_read_b64_tr_b16 v[96:97], v2 offset:6176
    v_mfma_f32_16x16x32_bf16 v[20:23], v[124:127], v[236:239], v[20:23]
    ds_read_b64_tr_b16 v[98:99], v2 offset:9760
    v_mfma_f32_16x16x32_bf16 v[24:27], v[128:131], v[232:235], v[24:27]
    ds_read_b64_tr_b16 v[100:101], v2 offset:6208
    buffer_load_dwordx4 v[228:231], v5, s[8:11], s33 offen sc1
    v_mfma_f32_16x16x32_bf16 v[28:31], v[128:131], v[236:239], v[28:31]
    ds_read_b64_tr_b16 v[102:103], v2 offset:9792
    v_mfma_f32_16x16x32_bf16 v[32:35], v[132:135], v[232:235], v[32:35]
    ds_read_b64_tr_b16 v[104:105], v2 offset:6240
    v_mfma_f32_16x16x32_bf16 v[36:39], v[132:135], v[236:239], v[36:39]
    ds_read_b64_tr_b16 v[106:107], v2 offset:9824
    v_mfma_f32_16x16x32_bf16 v[40:43], v[136:139], v[232:235], v[40:43]
    ds_read_b64_tr_b16 v[108:109], v2 offset:6272
    s_waitcnt vmcnt(16)
SVB_83:
    v_max3_u32 v252, v240, v242, v244
    v_max_u32 v252, v252, v246
    v_cmp_eq_u32 vcc, -1, v252
    s_nop 0
    s_cbranch_vccnz SVS_84
    v_swap_b32 v242, v244
    v_swap_b32 v243, v245
SVB_83_AFTER:
    v_mfma_f32_16x16x32_bf16 v[44:47], v[136:139], v[236:239], v[44:47]
    ds_read_b64_tr_b16 v[110:111], v2 offset:9856
    v_mfma_f32_16x16x32_bf16 v[48:51], v[140:143], v[232:235], v[48:51]
    ds_read_b64_tr_b16 v[112:113], v2 offset:6304
    v_mfma_f32_16x16x32_bf16 v[52:55], v[140:143], v[236:239], v[52:55]
    ds_read_b64_tr_b16 v[114:115], v2 offset:9888
    v_mfma_f32_16x16x32_bf16 v[56:59], v[144:147], v[232:235], v[56:59]
    ds_read_b64_tr_b16 v[116:117], v2 offset:6336
    v_mfma_f32_16x16x32_bf16 v[60:63], v[144:147], v[236:239], v[60:63]
    ds_read_b64_tr_b16 v[118:119], v2 offset:9920
    v_mfma_f32_16x16x32_bf16 v[156:159], v[232:235], v[232:235], v[156:159]
    v_mfma_f32_16x16x32_bf16 v[160:163], v[236:239], v[236:239], v[160:163]
    s_waitcnt lgkmcnt(14)
    v_mfma_f32_16x16x32_bf16 v[8:11], v[64:67], v[240:243], v[8:11]
    ds_read_b64_tr_b16 v[120:121], v2 offset:13312
    v_mfma_f32_16x16x32_bf16 v[12:15], v[64:67], v[244:247], v[12:15]
    ds_read_b64_tr_b16 v[122:123], v2 offset:16896
    s_add_u32 s33, s26, 2359296
    buffer_load_dwordx4 v[232:235], v4, s[8:11], s33 offen sc1
    v_mfma_f32_16x16x32_bf16 v[16:19], v[68:71], v[240:243], v[16:19]
    ds_read_b64_tr_b16 v[124:125], v2 offset:13344
    v_mfma_f32_16x16x32_bf16 v[20:23], v[68:71], v[244:247], v[20:23]
    ds_read_b64_tr_b16 v[126:127], v2 offset:16928
    v_mfma_f32_16x16x32_bf16 v[24:27], v[72:75], v[240:243], v[24:27]
    ds_read_b64_tr_b16 v[128:129], v2 offset:13376
    buffer_load_dwordx4 v[236:239], v5, s[8:11], s33 offen sc1
    v_mfma_f32_16x16x32_bf16 v[28:31], v[72:75], v[244:247], v[28:31]
    ds_read_b64_tr_b16 v[130:131], v2 offset:16960
    v_mfma_f32_16x16x32_bf16 v[32:35], v[76:79], v[240:243], v[32:35]
    ds_read_b64_tr_b16 v[132:133], v2 offset:13408
    v_mfma_f32_16x16x32_bf16 v[36:39], v[76:79], v[244:247], v[36:39]
    ds_read_b64_tr_b16 v[134:135], v2 offset:16992
    v_mfma_f32_16x16x32_bf16 v[40:43], v[80:83], v[240:243], v[40:43]
    ds_read_b64_tr_b16 v[136:137], v2 offset:13440
    s_waitcnt vmcnt(16)
SVB_85:
    v_max3_u32 v252, v168, v170, v172
    v_max_u32 v252, v252, v174
    v_cmp_eq_u32 vcc, -1, v252
    s_nop 0
    s_cbranch_vccnz SVS_86
    v_swap_b32 v170, v172
    v_swap_b32 v171, v173
SVB_85_AFTER:
    v_mfma_f32_16x16x32_bf16 v[44:47], v[80:83], v[244:247], v[44:47]
    ds_read_b64_tr_b16 v[138:139], v2 offset:17024
    v_mfma_f32_16x16x32_bf16 v[48:51], v[84:87], v[240:243], v[48:51]
    ds_read_b64_tr_b16 v[140:141], v2 offset:13472
    v_mfma_f32_16x16x32_bf16 v[52:55], v[84:87], v[244:247], v[52:55]
    ds_read_b64_tr_b16 v[142:143], v2 offset:17056
    v_mfma_f32_16x16x32_bf16 v[56:59], v[88:91], v[240:243], v[56:59]
    ds_read_b64_tr_b16 v[144:145], v2 offset:13504
    v_mfma_f32_16x16x32_bf16 v[60:63], v[88:91], v[244:247], v[60:63]
    ds_read_b64_tr_b16 v[146:147], v2 offset:17088
    v_mfma_f32_16x16x32_bf16 v[156:159], v[240:243], v[240:243], v[156:159]
    v_mfma_f32_16x16x32_bf16 v[160:163], v[244:247], v[244:247], v[160:163]
    s_waitcnt lgkmcnt(14)
    v_mfma_f32_16x16x32_bf16 v[8:11], v[92:95], v[168:171], v[8:11]
    ds_read_b64_tr_b16 v[64:65], v2 offset:20480
    v_mfma_f32_16x16x32_bf16 v[12:15], v[92:95], v[172:175], v[12:15]
    ds_read_b64_tr_b16 v[66:67], v2 offset:24064
    s_add_u32 s33, s26, 2490368
    buffer_load_dwordx4 v[240:243], v4, s[8:11], s33 offen sc1
    v_mfma_f32_16x16x32_bf16 v[16:19], v[96:99], v[168:171], v[16:19]
    ds_read_b64_tr_b16 v[68:69], v2 offset:20512
    v_mfma_f32_16x16x32_bf16 v[20:23], v[96:99], v[172:175], v[20:23]
    ds_read_b64_tr_b16 v[70:71], v2 offset:24096
    v_mfma_f32_16x16x32_bf16 v[24:27], v[100:103], v[168:171], v[24:27]
    ds_read_b64_tr_b16 v[72:73], v2 offset:20544
    buffer_load_dwordx4 v[244:247], v5, s[8:11], s33 offen sc1
    v_mfma_f32_16x16x32_bf16 v[28:31], v[100:103], v[172:175], v[28:31]
    ds_read_b64_tr_b16 v[74:75], v2 offset:24128
    v_mfma_f32_16x16x32_bf16 v[32:35], v[104:107], v[168:171], v[32:35]
    ds_read_b64_tr_b16 v[76:77], v2 offset:20576
    v_mfma_f32_16x16x32_bf16 v[36:39], v[104:107], v[172:175], v[36:39]
    ds_read_b64_tr_b16 v[78:79], v2 offset:24160
    v_mfma_f32_16x16x32_bf16 v[40:43], v[108:111], v[168:171], v[40:43]
    ds_read_b64_tr_b16 v[80:81], v2 offset:20608
    s_waitcnt vmcnt(16)
SVB_87:
    v_max3_u32 v252, v176, v178, v180
    v_max_u32 v252, v252, v182
    v_cmp_eq_u32 vcc, -1, v252
    s_nop 0
    s_cbranch_vccnz SVS_88
    v_swap_b32 v178, v180
    v_swap_b32 v179, v181
SVB_87_AFTER:
    v_mfma_f32_16x16x32_bf16 v[44:47], v[108:111], v[172:175], v[44:47]
    ds_read_b64_tr_b16 v[82:83], v2 offset:24192
    v_mfma_f32_16x16x32_bf16 v[48:51], v[112:115], v[168:171], v[48:51]
    ds_read_b64_tr_b16 v[84:85], v2 offset:20640
    v_mfma_f32_16x16x32_bf16 v[52:55], v[112:115], v[172:175], v[52:55]
    ds_read_b64_tr_b16 v[86:87], v2 offset:24224
    v_mfma_f32_16x16x32_bf16 v[56:59], v[116:119], v[168:171], v[56:59]
    ds_read_b64_tr_b16 v[88:89], v2 offset:20672
    v_mfma_f32_16x16x32_bf16 v[60:63], v[116:119], v[172:175], v[60:63]
    ds_read_b64_tr_b16 v[90:91], v2 offset:24256
    v_mfma_f32_16x16x32_bf16 v[156:159], v[168:171], v[168:171], v[156:159]
    v_mfma_f32_16x16x32_bf16 v[160:163], v[172:175], v[172:175], v[160:163]
    s_waitcnt lgkmcnt(14)
    v_mfma_f32_16x16x32_bf16 v[8:11], v[120:123], v[176:179], v[8:11]
    ds_read_b64_tr_b16 v[92:93], v2 offset:27648
    v_mfma_f32_16x16x32_bf16 v[12:15], v[120:123], v[180:183], v[12:15]
    ds_read_b64_tr_b16 v[94:95], v2 offset:31232
    v_mfma_f32_16x16x32_bf16 v[16:19], v[124:127], v[176:179], v[16:19]
    ds_read_b64_tr_b16 v[96:97], v2 offset:27680
    v_mfma_f32_16x16x32_bf16 v[20:23], v[124:127], v[180:183], v[20:23]
    ds_read_b64_tr_b16 v[98:99], v2 offset:31264
    v_mfma_f32_16x16x32_bf16 v[24:27], v[128:131], v[176:179], v[24:27]
    ds_read_b64_tr_b16 v[100:101], v2 offset:27712
    v_mfma_f32_16x16x32_bf16 v[28:31], v[128:131], v[180:183], v[28:31]
    ds_read_b64_tr_b16 v[102:103], v2 offset:31296
    v_mfma_f32_16x16x32_bf16 v[32:35], v[132:135], v[176:179], v[32:35]
    ds_read_b64_tr_b16 v[104:105], v2 offset:27744
    v_mfma_f32_16x16x32_bf16 v[36:39], v[132:135], v[180:183], v[36:39]
    ds_read_b64_tr_b16 v[106:107], v2 offset:31328
    v_mfma_f32_16x16x32_bf16 v[40:43], v[136:139], v[176:179], v[40:43]
    ds_read_b64_tr_b16 v[108:109], v2 offset:27776
    s_waitcnt vmcnt(14)
SVB_89:
    v_max3_u32 v252, v184, v186, v188
    v_max_u32 v252, v252, v190
    v_cmp_eq_u32 vcc, -1, v252
    s_nop 0
    s_cbranch_vccnz SVS_90
    v_swap_b32 v186, v188
    v_swap_b32 v187, v189
SVB_89_AFTER:
    v_mfma_f32_16x16x32_bf16 v[44:47], v[136:139], v[180:183], v[44:47]
    ds_read_b64_tr_b16 v[110:111], v2 offset:31360
    v_mfma_f32_16x16x32_bf16 v[48:51], v[140:143], v[176:179], v[48:51]
    ds_read_b64_tr_b16 v[112:113], v2 offset:27808
    v_mfma_f32_16x16x32_bf16 v[52:55], v[140:143], v[180:183], v[52:55]
    ds_read_b64_tr_b16 v[114:115], v2 offset:31392
    v_mfma_f32_16x16x32_bf16 v[56:59], v[144:147], v[176:179], v[56:59]
    ds_read_b64_tr_b16 v[116:117], v2 offset:27840
    v_mfma_f32_16x16x32_bf16 v[60:63], v[144:147], v[180:183], v[60:63]
    ds_read_b64_tr_b16 v[118:119], v2 offset:31424
    v_mfma_f32_16x16x32_bf16 v[156:159], v[176:179], v[176:179], v[156:159]
    v_mfma_f32_16x16x32_bf16 v[160:163], v[180:183], v[180:183], v[160:163]
    s_waitcnt lgkmcnt(14)
    v_mfma_f32_16x16x32_bf16 v[8:11], v[64:67], v[184:187], v[8:11]
    ds_read_b64_tr_b16 v[120:121], v2 offset:34816
    v_mfma_f32_16x16x32_bf16 v[12:15], v[64:67], v[188:191], v[12:15]
    ds_read_b64_tr_b16 v[122:123], v2 offset:38400
    v_mfma_f32_16x16x32_bf16 v[16:19], v[68:71], v[184:187], v[16:19]
    ds_read_b64_tr_b16 v[124:125], v2 offset:34848
    v_mfma_f32_16x16x32_bf16 v[20:23], v[68:71], v[188:191], v[20:23]
    ds_read_b64_tr_b16 v[126:127], v2 offset:38432
    v_mfma_f32_16x16x32_bf16 v[24:27], v[72:75], v[184:187], v[24:27]
    ds_read_b64_tr_b16 v[128:129], v2 offset:34880
    v_mfma_f32_16x16x32_bf16 v[28:31], v[72:75], v[188:191], v[28:31]
    ds_read_b64_tr_b16 v[130:131], v2 offset:38464
    v_mfma_f32_16x16x32_bf16 v[32:35], v[76:79], v[184:187], v[32:35]
    ds_read_b64_tr_b16 v[132:133], v2 offset:34912
    v_mfma_f32_16x16x32_bf16 v[36:39], v[76:79], v[188:191], v[36:39]
    ds_read_b64_tr_b16 v[134:135], v2 offset:38496
    v_mfma_f32_16x16x32_bf16 v[40:43], v[80:83], v[184:187], v[40:43]
    ds_read_b64_tr_b16 v[136:137], v2 offset:34944
    s_waitcnt vmcnt(12)
SVB_91:
    v_max3_u32 v252, v192, v194, v196
    v_max_u32 v252, v252, v198
    v_cmp_eq_u32 vcc, -1, v252
    s_nop 0
    s_cbranch_vccnz SVS_92
    v_swap_b32 v194, v196
    v_swap_b32 v195, v197
SVB_91_AFTER:
    v_mfma_f32_16x16x32_bf16 v[44:47], v[80:83], v[188:191], v[44:47]
    ds_read_b64_tr_b16 v[138:139], v2 offset:38528
    v_mfma_f32_16x16x32_bf16 v[48:51], v[84:87], v[184:187], v[48:51]
    ds_read_b64_tr_b16 v[140:141], v2 offset:34976
    v_mfma_f32_16x16x32_bf16 v[52:55], v[84:87], v[188:191], v[52:55]
    ds_read_b64_tr_b16 v[142:143], v2 offset:38560
    v_mfma_f32_16x16x32_bf16 v[56:59], v[88:91], v[184:187], v[56:59]
    ds_read_b64_tr_b16 v[144:145], v2 offset:35008
    v_mfma_f32_16x16x32_bf16 v[60:63], v[88:91], v[188:191], v[60:63]
    ds_read_b64_tr_b16 v[146:147], v2 offset:38592
    v_mfma_f32_16x16x32_bf16 v[156:159], v[184:187], v[184:187], v[156:159]
    v_mfma_f32_16x16x32_bf16 v[160:163], v[188:191], v[188:191], v[160:163]
    s_waitcnt lgkmcnt(14)
    v_mfma_f32_16x16x32_bf16 v[8:11], v[92:95], v[192:195], v[8:11]
    ds_read_b64_tr_b16 v[64:65], v2 offset:41984
    v_mfma_f32_16x16x32_bf16 v[12:15], v[92:95], v[196:199], v[12:15]
    ds_read_b64_tr_b16 v[66:67], v2 offset:45568
    v_mfma_f32_16x16x32_bf16 v[16:19], v[96:99], v[192:195], v[16:19]
    ds_read_b64_tr_b16 v[68:69], v2 offset:42016
    v_mfma_f32_16x16x32_bf16 v[20:23], v[96:99], v[196:199], v[20:23]
    ds_read_b64_tr_b16 v[70:71], v2 offset:45600
    v_mfma_f32_16x16x32_bf16 v[24:27], v[100:103], v[192:195], v[24:27]
    ds_read_b64_tr_b16 v[72:73], v2 offset:42048
    v_mfma_f32_16x16x32_bf16 v[28:31], v[100:103], v[196:199], v[28:31]
    ds_read_b64_tr_b16 v[74:75], v2 offset:45632
    v_mfma_f32_16x16x32_bf16 v[32:35], v[104:107], v[192:195], v[32:35]
    ds_read_b64_tr_b16 v[76:77], v2 offset:42080
    v_mfma_f32_16x16x32_bf16 v[36:39], v[104:107], v[196:199], v[36:39]
    ds_read_b64_tr_b16 v[78:79], v2 offset:45664
    v_mfma_f32_16x16x32_bf16 v[40:43], v[108:111], v[192:195], v[40:43]
    ds_read_b64_tr_b16 v[80:81], v2 offset:42112
    s_waitcnt vmcnt(10)
SVB_93:
    v_max3_u32 v252, v200, v202, v204
    v_max_u32 v252, v252, v206
    v_cmp_eq_u32 vcc, -1, v252
    s_nop 0
    s_cbranch_vccnz SVS_94
    v_swap_b32 v202, v204
    v_swap_b32 v203, v205
SVB_93_AFTER:
    v_mfma_f32_16x16x32_bf16 v[44:47], v[108:111], v[196:199], v[44:47]
    ds_read_b64_tr_b16 v[82:83], v2 offset:45696
    v_mfma_f32_16x16x32_bf16 v[48:51], v[112:115], v[192:195], v[48:51]
    ds_read_b64_tr_b16 v[84:85], v2 offset:42144
    v_mfma_f32_16x16x32_bf16 v[52:55], v[112:115], v[196:199], v[52:55]
    ds_read_b64_tr_b16 v[86:87], v2 offset:45728
    v_mfma_f32_16x16x32_bf16 v[56:59], v[116:119], v[192:195], v[56:59]
    ds_read_b64_tr_b16 v[88:89], v2 offset:42176
    v_mfma_f32_16x16x32_bf16 v[60:63], v[116:119], v[196:199], v[60:63]
    ds_read_b64_tr_b16 v[90:91], v2 offset:45760
    v_mfma_f32_16x16x32_bf16 v[156:159], v[192:195], v[192:195], v[156:159]
    v_mfma_f32_16x16x32_bf16 v[160:163], v[196:199], v[196:199], v[160:163]
    s_waitcnt lgkmcnt(14)
    v_mfma_f32_16x16x32_bf16 v[8:11], v[120:123], v[200:203], v[8:11]
    ds_read_b64_tr_b16 v[92:93], v2 offset:49152
    v_mfma_f32_16x16x32_bf16 v[12:15], v[120:123], v[204:207], v[12:15]
    ds_read_b64_tr_b16 v[94:95], v2 offset:52736
    v_mfma_f32_16x16x32_bf16 v[16:19], v[124:127], v[200:203], v[16:19]
    ds_read_b64_tr_b16 v[96:97], v2 offset:49184
    v_mfma_f32_16x16x32_bf16 v[20:23], v[124:127], v[204:207], v[20:23]
    ds_read_b64_tr_b16 v[98:99], v2 offset:52768
    v_mfma_f32_16x16x32_bf16 v[24:27], v[128:131], v[200:203], v[24:27]
    ds_read_b64_tr_b16 v[100:101], v2 offset:49216
    v_mfma_f32_16x16x32_bf16 v[28:31], v[128:131], v[204:207], v[28:31]
    ds_read_b64_tr_b16 v[102:103], v2 offset:52800
    v_mfma_f32_16x16x32_bf16 v[32:35], v[132:135], v[200:203], v[32:35]
    ds_read_b64_tr_b16 v[104:105], v2 offset:49248
    v_mfma_f32_16x16x32_bf16 v[36:39], v[132:135], v[204:207], v[36:39]
    ds_read_b64_tr_b16 v[106:107], v2 offset:52832
    v_mfma_f32_16x16x32_bf16 v[40:43], v[136:139], v[200:203], v[40:43]
    ds_read_b64_tr_b16 v[108:109], v2 offset:49280
    s_waitcnt vmcnt(8)
SVB_95:
    v_max3_u32 v252, v208, v210, v212
    v_max_u32 v252, v252, v214
    v_cmp_eq_u32 vcc, -1, v252
    s_nop 0
    s_cbranch_vccnz SVS_96
    v_swap_b32 v210, v212
    v_swap_b32 v211, v213
SVB_95_AFTER:
    v_mfma_f32_16x16x32_bf16 v[44:47], v[136:139], v[204:207], v[44:47]
    ds_read_b64_tr_b16 v[110:111], v2 offset:52864
    v_mfma_f32_16x16x32_bf16 v[48:51], v[140:143], v[200:203], v[48:51]
    ds_read_b64_tr_b16 v[112:113], v2 offset:49312
    v_mfma_f32_16x16x32_bf16 v[52:55], v[140:143], v[204:207], v[52:55]
    ds_read_b64_tr_b16 v[114:115], v2 offset:52896
    v_mfma_f32_16x16x32_bf16 v[56:59], v[144:147], v[200:203], v[56:59]
    ds_read_b64_tr_b16 v[116:117], v2 offset:49344
    v_mfma_f32_16x16x32_bf16 v[60:63], v[144:147], v[204:207], v[60:63]
    ds_read_b64_tr_b16 v[118:119], v2 offset:52928
    v_mfma_f32_16x16x32_bf16 v[156:159], v[200:203], v[200:203], v[156:159]
    v_mfma_f32_16x16x32_bf16 v[160:163], v[204:207], v[204:207], v[160:163]
    s_waitcnt lgkmcnt(14)
    v_mfma_f32_16x16x32_bf16 v[8:11], v[64:67], v[208:211], v[8:11]
    ds_read_b64_tr_b16 v[120:121], v2 offset:56320
    v_mfma_f32_16x16x32_bf16 v[12:15], v[64:67], v[212:215], v[12:15]
    ds_read_b64_tr_b16 v[122:123], v2 offset:59904
    v_mfma_f32_16x16x32_bf16 v[16:19], v[68:71], v[208:211], v[16:19]
    ds_read_b64_tr_b16 v[124:125], v2 offset:56352
    v_mfma_f32_16x16x32_bf16 v[20:23], v[68:71], v[212:215], v[20:23]
    ds_read_b64_tr_b16 v[126:127], v2 offset:59936
    v_mfma_f32_16x16x32_bf16 v[24:27], v[72:75], v[208:211], v[24:27]
    ds_read_b64_tr_b16 v[128:129], v2 offset:56384
    v_mfma_f32_16x16x32_bf16 v[28:31], v[72:75], v[212:215], v[28:31]
    ds_read_b64_tr_b16 v[130:131], v2 offset:59968
    v_mfma_f32_16x16x32_bf16 v[32:35], v[76:79], v[208:211], v[32:35]
    ds_read_b64_tr_b16 v[132:133], v2 offset:56416
    v_mfma_f32_16x16x32_bf16 v[36:39], v[76:79], v[212:215], v[36:39]
    ds_read_b64_tr_b16 v[134:135], v2 offset:60000
    v_mfma_f32_16x16x32_bf16 v[40:43], v[80:83], v[208:211], v[40:43]
    ds_read_b64_tr_b16 v[136:137], v2 offset:56448
    s_waitcnt vmcnt(6)
SVB_97:
    v_max3_u32 v252, v216, v218, v220
    v_max_u32 v252, v252, v222
    v_cmp_eq_u32 vcc, -1, v252
    s_nop 0
    s_cbranch_vccnz SVS_98
    v_swap_b32 v218, v220
    v_swap_b32 v219, v221
SVB_97_AFTER:
    v_mfma_f32_16x16x32_bf16 v[44:47], v[80:83], v[212:215], v[44:47]
    ds_read_b64_tr_b16 v[138:139], v2 offset:60032
    v_mfma_f32_16x16x32_bf16 v[48:51], v[84:87], v[208:211], v[48:51]
    ds_read_b64_tr_b16 v[140:141], v2 offset:56480
    v_mfma_f32_16x16x32_bf16 v[52:55], v[84:87], v[212:215], v[52:55]
    ds_read_b64_tr_b16 v[142:143], v2 offset:60064
    v_mfma_f32_16x16x32_bf16 v[56:59], v[88:91], v[208:211], v[56:59]
    ds_read_b64_tr_b16 v[144:145], v2 offset:56512
    v_mfma_f32_16x16x32_bf16 v[60:63], v[88:91], v[212:215], v[60:63]
    ds_read_b64_tr_b16 v[146:147], v2 offset:60096
    v_mfma_f32_16x16x32_bf16 v[156:159], v[208:211], v[208:211], v[156:159]
    v_mfma_f32_16x16x32_bf16 v[160:163], v[212:215], v[212:215], v[160:163]
    s_waitcnt lgkmcnt(14)
    v_mfma_f32_16x16x32_bf16 v[8:11], v[92:95], v[216:219], v[8:11]
    ds_read_b64_tr_b16 v[64:65], v2 offset:63488
    v_mfma_f32_16x16x32_bf16 v[12:15], v[92:95], v[220:223], v[12:15]
    ds_read_b64_tr_b16 v[66:67], v1 offset:1536
    v_mfma_f32_16x16x32_bf16 v[16:19], v[96:99], v[216:219], v[16:19]
    ds_read_b64_tr_b16 v[68:69], v2 offset:63520
    v_mfma_f32_16x16x32_bf16 v[20:23], v[96:99], v[220:223], v[20:23]
    ds_read_b64_tr_b16 v[70:71], v1 offset:1568
    v_mfma_f32_16x16x32_bf16 v[24:27], v[100:103], v[216:219], v[24:27]
    ds_read_b64_tr_b16 v[72:73], v2 offset:63552
    v_mfma_f32_16x16x32_bf16 v[28:31], v[100:103], v[220:223], v[28:31]
    ds_read_b64_tr_b16 v[74:75], v1 offset:1600
    v_mfma_f32_16x16x32_bf16 v[32:35], v[104:107], v[216:219], v[32:35]
    ds_read_b64_tr_b16 v[76:77], v2 offset:63584
    v_mfma_f32_16x16x32_bf16 v[36:39], v[104:107], v[220:223], v[36:39]
    ds_read_b64_tr_b16 v[78:79], v1 offset:1632
    v_mfma_f32_16x16x32_bf16 v[40:43], v[108:111], v[216:219], v[40:43]
    ds_read_b64_tr_b16 v[80:81], v2 offset:63616
    s_waitcnt vmcnt(4)
SVB_99:
    v_max3_u32 v252, v224, v226, v228
    v_max_u32 v252, v252, v230
    v_cmp_eq_u32 vcc, -1, v252
    s_nop 0
    s_cbranch_vccnz SVS_100
    v_swap_b32 v226, v228
    v_swap_b32 v227, v229
SVB_99_AFTER:
    v_mfma_f32_16x16x32_bf16 v[44:47], v[108:111], v[220:223], v[44:47]
    ds_read_b64_tr_b16 v[82:83], v1 offset:1664
    v_mfma_f32_16x16x32_bf16 v[48:51], v[112:115], v[216:219], v[48:51]
    ds_read_b64_tr_b16 v[84:85], v2 offset:63648
    v_mfma_f32_16x16x32_bf16 v[52:55], v[112:115], v[220:223], v[52:55]
    ds_read_b64_tr_b16 v[86:87], v1 offset:1696
    v_mfma_f32_16x16x32_bf16 v[56:59], v[116:119], v[216:219], v[56:59]
    ds_read_b64_tr_b16 v[88:89], v2 offset:63680
    v_mfma_f32_16x16x32_bf16 v[60:63], v[116:119], v[220:223], v[60:63]
    ds_read_b64_tr_b16 v[90:91], v1 offset:1728
    v_mfma_f32_16x16x32_bf16 v[156:159], v[216:219], v[216:219], v[156:159]
    v_mfma_f32_16x16x32_bf16 v[160:163], v[220:223], v[220:223], v[160:163]
    s_waitcnt lgkmcnt(14)
    v_mfma_f32_16x16x32_bf16 v[8:11], v[120:123], v[224:227], v[8:11]
    ds_read_b64_tr_b16 v[92:93], v1 offset:5120
    v_mfma_f32_16x16x32_bf16 v[12:15], v[120:123], v[228:231], v[12:15]
    ds_read_b64_tr_b16 v[94:95], v1 offset:8704
    v_mfma_f32_16x16x32_bf16 v[16:19], v[124:127], v[224:227], v[16:19]
    ds_read_b64_tr_b16 v[96:97], v1 offset:5152
    v_mfma_f32_16x16x32_bf16 v[20:23], v[124:127], v[228:231], v[20:23]
    ds_read_b64_tr_b16 v[98:99], v1 offset:8736
    v_mfma_f32_16x16x32_bf16 v[24:27], v[128:131], v[224:227], v[24:27]
    ds_read_b64_tr_b16 v[100:101], v1 offset:5184
    v_mfma_f32_16x16x32_bf16 v[28:31], v[128:131], v[228:231], v[28:31]
    ds_read_b64_tr_b16 v[102:103], v1 offset:8768
    v_mfma_f32_16x16x32_bf16 v[32:35], v[132:135], v[224:227], v[32:35]
    ds_read_b64_tr_b16 v[104:105], v1 offset:5216
    v_mfma_f32_16x16x32_bf16 v[36:39], v[132:135], v[228:231], v[36:39]
    ds_read_b64_tr_b16 v[106:107], v1 offset:8800
    v_mfma_f32_16x16x32_bf16 v[40:43], v[136:139], v[224:227], v[40:43]
    ds_read_b64_tr_b16 v[108:109], v1 offset:5248
    s_waitcnt vmcnt(2)
SVB_101:
    v_max3_u32 v252, v232, v234, v236
    v_max_u32 v252, v252, v238
    v_cmp_eq_u32 vcc, -1, v252
    s_nop 0
    s_cbranch_vccnz SVS_102
    v_swap_b32 v234, v236
    v_swap_b32 v235, v237
SVB_101_AFTER:
    v_mfma_f32_16x16x32_bf16 v[44:47], v[136:139], v[228:231], v[44:47]
    ds_read_b64_tr_b16 v[110:111], v1 offset:8832
    v_mfma_f32_16x16x32_bf16 v[48:51], v[140:143], v[224:227], v[48:51]
    ds_read_b64_tr_b16 v[112:113], v1 offset:5280
    v_mfma_f32_16x16x32_bf16 v[52:55], v[140:143], v[228:231], v[52:55]
    ds_read_b64_tr_b16 v[114:115], v1 offset:8864
    v_mfma_f32_16x16x32_bf16 v[56:59], v[144:147], v[224:227], v[56:59]
    ds_read_b64_tr_b16 v[116:117], v1 offset:5312
    v_mfma_f32_16x16x32_bf16 v[60:63], v[144:147], v[228:231], v[60:63]
    ds_read_b64_tr_b16 v[118:119], v1 offset:8896
    v_mfma_f32_16x16x32_bf16 v[156:159], v[224:227], v[224:227], v[156:159]
    v_mfma_f32_16x16x32_bf16 v[160:163], v[228:231], v[228:231], v[160:163]
    s_waitcnt lgkmcnt(14)
    v_mfma_f32_16x16x32_bf16 v[8:11], v[64:67], v[232:235], v[8:11]
    v_mfma_f32_16x16x32_bf16 v[12:15], v[64:67], v[236:239], v[12:15]
    v_mfma_f32_16x16x32_bf16 v[16:19], v[68:71], v[232:235], v[16:19]
    v_mfma_f32_16x16x32_bf16 v[20:23], v[68:71], v[236:239], v[20:23]
    v_mfma_f32_16x16x32_bf16 v[24:27], v[72:75], v[232:235], v[24:27]
    v_mfma_f32_16x16x32_bf16 v[28:31], v[72:75], v[236:239], v[28:31]
    v_mfma_f32_16x16x32_bf16 v[32:35], v[76:79], v[232:235], v[32:35]
    v_mfma_f32_16x16x32_bf16 v[36:39], v[76:79], v[236:239], v[36:39]
    v_mfma_f32_16x16x32_bf16 v[40:43], v[80:83], v[232:235], v[40:43]
    s_waitcnt vmcnt(0)
SVB_103:
    v_max3_u32 v252, v240, v242, v244
    v_max_u32 v252, v252, v246
    v_cmp_eq_u32 vcc, -1, v252
    s_nop 0
    s_cbranch_vccnz SVS_104
    v_swap_b32 v242, v244
    v_swap_b32 v243, v245
SVB_103_AFTER:
    v_mfma_f32_16x16x32_bf16 v[44:47], v[80:83], v[236:239], v[44:47]
    v_mfma_f32_16x16x32_bf16 v[48:51], v[84:87], v[232:235], v[48:51]
    v_mfma_f32_16x16x32_bf16 v[52:55], v[84:87], v[236:239], v[52:55]
    v_mfma_f32_16x16x32_bf16 v[56:59], v[88:91], v[232:235], v[56:59]
    v_mfma_f32_16x16x32_bf16 v[60:63], v[88:91], v[236:239], v[60:63]
    v_mfma_f32_16x16x32_bf16 v[156:159], v[232:235], v[232:235], v[156:159]
    v_mfma_f32_16x16x32_bf16 v[160:163], v[236:239], v[236:239], v[160:163]
    s_waitcnt lgkmcnt(0)
    v_mfma_f32_16x16x32_bf16 v[8:11], v[92:95], v[240:243], v[8:11]
    v_mfma_f32_16x16x32_bf16 v[12:15], v[92:95], v[244:247], v[12:15]
    v_mfma_f32_16x16x32_bf16 v[16:19], v[96:99], v[240:243], v[16:19]
    v_mfma_f32_16x16x32_bf16 v[20:23], v[96:99], v[244:247], v[20:23]
    v_mfma_f32_16x16x32_bf16 v[24:27], v[100:103], v[240:243], v[24:27]
    v_mfma_f32_16x16x32_bf16 v[28:31], v[100:103], v[244:247], v[28:31]
    v_mfma_f32_16x16x32_bf16 v[32:35], v[104:107], v[240:243], v[32:35]
    v_mfma_f32_16x16x32_bf16 v[36:39], v[104:107], v[244:247], v[36:39]
    v_mfma_f32_16x16x32_bf16 v[40:43], v[108:111], v[240:243], v[40:43]
    v_mfma_f32_16x16x32_bf16 v[44:47], v[108:111], v[244:247], v[44:47]
    v_mfma_f32_16x16x32_bf16 v[48:51], v[112:115], v[240:243], v[48:51]
    v_mfma_f32_16x16x32_bf16 v[52:55], v[112:115], v[244:247], v[52:55]
    v_mfma_f32_16x16x32_bf16 v[56:59], v[116:119], v[240:243], v[56:59]
    v_mfma_f32_16x16x32_bf16 v[60:63], v[116:119], v[244:247], v[60:63]
    v_mfma_f32_16x16x32_bf16 v[156:159], v[240:243], v[240:243], v[156:159]
    v_mfma_f32_16x16x32_bf16 v[160:163], v[244:247], v[244:247], v[160:163]
    s_waitcnt lgkmcnt(0)
    v_mov_b32 v64, 161928
    v_mov_b32 v65, 1
    s_mov_b64 exec, 1
    ds_add_u32 v64, v65
    s_mov_b64 exec, -1
    v_and_b32 v93, 3, v6
    v_lshrrev_b32 v94, 2, v6
    v_mov_b32 v96, v156
    v_cmp_eq_u32 vcc, 1, v93
    s_nop 1
    v_cndmask_b32 v96, v96, v157, vcc
    v_cmp_eq_u32 vcc, 2, v93
    s_nop 1
    v_cndmask_b32 v96, v96, v158, vcc
    v_cmp_eq_u32 vcc, 3, v93
    s_nop 1
    v_cndmask_b32 v96, v96, v159, vcc
    v_cmp_eq_u32 vcc, v94, v7
    s_nop 1
    v_cndmask_b32 v96, 0, v96, vcc
    v_mov_b32 v97, v160
    v_cmp_eq_u32 vcc, 1, v93
    s_nop 1
    v_cndmask_b32 v97, v97, v161, vcc
    v_cmp_eq_u32 vcc, 2, v93
    s_nop 1
    v_cndmask_b32 v97, v97, v162, vcc
    v_cmp_eq_u32 vcc, 3, v93
    s_nop 1
    v_cndmask_b32 v97, v97, v163, vcc
    v_cmp_eq_u32 vcc, v94, v7
    s_nop 1
    v_cndmask_b32 v97, 0, v97, vcc
    v_cmp_eq_u32 vcc, 3, v7
    s_nop 1
    v_cndmask_b32 v98, 0, v56, vcc
    v_cndmask_b32 v99, 0, v60, vcc
    v_mov_b32 v102, v96
    v_mov_b32 v103, v97
    v_mov_b32 v104, v98
    v_mov_b32 v105, v99
    v_permlane16_swap_b32 v96, v102
    v_permlane16_swap_b32 v97, v103
    v_permlane16_swap_b32 v98, v104
    v_permlane16_swap_b32 v99, v105
    v_add_f32 v96, v96, v102
    v_add_f32 v97, v97, v103
    v_add_f32 v98, v98, v104
    v_add_f32 v99, v99, v105
    v_mov_b32 v102, v96
    v_mov_b32 v103, v97
    v_mov_b32 v104, v98
    v_mov_b32 v105, v99
    v_permlane32_swap_b32 v96, v102
    v_permlane32_swap_b32 v97, v103
    v_permlane32_swap_b32 v98, v104
    v_permlane32_swap_b32 v99, v105
    v_add_f32 v96, v96, v102
    v_add_f32 v97, v97, v103
    v_add_f32 v98, v98, v104
    v_add_f32 v99, v99, v105
    v_mul_f32 v98, 0x3acccccd, v98
    v_mul_f32 v96, 0x3acccccd, v96
    v_fma_f32 v96, -v98, v98, v96
    v_add_f32 v96, 0x3727c5ac, v96
    v_rsq_f32 v96, v96
    s_nop 0
    v_mul_f32 v64, 0x3fb8aa3b, v96
    v_mul_f32 v68, v98, v64
    v_mul_f32 v99, 0x3acccccd, v99
    v_mul_f32 v97, 0x3acccccd, v97
    v_fma_f32 v97, -v99, v99, v97
    v_add_f32 v97, 0x3727c5ac, v97
    v_rsq_f32 v97, v97
    s_nop 0
    v_mul_f32 v66, 0x3fb8aa3b, v97
    v_mul_f32 v70, v99, v66
    s_add_u32 s42, s30, 0x710000
    s_mul_i32 s43, s23, 442368
    s_add_u32 s42, s42, s43
    v_mov_b32 v92, 161956
    s_mov_b32 s101, 0
LW_105:
    s_add_u32 s101, s101, 1
    s_cmp_gt_u32 s101, 4000000
    s_cbranch_scc1 LWX_106
    ds_read_b32 v93, v92
    s_waitcnt lgkmcnt(0)
    v_readfirstlane_b32 s34, v93
    s_nop 0
    s_cmp_ge_u32 s34, 1
    s_cbranch_scc1 LWX_106
    s_branch LW_105
LWX_106:
    v_lshlrev_b32 v106, 4, v7
    v_add_u32 v106, 143360, v106
    v_lshlrev_b32 v107, 3, v7
    v_add_u32 v107, 143808, v107
    ds_read_b128 v[120:123], v106 offset:0
    ds_read_b64 v[240:241], v107 offset:0
    ds_read_b128 v[124:127], v106 offset:64
    ds_read_b64 v[242:243], v107 offset:32
    ds_read_b128 v[128:131], v106 offset:128
    ds_read_b64 v[244:245], v107 offset:64
    ds_read_b128 v[132:135], v106 offset:192
    ds_read_b64 v[246:247], v107 offset:96
    ds_read_b128 v[136:139], v106 offset:256
    ds_read_b64 v[248:249], v107 offset:128
    ds_read_b128 v[140:143], v106 offset:320
    ds_read_b64 v[250:251], v107 offset:160
    ds_read_b128 v[144:147], v106 offset:384
    ds_read_b64 v[252:253], v107 offset:192
    s_waitcnt lgkmcnt(0)
    s_mov_b32 s38, 0x3fb8aa3b
    s_mov_b32 s39, 0x3fb8aa3b
    s_mov_b32 s40, 0xc0000000
    s_mov_b32 s41, 0xc0000000
    v_mov_b32 v168, 0x4038aa3b
    v_mov_b32 v169, 0x4038aa3b
    v_mov_b32 v170, 0x3f317218
    v_mov_b32 v171, 0x3f317218
    s_add_u32 s36, s42, 0
    v_lshlrev_b32 v172, 16, v240
    v_and_b32 v173, 0xffff0000, v240
    v_lshlrev_b32 v174, 16, v241
    v_and_b32 v175, 0xffff0000, v241
    v_pk_mul_f32 v[172:173], v[172:173], s[38:39]
    v_pk_mul_f32 v[174:175], v[174:175], s[38:39]
    v_pk_fma_f32 v[176:177], v[120:121], v[68:69], v[172:173] op_sel_hi:[1,0,1] neg_lo:[0,1,0] neg_hi:[0,1,0]
    v_pk_fma_f32 v[178:179], v[122:123], v[68:69], v[174:175] op_sel_hi:[1,0,1] neg_lo:[0,1,0] neg_hi:[0,1,0]
    v_pk_fma_f32 v[176:177], v[8:9], v[64:65], v[176:177] op_sel_hi:[1,0,1]
    v_pk_fma_f32 v[178:179], v[10:11], v[64:65], v[178:179] op_sel_hi:[1,0,1]
    v_pk_fma_f32 v[188:189], v[120:121], v[70:71], v[172:173] op_sel_hi:[1,0,1] neg_lo:[0,1,0] neg_hi:[0,1,0]
    v_pk_fma_f32 v[190:191], v[122:123], v[70:71], v[174:175] op_sel_hi:[1,0,1] neg_lo:[0,1,0] neg_hi:[0,1,0]
    v_pk_fma_f32 v[188:189], v[12:13], v[66:67], v[188:189] op_sel_hi:[1,0,1]
    v_pk_fma_f32 v[190:191], v[14:15], v[66:67], v[190:191] op_sel_hi:[1,0,1]
    v_exp_f32 v180, v176
    v_exp_f32 v181, v177
    v_exp_f32 v182, v178
    v_exp_f32 v183, v179
    v_exp_f32 v192, v188
    v_exp_f32 v193, v189
    v_exp_f32 v194, v190
    v_exp_f32 v195, v191
    v_pk_fma_f32 v[184:185], v[180:181], s[38:39], v[168:169]
    v_pk_fma_f32 v[186:187], v[182:183], s[38:39], v[168:169]
    v_pk_fma_f32 v[184:185], v[180:181], v[184:185], v[168:169]
    v_pk_fma_f32 v[186:187], v[182:183], v[186:187], v[168:169]
    v_pk_fma_f32 v[196:197], v[192:193], s[38:39], v[168:169]
    v_pk_fma_f32 v[198:199], v[194:195], s[38:39], v[168:169]
    v_pk_fma_f32 v[196:197], v[192:193], v[196:197], v[168:169]
    v_pk_fma_f32 v[198:199], v[194:195], v[198:199], v[168:169]
    v_rcp_f32 v184, v184
    v_rcp_f32 v185, v185
    v_rcp_f32 v186, v186
    v_rcp_f32 v187, v187
    v_rcp_f32 v196, v196
    v_rcp_f32 v197, v197
    v_rcp_f32 v198, v198
    v_rcp_f32 v199, v199
    v_pk_fma_f32 v[184:185], v[184:185], s[40:41], v[170:171]
    v_pk_fma_f32 v[186:187], v[186:187], s[40:41], v[170:171]
    v_pk_mul_f32 v[176:177], v[176:177], v[184:185]
    v_pk_mul_f32 v[178:179], v[178:179], v[186:187]
    v_cvt_pk_bf16_f32 v200, v176, v177
    v_cvt_pk_bf16_f32 v201, v178, v179
    v_pk_fma_f32 v[196:197], v[196:197], s[40:41], v[170:171]
    v_pk_fma_f32 v[198:199], v[198:199], s[40:41], v[170:171]
    v_pk_mul_f32 v[188:189], v[188:189], v[196:197]
    v_pk_mul_f32 v[190:191], v[190:191], v[198:199]
    v_cvt_pk_bf16_f32 v202, v188, v189
    v_cvt_pk_bf16_f32 v203, v190, v191
    buffer_store_dwordx4 v[200:203], v4, s[8:11], s36 offen sc1
    s_add_u32 s36, s42, 65536
    v_lshlrev_b32 v172, 16, v242
    v_and_b32 v173, 0xffff0000, v242
    v_lshlrev_b32 v174, 16, v243
    v_and_b32 v175, 0xffff0000, v243
    v_pk_mul_f32 v[172:173], v[172:173], s[38:39]
    v_pk_mul_f32 v[174:175], v[174:175], s[38:39]
    v_pk_fma_f32 v[208:209], v[124:125], v[68:69], v[172:173] op_sel_hi:[1,0,1] neg_lo:[0,1,0] neg_hi:[0,1,0]
    v_pk_fma_f32 v[210:211], v[126:127], v[68:69], v[174:175] op_sel_hi:[1,0,1] neg_lo:[0,1,0] neg_hi:[0,1,0]
    v_pk_fma_f32 v[208:209], v[16:17], v[64:65], v[208:209] op_sel_hi:[1,0,1]
    v_pk_fma_f32 v[210:211], v[18:19], v[64:65], v[210:211] op_sel_hi:[1,0,1]
    v_pk_fma_f32 v[220:221], v[124:125], v[70:71], v[172:173] op_sel_hi:[1,0,1] neg_lo:[0,1,0] neg_hi:[0,1,0]
    v_pk_fma_f32 v[222:223], v[126:127], v[70:71], v[174:175] op_sel_hi:[1,0,1] neg_lo:[0,1,0] neg_hi:[0,1,0]
    v_pk_fma_f32 v[220:221], v[20:21], v[66:67], v[220:221] op_sel_hi:[1,0,1]
    v_pk_fma_f32 v[222:223], v[22:23], v[66:67], v[222:223] op_sel_hi:[1,0,1]
    v_exp_f32 v212, v208
    v_exp_f32 v213, v209
    v_exp_f32 v214, v210
    v_exp_f32 v215, v211
    v_exp_f32 v224, v220
    v_exp_f32 v225, v221
    v_exp_f32 v226, v222
    v_exp_f32 v227, v223
    v_pk_fma_f32 v[216:217], v[212:213], s[38:39], v[168:169]
    v_pk_fma_f32 v[218:219], v[214:215], s[38:39], v[168:169]
    v_pk_fma_f32 v[216:217], v[212:213], v[216:217], v[168:169]
    v_pk_fma_f32 v[218:219], v[214:215], v[218:219], v[168:169]
    v_pk_fma_f32 v[228:229], v[224:225], s[38:39], v[168:169]
    v_pk_fma_f32 v[230:231], v[226:227], s[38:39], v[168:169]
    v_pk_fma_f32 v[228:229], v[224:225], v[228:229], v[168:169]
    v_pk_fma_f32 v[230:231], v[226:227], v[230:231], v[168:169]
    v_rcp_f32 v216, v216
    v_rcp_f32 v217, v217
    v_rcp_f32 v218, v218
    v_rcp_f32 v219, v219
    v_rcp_f32 v228, v228
    v_rcp_f32 v229, v229
    v_rcp_f32 v230, v230
    v_rcp_f32 v231, v231
    v_pk_fma_f32 v[216:217], v[216:217], s[40:41], v[170:171]
    v_pk_fma_f32 v[218:219], v[218:219], s[40:41], v[170:171]
    v_pk_mul_f32 v[208:209], v[208:209], v[216:217]
    v_pk_mul_f32 v[210:211], v[210:211], v[218:219]
    v_cvt_pk_bf16_f32 v232, v208, v209
    v_cvt_pk_bf16_f32 v233, v210, v211
    v_pk_fma_f32 v[228:229], v[228:229], s[40:41], v[170:171]
    v_pk_fma_f32 v[230:231], v[230:231], s[40:41], v[170:171]
    v_pk_mul_f32 v[220:221], v[220:221], v[228:229]
    v_pk_mul_f32 v[222:223], v[222:223], v[230:231]
    v_cvt_pk_bf16_f32 v234, v220, v221
    v_cvt_pk_bf16_f32 v235, v222, v223
    buffer_store_dwordx4 v[232:235], v4, s[8:11], s36 offen sc1
    s_add_u32 s36, s42, 131072
    v_lshlrev_b32 v172, 16, v244
    v_and_b32 v173, 0xffff0000, v244
    v_lshlrev_b32 v174, 16, v245
    v_and_b32 v175, 0xffff0000, v245
    v_pk_mul_f32 v[172:173], v[172:173], s[38:39]
    v_pk_mul_f32 v[174:175], v[174:175], s[38:39]
    v_pk_fma_f32 v[176:177], v[128:129], v[68:69], v[172:173] op_sel_hi:[1,0,1] neg_lo:[0,1,0] neg_hi:[0,1,0]
    v_pk_fma_f32 v[178:179], v[130:131], v[68:69], v[174:175] op_sel_hi:[1,0,1] neg_lo:[0,1,0] neg_hi:[0,1,0]
    v_pk_fma_f32 v[176:177], v[24:25], v[64:65], v[176:177] op_sel_hi:[1,0,1]
    v_pk_fma_f32 v[178:179], v[26:27], v[64:65], v[178:179] op_sel_hi:[1,0,1]
    v_pk_fma_f32 v[188:189], v[128:129], v[70:71], v[172:173] op_sel_hi:[1,0,1] neg_lo:[0,1,0] neg_hi:[0,1,0]
    v_pk_fma_f32 v[190:191], v[130:131], v[70:71], v[174:175] op_sel_hi:[1,0,1] neg_lo:[0,1,0] neg_hi:[0,1,0]
    v_pk_fma_f32 v[188:189], v[28:29], v[66:67], v[188:189] op_sel_hi:[1,0,1]
    v_pk_fma_f32 v[190:191], v[30:31], v[66:67], v[190:191] op_sel_hi:[1,0,1]
    v_exp_f32 v180, v176
    v_exp_f32 v181, v177
    v_exp_f32 v182, v178
    v_exp_f32 v183, v179
    v_exp_f32 v192, v188
    v_exp_f32 v193, v189
    v_exp_f32 v194, v190
    v_exp_f32 v195, v191
    v_pk_fma_f32 v[184:185], v[180:181], s[38:39], v[168:169]
    v_pk_fma_f32 v[186:187], v[182:183], s[38:39], v[168:169]
    v_pk_fma_f32 v[184:185], v[180:181], v[184:185], v[168:169]
    v_pk_fma_f32 v[186:187], v[182:183], v[186:187], v[168:169]
    v_pk_fma_f32 v[196:197], v[192:193], s[38:39], v[168:169]
    v_pk_fma_f32 v[198:199], v[194:195], s[38:39], v[168:169]
    v_pk_fma_f32 v[196:197], v[192:193], v[196:197], v[168:169]
    v_pk_fma_f32 v[198:199], v[194:195], v[198:199], v[168:169]
    v_rcp_f32 v184, v184
    v_rcp_f32 v185, v185
    v_rcp_f32 v186, v186
    v_rcp_f32 v187, v187
    v_rcp_f32 v196, v196
    v_rcp_f32 v197, v197
    v_rcp_f32 v198, v198
    v_rcp_f32 v199, v199
    v_pk_fma_f32 v[184:185], v[184:185], s[40:41], v[170:171]
    v_pk_fma_f32 v[186:187], v[186:187], s[40:41], v[170:171]
    v_pk_mul_f32 v[176:177], v[176:177], v[184:185]
    v_pk_mul_f32 v[178:179], v[178:179], v[186:187]
    v_cvt_pk_bf16_f32 v200, v176, v177
    v_cvt_pk_bf16_f32 v201, v178, v179
    v_pk_fma_f32 v[196:197], v[196:197], s[40:41], v[170:171]
    v_pk_fma_f32 v[198:199], v[198:199], s[40:41], v[170:171]
    v_pk_mul_f32 v[188:189], v[188:189], v[196:197]
    v_pk_mul_f32 v[190:191], v[190:191], v[198:199]
    v_cvt_pk_bf16_f32 v202, v188, v189
    v_cvt_pk_bf16_f32 v203, v190, v191
    buffer_store_dwordx4 v[200:203], v4, s[8:11], s36 offen sc1
    s_add_u32 s36, s42, 196608
    v_lshlrev_b32 v172, 16, v246
    v_and_b32 v173, 0xffff0000, v246
    v_lshlrev_b32 v174, 16, v247
    v_and_b32 v175, 0xffff0000, v247
    v_pk_mul_f32 v[172:173], v[172:173], s[38:39]
    v_pk_mul_f32 v[174:175], v[174:175], s[38:39]
    v_pk_fma_f32 v[208:209], v[132:133], v[68:69], v[172:173] op_sel_hi:[1,0,1] neg_lo:[0,1,0] neg_hi:[0,1,0]
    v_pk_fma_f32 v[210:211], v[134:135], v[68:69], v[174:175] op_sel_hi:[1,0,1] neg_lo:[0,1,0] neg_hi:[0,1,0]
    v_pk_fma_f32 v[208:209], v[32:33], v[64:65], v[208:209] op_sel_hi:[1,0,1]
    v_pk_fma_f32 v[210:211], v[34:35], v[64:65], v[210:211] op_sel_hi:[1,0,1]
    v_pk_fma_f32 v[220:221], v[132:133], v[70:71], v[172:173] op_sel_hi:[1,0,1] neg_lo:[0,1,0] neg_hi:[0,1,0]
    v_pk_fma_f32 v[222:223], v[134:135], v[70:71], v[174:175] op_sel_hi:[1,0,1] neg_lo:[0,1,0] neg_hi:[0,1,0]
    v_pk_fma_f32 v[220:221], v[36:37], v[66:67], v[220:221] op_sel_hi:[1,0,1]
    v_pk_fma_f32 v[222:223], v[38:39], v[66:67], v[222:223] op_sel_hi:[1,0,1]
    v_exp_f32 v212, v208
    v_exp_f32 v213, v209
    v_exp_f32 v214, v210
    v_exp_f32 v215, v211
    v_exp_f32 v224, v220
    v_exp_f32 v225, v221
    v_exp_f32 v226, v222
    v_exp_f32 v227, v223
    v_pk_fma_f32 v[216:217], v[212:213], s[38:39], v[168:169]
    v_pk_fma_f32 v[218:219], v[214:215], s[38:39], v[168:169]
    v_pk_fma_f32 v[216:217], v[212:213], v[216:217], v[168:169]
    v_pk_fma_f32 v[218:219], v[214:215], v[218:219], v[168:169]
    v_pk_fma_f32 v[228:229], v[224:225], s[38:39], v[168:169]
    v_pk_fma_f32 v[230:231], v[226:227], s[38:39], v[168:169]
    v_pk_fma_f32 v[228:229], v[224:225], v[228:229], v[168:169]
    v_pk_fma_f32 v[230:231], v[226:227], v[230:231], v[168:169]
    v_rcp_f32 v216, v216
    v_rcp_f32 v217, v217
    v_rcp_f32 v218, v218
    v_rcp_f32 v219, v219
    v_rcp_f32 v228, v228
    v_rcp_f32 v229, v229
    v_rcp_f32 v230, v230
    v_rcp_f32 v231, v231
    v_pk_fma_f32 v[216:217], v[216:217], s[40:41], v[170:171]
    v_pk_fma_f32 v[218:219], v[218:219], s[40:41], v[170:171]
    v_pk_mul_f32 v[208:209], v[208:209], v[216:217]
    v_pk_mul_f32 v[210:211], v[210:211], v[218:219]
    v_cvt_pk_bf16_f32 v232, v208, v209
    v_cvt_pk_bf16_f32 v233, v210, v211
    v_pk_fma_f32 v[228:229], v[228:229], s[40:41], v[170:171]
    v_pk_fma_f32 v[230:231], v[230:231], s[40:41], v[170:171]
    v_pk_mul_f32 v[220:221], v[220:221], v[228:229]
    v_pk_mul_f32 v[222:223], v[222:223], v[230:231]
    v_cvt_pk_bf16_f32 v234, v220, v221
    v_cvt_pk_bf16_f32 v235, v222, v223
    buffer_store_dwordx4 v[232:235], v4, s[8:11], s36 offen sc1
    s_add_u32 s36, s42, 262144
    v_lshlrev_b32 v172, 16, v248
    v_and_b32 v173, 0xffff0000, v248
    v_lshlrev_b32 v174, 16, v249
    v_and_b32 v175, 0xffff0000, v249
    v_pk_mul_f32 v[172:173], v[172:173], s[38:39]
    v_pk_mul_f32 v[174:175], v[174:175], s[38:39]
    v_pk_fma_f32 v[176:177], v[136:137], v[68:69], v[172:173] op_sel_hi:[1,0,1] neg_lo:[0,1,0] neg_hi:[0,1,0]
    v_pk_fma_f32 v[178:179], v[138:139], v[68:69], v[174:175] op_sel_hi:[1,0,1] neg_lo:[0,1,0] neg_hi:[0,1,0]
    v_pk_fma_f32 v[176:177], v[40:41], v[64:65], v[176:177] op_sel_hi:[1,0,1]
    v_pk_fma_f32 v[178:179], v[42:43], v[64:65], v[178:179] op_sel_hi:[1,0,1]
    v_pk_fma_f32 v[188:189], v[136:137], v[70:71], v[172:173] op_sel_hi:[1,0,1] neg_lo:[0,1,0] neg_hi:[0,1,0]
    v_pk_fma_f32 v[190:191], v[138:139], v[70:71], v[174:175] op_sel_hi:[1,0,1] neg_lo:[0,1,0] neg_hi:[0,1,0]
    v_pk_fma_f32 v[188:189], v[44:45], v[66:67], v[188:189] op_sel_hi:[1,0,1]
    v_pk_fma_f32 v[190:191], v[46:47], v[66:67], v[190:191] op_sel_hi:[1,0,1]
    v_exp_f32 v180, v176
    v_exp_f32 v181, v177
    v_exp_f32 v182, v178
    v_exp_f32 v183, v179
    v_exp_f32 v192, v188
    v_exp_f32 v193, v189
    v_exp_f32 v194, v190
    v_exp_f32 v195, v191
    v_pk_fma_f32 v[184:185], v[180:181], s[38:39], v[168:169]
    v_pk_fma_f32 v[186:187], v[182:183], s[38:39], v[168:169]
    v_pk_fma_f32 v[184:185], v[180:181], v[184:185], v[168:169]
    v_pk_fma_f32 v[186:187], v[182:183], v[186:187], v[168:169]
    v_pk_fma_f32 v[196:197], v[192:193], s[38:39], v[168:169]
    v_pk_fma_f32 v[198:199], v[194:195], s[38:39], v[168:169]
    v_pk_fma_f32 v[196:197], v[192:193], v[196:197], v[168:169]
    v_pk_fma_f32 v[198:199], v[194:195], v[198:199], v[168:169]
    v_rcp_f32 v184, v184
    v_rcp_f32 v185, v185
    v_rcp_f32 v186, v186
    v_rcp_f32 v187, v187
    v_rcp_f32 v196, v196
    v_rcp_f32 v197, v197
    v_rcp_f32 v198, v198
    v_rcp_f32 v199, v199
    v_pk_fma_f32 v[184:185], v[184:185], s[40:41], v[170:171]
    v_pk_fma_f32 v[186:187], v[186:187], s[40:41], v[170:171]
    v_pk_mul_f32 v[176:177], v[176:177], v[184:185]
    v_pk_mul_f32 v[178:179], v[178:179], v[186:187]
    v_cvt_pk_bf16_f32 v200, v176, v177
    v_cvt_pk_bf16_f32 v201, v178, v179
    v_pk_fma_f32 v[196:197], v[196:197], s[40:41], v[170:171]
    v_pk_fma_f32 v[198:199], v[198:199], s[40:41], v[170:171]
    v_pk_mul_f32 v[188:189], v[188:189], v[196:197]
    v_pk_mul_f32 v[190:191], v[190:191], v[198:199]
    v_cvt_pk_bf16_f32 v202, v188, v189
    v_cvt_pk_bf16_f32 v203, v190, v191
    buffer_store_dwordx4 v[200:203], v4, s[8:11], s36 offen sc1
    s_add_u32 s36, s42, 327680
    v_lshlrev_b32 v172, 16, v250
    v_and_b32 v173, 0xffff0000, v250
    v_lshlrev_b32 v174, 16, v251
    v_and_b32 v175, 0xffff0000, v251
    v_pk_mul_f32 v[172:173], v[172:173], s[38:39]
    v_pk_mul_f32 v[174:175], v[174:175], s[38:39]
    v_pk_fma_f32 v[208:209], v[140:141], v[68:69], v[172:173] op_sel_hi:[1,0,1] neg_lo:[0,1,0] neg_hi:[0,1,0]
    v_pk_fma_f32 v[210:211], v[142:143], v[68:69], v[174:175] op_sel_hi:[1,0,1] neg_lo:[0,1,0] neg_hi:[0,1,0]
    v_pk_fma_f32 v[208:209], v[48:49], v[64:65], v[208:209] op_sel_hi:[1,0,1]
    v_pk_fma_f32 v[210:211], v[50:51], v[64:65], v[210:211] op_sel_hi:[1,0,1]
    v_pk_fma_f32 v[220:221], v[140:141], v[70:71], v[172:173] op_sel_hi:[1,0,1] neg_lo:[0,1,0] neg_hi:[0,1,0]
    v_pk_fma_f32 v[222:223], v[142:143], v[70:71], v[174:175] op_sel_hi:[1,0,1] neg_lo:[0,1,0] neg_hi:[0,1,0]
    v_pk_fma_f32 v[220:221], v[52:53], v[66:67], v[220:221] op_sel_hi:[1,0,1]
    v_pk_fma_f32 v[222:223], v[54:55], v[66:67], v[222:223] op_sel_hi:[1,0,1]
    v_exp_f32 v212, v208
    v_exp_f32 v213, v209
    v_exp_f32 v214, v210
    v_exp_f32 v215, v211
    v_exp_f32 v224, v220
    v_exp_f32 v225, v221
    v_exp_f32 v226, v222
    v_exp_f32 v227, v223
    v_pk_fma_f32 v[216:217], v[212:213], s[38:39], v[168:169]
    v_pk_fma_f32 v[218:219], v[214:215], s[38:39], v[168:169]
    v_pk_fma_f32 v[216:217], v[212:213], v[216:217], v[168:169]
    v_pk_fma_f32 v[218:219], v[214:215], v[218:219], v[168:169]
    v_pk_fma_f32 v[228:229], v[224:225], s[38:39], v[168:169]
    v_pk_fma_f32 v[230:231], v[226:227], s[38:39], v[168:169]
    v_pk_fma_f32 v[228:229], v[224:225], v[228:229], v[168:169]
    v_pk_fma_f32 v[230:231], v[226:227], v[230:231], v[168:169]
    v_rcp_f32 v216, v216
    v_rcp_f32 v217, v217
    v_rcp_f32 v218, v218
    v_rcp_f32 v219, v219
    v_rcp_f32 v228, v228
    v_rcp_f32 v229, v229
    v_rcp_f32 v230, v230
    v_rcp_f32 v231, v231
    v_pk_fma_f32 v[216:217], v[216:217], s[40:41], v[170:171]
    v_pk_fma_f32 v[218:219], v[218:219], s[40:41], v[170:171]
    v_pk_mul_f32 v[208:209], v[208:209], v[216:217]
    v_pk_mul_f32 v[210:211], v[210:211], v[218:219]
    v_cvt_pk_bf16_f32 v232, v208, v209
    v_cvt_pk_bf16_f32 v233, v210, v211
    v_pk_fma_f32 v[228:229], v[228:229], s[40:41], v[170:171]
    v_pk_fma_f32 v[230:231], v[230:231], s[40:41], v[170:171]
    v_pk_mul_f32 v[220:221], v[220:221], v[228:229]
    v_pk_mul_f32 v[222:223], v[222:223], v[230:231]
    v_cvt_pk_bf16_f32 v234, v220, v221
    v_cvt_pk_bf16_f32 v235, v222, v223
    buffer_store_dwordx4 v[232:235], v4, s[8:11], s36 offen sc1
    s_lshr_b32 s50, s23, 3
    s_lshl_b32 s51, s22, 1
    s_add_u32 s50, s50, s51
    s_and_b32 s51, s23, 7
    s_mul_i32 s45, s51, 27
    s_lshr_b32 s45, s45, 3
    s_mov_b32 s45, 0
    s_and_b32 s52, s24, 1
    s_lshr_b32 s53, s24, 1
    s_lshl_b32 s55, s50, 6
    s_lshl_b32 s56, s52, 5
    s_add_u32 s55, s55, s56
    s_lshl_b32 s56, s55, 3
    s_add_u32 s56, s56, 0x710000
    s_mov_b32 s100, 0
    s_mov_b32 s33, 0
    s_cmp_lg_u32 s53, 0
    s_cmov_b32 s33, 3538944
    s_add_u32 s33, s33, s56
    buffer_load_dwordx4 v[72:75], v4, s[8:11], s33 offen sc1
    buffer_load_dwordx4 v[76:79], v5, s[8:11], s33 offen sc1
    s_mov_b32 s33, 917504
    s_cmp_lg_u32 s53, 0
    s_cmov_b32 s33, 1835008
    s_add_u32 s33, s33, s56
    buffer_load_dwordx4 v[80:83], v4, s[8:11], s33 offen sc1
    buffer_load_dwordx4 v[84:87], v5, s[8:11], s33 offen sc1
    s_mov_b32 s33, 2228224
    s_cmp_lg_u32 s53, 0
    s_cmov_b32 s33, 3145728
    s_add_u32 s33, s33, s56
    buffer_load_dwordx4 v[96:99], v4, s[8:11], s33 offen sc1
    buffer_load_dwordx4 v[100:103], v5, s[8:11], s33 offen sc1
    s_mov_b32 s33, 4456448
    s_cmp_lg_u32 s53, 0
    s_cmov_b32 s33, 5373952
    s_add_u32 s33, s33, s56
    buffer_load_dwordx4 v[104:107], v4, s[8:11], s33 offen sc1
    buffer_load_dwordx4 v[108:111], v5, s[8:11], s33 offen sc1
    s_add_u32 s36, s42, 393216
    v_lshlrev_b32 v172, 16, v252
    v_and_b32 v173, 0xffff0000, v252
    v_lshlrev_b32 v174, 16, v253
    v_and_b32 v175, 0xffff0000, v253
    v_pk_mul_f32 v[172:173], v[172:173], s[38:39]
    v_pk_mul_f32 v[174:175], v[174:175], s[38:39]
    v_pk_fma_f32 v[176:177], v[144:145], v[68:69], v[172:173] op_sel_hi:[1,0,1] neg_lo:[0,1,0] neg_hi:[0,1,0]
    v_pk_fma_f32 v[178:179], v[146:147], v[68:69], v[174:175] op_sel_hi:[1,0,1] neg_lo:[0,1,0] neg_hi:[0,1,0]
    v_pk_fma_f32 v[176:177], v[56:57], v[64:65], v[176:177] op_sel_hi:[1,0,1]
    v_pk_fma_f32 v[178:179], v[58:59], v[64:65], v[178:179] op_sel_hi:[1,0,1]
    v_pk_fma_f32 v[188:189], v[144:145], v[70:71], v[172:173] op_sel_hi:[1,0,1] neg_lo:[0,1,0] neg_hi:[0,1,0]
    v_pk_fma_f32 v[190:191], v[146:147], v[70:71], v[174:175] op_sel_hi:[1,0,1] neg_lo:[0,1,0] neg_hi:[0,1,0]
    v_pk_fma_f32 v[188:189], v[60:61], v[66:67], v[188:189] op_sel_hi:[1,0,1]
    v_pk_fma_f32 v[190:191], v[62:63], v[66:67], v[190:191] op_sel_hi:[1,0,1]
    v_exp_f32 v180, v176
    v_exp_f32 v181, v177
    v_exp_f32 v182, v178
    v_exp_f32 v183, v179
    v_exp_f32 v192, v188
    v_exp_f32 v193, v189
    v_exp_f32 v194, v190
    v_exp_f32 v195, v191
    v_pk_fma_f32 v[184:185], v[180:181], s[38:39], v[168:169]
    v_pk_fma_f32 v[186:187], v[182:183], s[38:39], v[168:169]
    v_pk_fma_f32 v[184:185], v[180:181], v[184:185], v[168:169]
    v_pk_fma_f32 v[186:187], v[182:183], v[186:187], v[168:169]
    v_pk_fma_f32 v[196:197], v[192:193], s[38:39], v[168:169]
    v_pk_fma_f32 v[198:199], v[194:195], s[38:39], v[168:169]
    v_pk_fma_f32 v[196:197], v[192:193], v[196:197], v[168:169]
    v_pk_fma_f32 v[198:199], v[194:195], v[198:199], v[168:169]
    v_rcp_f32 v184, v184
    v_rcp_f32 v185, v185
    v_rcp_f32 v186, v186
    v_rcp_f32 v187, v187
    v_rcp_f32 v196, v196
    v_rcp_f32 v197, v197
    v_rcp_f32 v198, v198
    v_rcp_f32 v199, v199
    v_pk_fma_f32 v[184:185], v[184:185], s[40:41], v[170:171]
    v_pk_fma_f32 v[186:187], v[186:187], s[40:41], v[170:171]
    v_pk_mul_f32 v[176:177], v[176:177], v[184:185]
    v_pk_mul_f32 v[178:179], v[178:179], v[186:187]
    v_cvt_pk_bf16_f32 v200, v176, v177
    v_cvt_pk_bf16_f32 v201, v178, v179
    v_pk_fma_f32 v[196:197], v[196:197], s[40:41], v[170:171]
    v_pk_fma_f32 v[198:199], v[198:199], s[40:41], v[170:171]
    v_pk_mul_f32 v[188:189], v[188:189], v[196:197]
    v_pk_mul_f32 v[190:191], v[190:191], v[198:199]
    v_cvt_pk_bf16_f32 v202, v188, v189
    v_cvt_pk_bf16_f32 v203, v190, v191
    s_mov_b32 exec_hi, 0x0000ffff
    buffer_store_dwordx4 v[200:203], v4, s[8:11], s36 offen sc1
    s_mov_b64 exec, -1
    v_mov_b32 v240, 161972
    v_mov_b32 v241, 1
    s_mov_b64 exec, 1
    ds_add_u32 v240, v241
    s_mov_b64 exec, -1
    v_mbcnt_lo_u32_b32 v1, -1, 0
    v_mbcnt_hi_u32_b32 v1, -1, v1
    v_lshlrev_b32 v3, 4, v1
    v_lshrrev_b32 v7, 4, v1
    v_and_b32 v6, 15, v1
    v_lshlrev_b32 v4, 14, v7
    v_lshl_add_u32 v4, v6, 4, v4
    v_add_u32 v5, 0x10000, v4
    s_mul_i32 s57, s53, 5120
    v_add_u32 v3, s57, v3
    v_add_u32 v2, 0x10000, v3
    v_add_u32 v1, 0x20000, v3
    v_mov_b32 v8, 0
    v_mov_b32 v9, 0
    v_mov_b32 v10, 0
    v_mov_b32 v11, 0
    v_mov_b32 v12, 0
    v_mov_b32 v13, 0
    v_mov_b32 v14, 0
    v_mov_b32 v15, 0
    v_mov_b32 v16, 0
    v_mov_b32 v17, 0
    v_mov_b32 v18, 0
    v_mov_b32 v19, 0
    v_mov_b32 v20, 0
    v_mov_b32 v21, 0
    v_mov_b32 v22, 0
    v_mov_b32 v23, 0
    v_mov_b32 v24, 0
    v_mov_b32 v25, 0
    v_mov_b32 v26, 0
    v_mov_b32 v27, 0
    v_mov_b32 v28, 0
    v_mov_b32 v29, 0
    v_mov_b32 v30, 0
    v_mov_b32 v31, 0
    v_mov_b32 v32, 0
    v_mov_b32 v33, 0
    v_mov_b32 v34, 0
    v_mov_b32 v35, 0
    v_mov_b32 v36, 0
    v_mov_b32 v37, 0
    v_mov_b32 v38, 0
    v_mov_b32 v39, 0
    v_mov_b32 v40, 0
    v_mov_b32 v41, 0
    v_mov_b32 v42, 0
    v_mov_b32 v43, 0
    v_mov_b32 v44, 0
    v_mov_b32 v45, 0
    v_mov_b32 v46, 0
    v_mov_b32 v47, 0
    v_mov_b32 v240, 161936
    s_mov_b32 s101, 0
LW_107:
    s_add_u32 s101, s101, 1
    s_cmp_gt_u32 s101, 4000000
    s_cbranch_scc1 LWX_108
    ds_read_b32 v241, v240
    s_waitcnt lgkmcnt(0)
    v_readfirstlane_b32 s34, v241
    s_nop 0
    s_cmp_ge_u32 s34, 4
    s_cbranch_scc1 LWX_108
    s_branch LW_107
LWX_108:
    ds_read_b128 v[48:51], v3 offset:0
    ds_read_b128 v[52:55], v3 offset:1024
    ds_read_b128 v[56:59], v3 offset:2048
    ds_read_b128 v[60:63], v3 offset:3072
    ds_read_b128 v[64:67], v3 offset:4096
    ds_read_b128 v[112:115], v3 offset:10240
    ds_read_b128 v[116:119], v3 offset:11264
    ds_read_b128 v[120:123], v3 offset:12288
    ds_read_b128 v[124:127], v3 offset:13312
    ds_read_b128 v[128:131], v3 offset:14336
    s_waitcnt vmcnt(6)
SVB_109:
    v_max3_u32 v242, v72, v74, v76
    v_max_u32 v242, v242, v78
    v_cmp_eq_u32 vcc, -1, v242
    s_nop 0
    s_cbranch_vccnz SVS_110
    v_swap_b32 v74, v76
    v_swap_b32 v75, v77
SVB_109_AFTER:
    s_waitcnt lgkmcnt(5)
    s_nop 0
    v_mfma_f32_16x16x32_bf16 v[8:11], v[48:51], v[72:75], v[8:11]
    ds_read_b128 v[164:167], v3 offset:20480
    v_mfma_f32_16x16x32_bf16 v[12:15], v[48:51], v[76:79], v[12:15]
    ds_read_b128 v[168:171], v3 offset:21504
    s_mov_b32 s33, 5767168
    s_cmp_lg_u32 s53, 0
    s_cmov_b32 s33, 6684672
    s_add_u32 s33, s33, s56
    buffer_load_dwordx4 v[148:151], v4, s[8:11], s33 offen sc1
    v_mfma_f32_16x16x32_bf16 v[16:19], v[52:55], v[72:75], v[16:19]
    ds_read_b128 v[172:175], v3 offset:22528
    v_mfma_f32_16x16x32_bf16 v[20:23], v[52:55], v[76:79], v[20:23]
    ds_read_b128 v[176:179], v3 offset:23552
    v_mfma_f32_16x16x32_bf16 v[24:27], v[56:59], v[72:75], v[24:27]
    ds_read_b128 v[180:183], v3 offset:24576
    buffer_load_dwordx4 v[152:155], v5, s[8:11], s33 offen sc1
    v_mfma_f32_16x16x32_bf16 v[28:31], v[56:59], v[76:79], v[28:31]
    s_waitcnt vmcnt(6)
SVB_111:
    v_max3_u32 v242, v80, v82, v84
    v_max_u32 v242, v242, v86
    v_cmp_eq_u32 vcc, -1, v242
    s_nop 0
    s_cbranch_vccnz SVS_112
    v_swap_b32 v82, v84
    v_swap_b32 v83, v85
SVB_111_AFTER:
    v_mfma_f32_16x16x32_bf16 v[32:35], v[60:63], v[72:75], v[32:35]
    v_mfma_f32_16x16x32_bf16 v[36:39], v[60:63], v[76:79], v[36:39]
    v_mfma_f32_16x16x32_bf16 v[40:43], v[64:67], v[72:75], v[40:43]
    v_mfma_f32_16x16x32_bf16 v[44:47], v[64:67], v[76:79], v[44:47]
    s_waitcnt lgkmcnt(5)
    v_mfma_f32_16x16x32_bf16 v[8:11], v[112:115], v[80:83], v[8:11]
    ds_read_b128 v[48:51], v3 offset:30720
    v_mfma_f32_16x16x32_bf16 v[12:15], v[112:115], v[84:87], v[12:15]
    ds_read_b128 v[52:55], v3 offset:31744
    s_mov_b32 s33, 131072
    s_cmp_lg_u32 s53, 0
    s_cmov_b32 s33, 524288
    s_add_u32 s33, s33, s56
    buffer_load_dwordx4 v[72:75], v4, s[8:11], s33 offen sc1
    v_mfma_f32_16x16x32_bf16 v[16:19], v[116:119], v[80:83], v[16:19]
    ds_read_b128 v[56:59], v3 offset:32768
    v_mfma_f32_16x16x32_bf16 v[20:23], v[116:119], v[84:87], v[20:23]
    ds_read_b128 v[60:63], v3 offset:33792
    v_mfma_f32_16x16x32_bf16 v[24:27], v[120:123], v[80:83], v[24:27]
    ds_read_b128 v[64:67], v3 offset:34816
    buffer_load_dwordx4 v[76:79], v5, s[8:11], s33 offen sc1
    v_mfma_f32_16x16x32_bf16 v[28:31], v[120:123], v[84:87], v[28:31]
    s_waitcnt vmcnt(6)
SVB_113:
    v_max3_u32 v242, v96, v98, v100
    v_max_u32 v242, v242, v102
    v_cmp_eq_u32 vcc, -1, v242
    s_nop 0
    s_cbranch_vccnz SVS_114
    v_swap_b32 v98, v100
    v_swap_b32 v99, v101
SVB_113_AFTER:
    v_mfma_f32_16x16x32_bf16 v[32:35], v[124:127], v[80:83], v[32:35]
    v_mfma_f32_16x16x32_bf16 v[36:39], v[124:127], v[84:87], v[36:39]
    v_mfma_f32_16x16x32_bf16 v[40:43], v[128:131], v[80:83], v[40:43]
    v_mfma_f32_16x16x32_bf16 v[44:47], v[128:131], v[84:87], v[44:47]
    s_waitcnt lgkmcnt(5)
    v_mfma_f32_16x16x32_bf16 v[8:11], v[164:167], v[96:99], v[8:11]
    ds_read_b128 v[112:115], v3 offset:40960
    v_mfma_f32_16x16x32_bf16 v[12:15], v[164:167], v[100:103], v[12:15]
    ds_read_b128 v[116:119], v3 offset:41984
    s_mov_b32 s33, 1441792
    s_cmp_lg_u32 s53, 0
    s_cmov_b32 s33, 2752512
    s_add_u32 s33, s33, s56
    buffer_load_dwordx4 v[80:83], v4, s[8:11], s33 offen sc1
    v_mfma_f32_16x16x32_bf16 v[16:19], v[168:171], v[96:99], v[16:19]
    ds_read_b128 v[120:123], v3 offset:43008
    v_mfma_f32_16x16x32_bf16 v[20:23], v[168:171], v[100:103], v[20:23]
    ds_read_b128 v[124:127], v3 offset:44032
    v_mfma_f32_16x16x32_bf16 v[24:27], v[172:175], v[96:99], v[24:27]
    ds_read_b128 v[128:131], v3 offset:45056
    buffer_load_dwordx4 v[84:87], v5, s[8:11], s33 offen sc1
    v_mfma_f32_16x16x32_bf16 v[28:31], v[172:175], v[100:103], v[28:31]
    s_waitcnt vmcnt(6)
SVB_115:
    v_max3_u32 v242, v104, v106, v108
    v_max_u32 v242, v242, v110
    v_cmp_eq_u32 vcc, -1, v242
    s_nop 0
    s_cbranch_vccnz SVS_116
    v_swap_b32 v106, v108
    v_swap_b32 v107, v109
SVB_115_AFTER:
    v_mfma_f32_16x16x32_bf16 v[32:35], v[176:179], v[96:99], v[32:35]
    v_mfma_f32_16x16x32_bf16 v[36:39], v[176:179], v[100:103], v[36:39]
    v_mfma_f32_16x16x32_bf16 v[40:43], v[180:183], v[96:99], v[40:43]
    v_mfma_f32_16x16x32_bf16 v[44:47], v[180:183], v[100:103], v[44:47]
    s_waitcnt lgkmcnt(5)
    v_mfma_f32_16x16x32_bf16 v[8:11], v[48:51], v[104:107], v[8:11]
    ds_read_b128 v[164:167], v3 offset:51200
    v_mfma_f32_16x16x32_bf16 v[12:15], v[48:51], v[108:111], v[12:15]
    ds_read_b128 v[168:171], v3 offset:52224
    s_mov_b32 s33, 3670016
    s_cmp_lg_u32 s53, 0
    s_cmov_b32 s33, 4063232
    s_add_u32 s33, s33, s56
    buffer_load_dwordx4 v[96:99], v4, s[8:11], s33 offen sc1
    v_mfma_f32_16x16x32_bf16 v[16:19], v[52:55], v[104:107], v[16:19]
    ds_read_b128 v[172:175], v3 offset:53248
    v_mfma_f32_16x16x32_bf16 v[20:23], v[52:55], v[108:111], v[20:23]
    ds_read_b128 v[176:179], v3 offset:54272
    v_mfma_f32_16x16x32_bf16 v[24:27], v[56:59], v[104:107], v[24:27]
    ds_read_b128 v[180:183], v3 offset:55296
    buffer_load_dwordx4 v[100:103], v5, s[8:11], s33 offen sc1
    v_mfma_f32_16x16x32_bf16 v[28:31], v[56:59], v[108:111], v[28:31]
    s_waitcnt vmcnt(6)
SVB_117:
    v_max3_u32 v242, v148, v150, v152
    v_max_u32 v242, v242, v154
    v_cmp_eq_u32 vcc, -1, v242
    s_nop 0
    s_cbranch_vccnz SVS_118
    v_swap_b32 v150, v152
    v_swap_b32 v151, v153
SVB_117_AFTER:
    v_mfma_f32_16x16x32_bf16 v[32:35], v[60:63], v[104:107], v[32:35]
    v_mfma_f32_16x16x32_bf16 v[36:39], v[60:63], v[108:111], v[36:39]
    v_mfma_f32_16x16x32_bf16 v[40:43], v[64:67], v[104:107], v[40:43]
    v_mfma_f32_16x16x32_bf16 v[44:47], v[64:67], v[108:111], v[44:47]
    s_waitcnt lgkmcnt(0)
    s_barrier
    v_mfma_f32_16x16x32_bf16 v[8:11], v[112:115], v[148:151], v[8:11]
    ds_read_b128 v[48:51], v3 offset:61440
    v_mfma_f32_16x16x32_bf16 v[12:15], v[112:115], v[152:155], v[12:15]
    ds_read_b128 v[52:55], v3 offset:62464
    s_mov_b32 s33, 4980736
    s_cmp_lg_u32 s53, 0
    s_cmov_b32 s33, 6291456
    s_add_u32 s33, s33, s56
    buffer_load_dwordx4 v[104:107], v4, s[8:11], s33 offen sc1
    v_mfma_f32_16x16x32_bf16 v[16:19], v[116:119], v[148:151], v[16:19]
    ds_read_b128 v[56:59], v3 offset:63488
    v_mfma_f32_16x16x32_bf16 v[20:23], v[116:119], v[152:155], v[20:23]
    ds_read_b128 v[60:63], v3 offset:64512
    v_mfma_f32_16x16x32_bf16 v[24:27], v[120:123], v[148:151], v[24:27]
    ds_read_b128 v[64:67], v2 offset:0
    buffer_load_dwordx4 v[108:111], v5, s[8:11], s33 offen sc1
    v_mfma_f32_16x16x32_bf16 v[28:31], v[120:123], v[152:155], v[28:31]
    s_waitcnt vmcnt(6)
SVB_119:
    v_max3_u32 v242, v72, v74, v76
    v_max_u32 v242, v242, v78
    v_cmp_eq_u32 vcc, -1, v242
    s_nop 0
    s_cbranch_vccnz SVS_120
    v_swap_b32 v74, v76
    v_swap_b32 v75, v77
SVB_119_AFTER:
    v_mfma_f32_16x16x32_bf16 v[32:35], v[124:127], v[148:151], v[32:35]
    v_mfma_f32_16x16x32_bf16 v[36:39], v[124:127], v[152:155], v[36:39]
    v_mfma_f32_16x16x32_bf16 v[40:43], v[128:131], v[148:151], v[40:43]
    v_mfma_f32_16x16x32_bf16 v[44:47], v[128:131], v[152:155], v[44:47]
    s_waitcnt lgkmcnt(5)
    v_mfma_f32_16x16x32_bf16 v[8:11], v[164:167], v[72:75], v[8:11]
    ds_read_b128 v[112:115], v2 offset:6144
    v_mfma_f32_16x16x32_bf16 v[12:15], v[164:167], v[76:79], v[12:15]
    ds_read_b128 v[116:119], v2 offset:7168
    s_mov_b32 s33, 1048576
    s_cmp_lg_u32 s53, 0
    s_cmov_b32 s33, 1966080
    s_add_u32 s33, s33, s56
    buffer_load_dwordx4 v[148:151], v4, s[8:11], s33 offen sc1
    v_mfma_f32_16x16x32_bf16 v[16:19], v[168:171], v[72:75], v[16:19]
    ds_read_b128 v[120:123], v2 offset:8192
    v_mfma_f32_16x16x32_bf16 v[20:23], v[168:171], v[76:79], v[20:23]
    ds_read_b128 v[124:127], v2 offset:9216
    v_mfma_f32_16x16x32_bf16 v[24:27], v[172:175], v[72:75], v[24:27]
    ds_read_b128 v[128:131], v2 offset:10240
    buffer_load_dwordx4 v[152:155], v5, s[8:11], s33 offen sc1
    v_mfma_f32_16x16x32_bf16 v[28:31], v[172:175], v[76:79], v[28:31]
    s_waitcnt vmcnt(6)
SVB_121:
    v_max3_u32 v242, v80, v82, v84
    v_max_u32 v242, v242, v86
    v_cmp_eq_u32 vcc, -1, v242
    s_nop 0
    s_cbranch_vccnz SVS_122
    v_swap_b32 v82, v84
    v_swap_b32 v83, v85
SVB_121_AFTER:
    v_mfma_f32_16x16x32_bf16 v[32:35], v[176:179], v[72:75], v[32:35]
    v_mfma_f32_16x16x32_bf16 v[36:39], v[176:179], v[76:79], v[36:39]
    v_mfma_f32_16x16x32_bf16 v[40:43], v[180:183], v[72:75], v[40:43]
    v_mfma_f32_16x16x32_bf16 v[44:47], v[180:183], v[76:79], v[44:47]
    s_waitcnt lgkmcnt(5)
    v_mfma_f32_16x16x32_bf16 v[8:11], v[48:51], v[80:83], v[8:11]
    ds_read_b128 v[164:167], v2 offset:16384
    v_mfma_f32_16x16x32_bf16 v[12:15], v[48:51], v[84:87], v[12:15]
    ds_read_b128 v[168:171], v2 offset:17408
    s_mov_b32 s33, 2359296
    s_cmp_lg_u32 s53, 0
    s_cmov_b32 s33, 3276800
    s_add_u32 s33, s33, s56
    buffer_load_dwordx4 v[72:75], v4, s[8:11], s33 offen sc1
    v_mfma_f32_16x16x32_bf16 v[16:19], v[52:55], v[80:83], v[16:19]
    ds_read_b128 v[172:175], v2 offset:18432
    v_mfma_f32_16x16x32_bf16 v[20:23], v[52:55], v[84:87], v[20:23]
    ds_read_b128 v[176:179], v2 offset:19456
    v_mfma_f32_16x16x32_bf16 v[24:27], v[56:59], v[80:83], v[24:27]
    ds_read_b128 v[180:183], v2 offset:20480
    buffer_load_dwordx4 v[76:79], v5, s[8:11], s33 offen sc1
    v_mfma_f32_16x16x32_bf16 v[28:31], v[56:59], v[84:87], v[28:31]
    s_waitcnt vmcnt(6)
SVB_123:
    v_max3_u32 v242, v96, v98, v100
    v_max_u32 v242, v242, v102
    v_cmp_eq_u32 vcc, -1, v242
    s_nop 0
    s_cbranch_vccnz SVS_124
    v_swap_b32 v98, v100
    v_swap_b32 v99, v101
SVB_123_AFTER:
    v_mfma_f32_16x16x32_bf16 v[32:35], v[60:63], v[80:83], v[32:35]
    v_mfma_f32_16x16x32_bf16 v[36:39], v[60:63], v[84:87], v[36:39]
    v_mfma_f32_16x16x32_bf16 v[40:43], v[64:67], v[80:83], v[40:43]
    v_mfma_f32_16x16x32_bf16 v[44:47], v[64:67], v[84:87], v[44:47]
    s_waitcnt lgkmcnt(5)
    v_mfma_f32_16x16x32_bf16 v[8:11], v[112:115], v[96:99], v[8:11]
    ds_read_b128 v[48:51], v2 offset:26624
    v_mfma_f32_16x16x32_bf16 v[12:15], v[112:115], v[100:103], v[12:15]
    ds_read_b128 v[52:55], v2 offset:27648
    s_mov_b32 s33, 4587520
    s_cmp_lg_u32 s53, 0
    s_cmov_b32 s33, 5505024
    s_add_u32 s33, s33, s56
    buffer_load_dwordx4 v[80:83], v4, s[8:11], s33 offen sc1
    v_mfma_f32_16x16x32_bf16 v[16:19], v[116:119], v[96:99], v[16:19]
    ds_read_b128 v[56:59], v2 offset:28672
    v_mfma_f32_16x16x32_bf16 v[20:23], v[116:119], v[100:103], v[20:23]
    ds_read_b128 v[60:63], v2 offset:29696
    v_mfma_f32_16x16x32_bf16 v[24:27], v[120:123], v[96:99], v[24:27]
    ds_read_b128 v[64:67], v2 offset:30720
    buffer_load_dwordx4 v[84:87], v5, s[8:11], s33 offen sc1
    v_mfma_f32_16x16x32_bf16 v[28:31], v[120:123], v[100:103], v[28:31]
    s_waitcnt vmcnt(6)
SVB_125:
    v_max3_u32 v242, v104, v106, v108
    v_max_u32 v242, v242, v110
    v_cmp_eq_u32 vcc, -1, v242
    s_nop 0
    s_cbranch_vccnz SVS_126
    v_swap_b32 v106, v108
    v_swap_b32 v107, v109
SVB_125_AFTER:
    v_mfma_f32_16x16x32_bf16 v[32:35], v[124:127], v[96:99], v[32:35]
    v_mfma_f32_16x16x32_bf16 v[36:39], v[124:127], v[100:103], v[36:39]
    v_mfma_f32_16x16x32_bf16 v[40:43], v[128:131], v[96:99], v[40:43]
    v_mfma_f32_16x16x32_bf16 v[44:47], v[128:131], v[100:103], v[44:47]
    s_waitcnt lgkmcnt(5)
    v_mfma_f32_16x16x32_bf16 v[8:11], v[164:167], v[104:107], v[8:11]
    ds_read_b128 v[112:115], v2 offset:36864
    v_mfma_f32_16x16x32_bf16 v[12:15], v[164:167], v[108:111], v[12:15]
    ds_read_b128 v[116:119], v2 offset:37888
    s_mov_b32 s33, 5898240
    s_cmp_lg_u32 s53, 0
    s_cmov_b32 s33, 6815744
    s_add_u32 s33, s33, s56
    buffer_load_dwordx4 v[96:99], v4, s[8:11], s33 offen sc1
    v_mfma_f32_16x16x32_bf16 v[16:19], v[168:171], v[104:107], v[16:19]
    ds_read_b128 v[120:123], v2 offset:38912
    v_mfma_f32_16x16x32_bf16 v[20:23], v[168:171], v[108:111], v[20:23]
    ds_read_b128 v[124:127], v2 offset:39936
    v_mfma_f32_16x16x32_bf16 v[24:27], v[172:175], v[104:107], v[24:27]
    ds_read_b128 v[128:131], v2 offset:40960
    buffer_load_dwordx4 v[100:103], v5, s[8:11], s33 offen sc1
    v_mfma_f32_16x16x32_bf16 v[28:31], v[172:175], v[108:111], v[28:31]
    s_waitcnt vmcnt(6)
SVB_127:
    v_max3_u32 v242, v148, v150, v152
    v_max_u32 v242, v242, v154
    v_cmp_eq_u32 vcc, -1, v242
    s_nop 0
    s_cbranch_vccnz SVS_128
    v_swap_b32 v150, v152
    v_swap_b32 v151, v153
SVB_127_AFTER:
    v_mfma_f32_16x16x32_bf16 v[32:35], v[176:179], v[104:107], v[32:35]
    v_mfma_f32_16x16x32_bf16 v[36:39], v[176:179], v[108:111], v[36:39]
    v_mfma_f32_16x16x32_bf16 v[40:43], v[180:183], v[104:107], v[40:43]
    v_mfma_f32_16x16x32_bf16 v[44:47], v[180:183], v[108:111], v[44:47]
    s_waitcnt lgkmcnt(5)
    v_mfma_f32_16x16x32_bf16 v[8:11], v[48:51], v[148:151], v[8:11]
    ds_read_b128 v[164:167], v2 offset:47104
    v_mfma_f32_16x16x32_bf16 v[12:15], v[48:51], v[152:155], v[12:15]
    ds_read_b128 v[168:171], v2 offset:48128
    s_mov_b32 s33, 262144
    s_cmp_lg_u32 s53, 0
    s_cmov_b32 s33, 655360
    s_add_u32 s33, s33, s56
    buffer_load_dwordx4 v[104:107], v4, s[8:11], s33 offen sc1
    v_mfma_f32_16x16x32_bf16 v[16:19], v[52:55], v[148:151], v[16:19]
    ds_read_b128 v[172:175], v2 offset:49152
    v_mfma_f32_16x16x32_bf16 v[20:23], v[52:55], v[152:155], v[20:23]
    ds_read_b128 v[176:179], v2 offset:50176
    v_mfma_f32_16x16x32_bf16 v[24:27], v[56:59], v[148:151], v[24:27]
    ds_read_b128 v[180:183], v2 offset:51200
    buffer_load_dwordx4 v[108:111], v5, s[8:11], s33 offen sc1
    v_mfma_f32_16x16x32_bf16 v[28:31], v[56:59], v[152:155], v[28:31]
    s_waitcnt vmcnt(6)
SVB_129:
    v_max3_u32 v242, v72, v74, v76
    v_max_u32 v242, v242, v78
    v_cmp_eq_u32 vcc, -1, v242
    s_nop 0
    s_cbranch_vccnz SVS_130
    v_swap_b32 v74, v76
    v_swap_b32 v75, v77
SVB_129_AFTER:
    v_mfma_f32_16x16x32_bf16 v[32:35], v[60:63], v[148:151], v[32:35]
    v_mfma_f32_16x16x32_bf16 v[36:39], v[60:63], v[152:155], v[36:39]
    v_mfma_f32_16x16x32_bf16 v[40:43], v[64:67], v[148:151], v[40:43]
    v_mfma_f32_16x16x32_bf16 v[44:47], v[64:67], v[152:155], v[44:47]
    s_waitcnt lgkmcnt(0)
    s_barrier
    v_mfma_f32_16x16x32_bf16 v[8:11], v[112:115], v[72:75], v[8:11]
    ds_read_b128 v[48:51], v3 offset:0
    v_mfma_f32_16x16x32_bf16 v[12:15], v[112:115], v[76:79], v[12:15]
    ds_read_b128 v[52:55], v3 offset:1024
    s_mov_b32 s33, 1572864
    s_cmp_lg_u32 s53, 0
    s_cmov_b32 s33, 2883584
    s_add_u32 s33, s33, s56
    buffer_load_dwordx4 v[148:151], v4, s[8:11], s33 offen sc1
    v_mfma_f32_16x16x32_bf16 v[16:19], v[116:119], v[72:75], v[16:19]
    ds_read_b128 v[56:59], v3 offset:2048
    v_mfma_f32_16x16x32_bf16 v[20:23], v[116:119], v[76:79], v[20:23]
    ds_read_b128 v[60:63], v3 offset:3072
    v_mfma_f32_16x16x32_bf16 v[24:27], v[120:123], v[72:75], v[24:27]
    ds_read_b128 v[64:67], v3 offset:4096
    buffer_load_dwordx4 v[152:155], v5, s[8:11], s33 offen sc1
    v_mfma_f32_16x16x32_bf16 v[28:31], v[120:123], v[76:79], v[28:31]
    s_waitcnt vmcnt(6)
SVB_131:
    v_max3_u32 v242, v80, v82, v84
    v_max_u32 v242, v242, v86
    v_cmp_eq_u32 vcc, -1, v242
    s_nop 0
    s_cbranch_vccnz SVS_132
    v_swap_b32 v82, v84
    v_swap_b32 v83, v85
SVB_131_AFTER:
    v_mfma_f32_16x16x32_bf16 v[32:35], v[124:127], v[72:75], v[32:35]
    v_mfma_f32_16x16x32_bf16 v[36:39], v[124:127], v[76:79], v[36:39]
    v_mfma_f32_16x16x32_bf16 v[40:43], v[128:131], v[72:75], v[40:43]
    v_mfma_f32_16x16x32_bf16 v[44:47], v[128:131], v[76:79], v[44:47]
    s_waitcnt lgkmcnt(5)
    v_mfma_f32_16x16x32_bf16 v[8:11], v[164:167], v[80:83], v[8:11]
    ds_read_b128 v[112:115], v3 offset:10240
    v_mfma_f32_16x16x32_bf16 v[12:15], v[164:167], v[84:87], v[12:15]
    ds_read_b128 v[116:119], v3 offset:11264
    s_mov_b32 s33, 3801088
    s_cmp_lg_u32 s53, 0
    s_cmov_b32 s33, 4194304
    s_add_u32 s33, s33, s56
    buffer_load_dwordx4 v[72:75], v4, s[8:11], s33 offen sc1
    v_mfma_f32_16x16x32_bf16 v[16:19], v[168:171], v[80:83], v[16:19]
    ds_read_b128 v[120:123], v3 offset:12288
    v_mfma_f32_16x16x32_bf16 v[20:23], v[168:171], v[84:87], v[20:23]
    ds_read_b128 v[124:127], v3 offset:13312
    v_mfma_f32_16x16x32_bf16 v[24:27], v[172:175], v[80:83], v[24:27]
    ds_read_b128 v[128:131], v3 offset:14336
    buffer_load_dwordx4 v[76:79], v5, s[8:11], s33 offen sc1
    v_mfma_f32_16x16x32_bf16 v[28:31], v[172:175], v[84:87], v[28:31]
    s_waitcnt vmcnt(6)
SVB_133:
    v_max3_u32 v242, v96, v98, v100
    v_max_u32 v242, v242, v102
    v_cmp_eq_u32 vcc, -1, v242
    s_nop 0
    s_cbranch_vccnz SVS_134
    v_swap_b32 v98, v100
    v_swap_b32 v99, v101
SVB_133_AFTER:
    v_mfma_f32_16x16x32_bf16 v[32:35], v[176:179], v[80:83], v[32:35]
    v_mfma_f32_16x16x32_bf16 v[36:39], v[176:179], v[84:87], v[36:39]
    v_mfma_f32_16x16x32_bf16 v[40:43], v[180:183], v[80:83], v[40:43]
    v_mfma_f32_16x16x32_bf16 v[44:47], v[180:183], v[84:87], v[44:47]
    s_waitcnt lgkmcnt(5)
    v_mfma_f32_16x16x32_bf16 v[8:11], v[48:51], v[96:99], v[8:11]
    ds_read_b128 v[164:167], v3 offset:20480
    v_mfma_f32_16x16x32_bf16 v[12:15], v[48:51], v[100:103], v[12:15]
    ds_read_b128 v[168:171], v3 offset:21504
    s_mov_b32 s33, 5111808
    s_cmp_lg_u32 s53, 0
    s_cmov_b32 s33, 6422528
    s_add_u32 s33, s33, s56
    buffer_load_dwordx4 v[80:83], v4, s[8:11], s33 offen sc1
    v_mfma_f32_16x16x32_bf16 v[16:19], v[52:55], v[96:99], v[16:19]
    ds_read_b128 v[172:175], v3 offset:22528
    v_mfma_f32_16x16x32_bf16 v[20:23], v[52:55], v[100:103], v[20:23]
    ds_read_b128 v[176:179], v3 offset:23552
    v_mfma_f32_16x16x32_bf16 v[24:27], v[56:59], v[96:99], v[24:27]
    ds_read_b128 v[180:183], v3 offset:24576
    buffer_load_dwordx4 v[84:87], v5, s[8:11], s33 offen sc1
    v_mfma_f32_16x16x32_bf16 v[28:31], v[56:59], v[100:103], v[28:31]
    s_waitcnt vmcnt(6)
SVB_135:
    v_max3_u32 v242, v104, v106, v108
    v_max_u32 v242, v242, v110
    v_cmp_eq_u32 vcc, -1, v242
    s_nop 0
    s_cbranch_vccnz SVS_136
    v_swap_b32 v106, v108
    v_swap_b32 v107, v109
SVB_135_AFTER:
    v_mfma_f32_16x16x32_bf16 v[32:35], v[60:63], v[96:99], v[32:35]
    v_mfma_f32_16x16x32_bf16 v[36:39], v[60:63], v[100:103], v[36:39]
    v_mfma_f32_16x16x32_bf16 v[40:43], v[64:67], v[96:99], v[40:43]
    v_mfma_f32_16x16x32_bf16 v[44:47], v[64:67], v[100:103], v[44:47]
    s_waitcnt lgkmcnt(5)
    v_mfma_f32_16x16x32_bf16 v[8:11], v[112:115], v[104:107], v[8:11]
    ds_read_b128 v[48:51], v3 offset:30720
    v_mfma_f32_16x16x32_bf16 v[12:15], v[112:115], v[108:111], v[12:15]
    ds_read_b128 v[52:55], v3 offset:31744
    s_mov_b32 s33, 393216
    s_cmp_lg_u32 s53, 0
    s_cmov_b32 s33, 786432
    s_add_u32 s33, s33, s56
    buffer_load_dwordx4 v[96:99], v4, s[8:11], s33 offen sc1
    v_mfma_f32_16x16x32_bf16 v[16:19], v[116:119], v[104:107], v[16:19]
    ds_read_b128 v[56:59], v3 offset:32768
    v_mfma_f32_16x16x32_bf16 v[20:23], v[116:119], v[108:111], v[20:23]
    ds_read_b128 v[60:63], v3 offset:33792
    v_mfma_f32_16x16x32_bf16 v[24:27], v[120:123], v[104:107], v[24:27]
    ds_read_b128 v[64:67], v3 offset:34816
    buffer_load_dwordx4 v[100:103], v5, s[8:11], s33 offen sc1
    v_mfma_f32_16x16x32_bf16 v[28:31], v[120:123], v[108:111], v[28:31]
    s_waitcnt vmcnt(6)
SVB_137:
    v_max3_u32 v242, v148, v150, v152
    v_max_u32 v242, v242, v154
    v_cmp_eq_u32 vcc, -1, v242
    s_nop 0
    s_cbranch_vccnz SVS_138
    v_swap_b32 v150, v152
    v_swap_b32 v151, v153
SVB_137_AFTER:
    v_mfma_f32_16x16x32_bf16 v[32:35], v[124:127], v[104:107], v[32:35]
    v_mfma_f32_16x16x32_bf16 v[36:39], v[124:127], v[108:111], v[36:39]
    v_mfma_f32_16x16x32_bf16 v[40:43], v[128:131], v[104:107], v[40:43]
    v_mfma_f32_16x16x32_bf16 v[44:47], v[128:131], v[108:111], v[44:47]
    s_waitcnt lgkmcnt(5)
    v_mfma_f32_16x16x32_bf16 v[8:11], v[164:167], v[148:151], v[8:11]
    ds_read_b128 v[112:115], v3 offset:40960
    v_mfma_f32_16x16x32_bf16 v[12:15], v[164:167], v[152:155], v[12:15]
    ds_read_b128 v[116:119], v3 offset:41984
    s_mov_b32 s33, 1179648
    s_cmp_lg_u32 s53, 0
    s_cmov_b32 s33, 1310720
    s_add_u32 s33, s33, s56
    buffer_load_dwordx4 v[104:107], v4, s[8:11], s33 offen sc1
    v_mfma_f32_16x16x32_bf16 v[16:19], v[168:171], v[148:151], v[16:19]
    ds_read_b128 v[120:123], v3 offset:43008
    v_mfma_f32_16x16x32_bf16 v[20:23], v[168:171], v[152:155], v[20:23]
    ds_read_b128 v[124:127], v3 offset:44032
    v_mfma_f32_16x16x32_bf16 v[24:27], v[172:175], v[148:151], v[24:27]
    ds_read_b128 v[128:131], v3 offset:45056
    buffer_load_dwordx4 v[108:111], v5, s[8:11], s33 offen sc1
    v_mfma_f32_16x16x32_bf16 v[28:31], v[172:175], v[152:155], v[28:31]
    s_waitcnt vmcnt(6)
SVB_139:
    v_max3_u32 v242, v72, v74, v76
    v_max_u32 v242, v242, v78
    v_cmp_eq_u32 vcc, -1, v242
    s_nop 0
    s_cbranch_vccnz SVS_140
    v_swap_b32 v74, v76
    v_swap_b32 v75, v77
SVB_139_AFTER:
    v_mfma_f32_16x16x32_bf16 v[32:35], v[176:179], v[148:151], v[32:35]
    v_mfma_f32_16x16x32_bf16 v[36:39], v[176:179], v[152:155], v[36:39]
    v_mfma_f32_16x16x32_bf16 v[40:43], v[180:183], v[148:151], v[40:43]
    v_mfma_f32_16x16x32_bf16 v[44:47], v[180:183], v[152:155], v[44:47]
    s_waitcnt lgkmcnt(5)
    v_mfma_f32_16x16x32_bf16 v[8:11], v[48:51], v[72:75], v[8:11]
    ds_read_b128 v[164:167], v3 offset:51200
    v_mfma_f32_16x16x32_bf16 v[12:15], v[48:51], v[76:79], v[12:15]
    ds_read_b128 v[168:171], v3 offset:52224
    s_mov_b32 s33, 1703936
    s_cmp_lg_u32 s53, 0
    s_cmov_b32 s33, 2097152
    s_add_u32 s33, s33, s56
    buffer_load_dwordx4 v[148:151], v4, s[8:11], s33 offen sc1
    v_mfma_f32_16x16x32_bf16 v[16:19], v[52:55], v[72:75], v[16:19]
    ds_read_b128 v[172:175], v3 offset:53248
    v_mfma_f32_16x16x32_bf16 v[20:23], v[52:55], v[76:79], v[20:23]
    ds_read_b128 v[176:179], v3 offset:54272
    v_mfma_f32_16x16x32_bf16 v[24:27], v[56:59], v[72:75], v[24:27]
    ds_read_b128 v[180:183], v3 offset:55296
    buffer_load_dwordx4 v[152:155], v5, s[8:11], s33 offen sc1
    v_mfma_f32_16x16x32_bf16 v[28:31], v[56:59], v[76:79], v[28:31]
    s_waitcnt vmcnt(6)
SVB_141:
    v_max3_u32 v242, v80, v82, v84
    v_max_u32 v242, v242, v86
    v_cmp_eq_u32 vcc, -1, v242
    s_nop 0
    s_cbranch_vccnz SVS_142
    v_swap_b32 v82, v84
    v_swap_b32 v83, v85
SVB_141_AFTER:
    v_mfma_f32_16x16x32_bf16 v[32:35], v[60:63], v[72:75], v[32:35]
    v_mfma_f32_16x16x32_bf16 v[36:39], v[60:63], v[76:79], v[36:39]
    v_mfma_f32_16x16x32_bf16 v[40:43], v[64:67], v[72:75], v[40:43]
    v_mfma_f32_16x16x32_bf16 v[44:47], v[64:67], v[76:79], v[44:47]
    s_waitcnt lgkmcnt(0)
    s_barrier
    v_mfma_f32_16x16x32_bf16 v[8:11], v[112:115], v[80:83], v[8:11]
    ds_read_b128 v[48:51], v3 offset:61440
    v_mfma_f32_16x16x32_bf16 v[12:15], v[112:115], v[84:87], v[12:15]
    ds_read_b128 v[52:55], v3 offset:62464
    s_mov_b32 s33, 2490368
    s_cmp_lg_u32 s53, 0
    s_cmov_b32 s33, 2621440
    s_add_u32 s33, s33, s56
    buffer_load_dwordx4 v[72:75], v4, s[8:11], s33 offen sc1
    v_mfma_f32_16x16x32_bf16 v[16:19], v[116:119], v[80:83], v[16:19]
    ds_read_b128 v[56:59], v3 offset:63488
    v_mfma_f32_16x16x32_bf16 v[20:23], v[116:119], v[84:87], v[20:23]
    ds_read_b128 v[60:63], v3 offset:64512
    v_mfma_f32_16x16x32_bf16 v[24:27], v[120:123], v[80:83], v[24:27]
    ds_read_b128 v[64:67], v2 offset:0
    buffer_load_dwordx4 v[76:79], v5, s[8:11], s33 offen sc1
    v_mfma_f32_16x16x32_bf16 v[28:31], v[120:123], v[84:87], v[28:31]
    s_waitcnt vmcnt(6)
SVB_143:
    v_max3_u32 v242, v96, v98, v100
    v_max_u32 v242, v242, v102
    v_cmp_eq_u32 vcc, -1, v242
    s_nop 0
    s_cbranch_vccnz SVS_144
    v_swap_b32 v98, v100
    v_swap_b32 v99, v101
SVB_143_AFTER:
    v_mfma_f32_16x16x32_bf16 v[32:35], v[124:127], v[80:83], v[32:35]
    v_mfma_f32_16x16x32_bf16 v[36:39], v[124:127], v[84:87], v[36:39]
    v_mfma_f32_16x16x32_bf16 v[40:43], v[128:131], v[80:83], v[40:43]
    v_mfma_f32_16x16x32_bf16 v[44:47], v[128:131], v[84:87], v[44:47]
    s_waitcnt lgkmcnt(5)
    v_mfma_f32_16x16x32_bf16 v[8:11], v[164:167], v[96:99], v[8:11]
    ds_read_b128 v[112:115], v2 offset:6144
    v_mfma_f32_16x16x32_bf16 v[12:15], v[164:167], v[100:103], v[12:15]
    ds_read_b128 v[116:119], v2 offset:7168
    s_mov_b32 s33, 3014656
    s_cmp_lg_u32 s53, 0
    s_cmov_b32 s33, 3407872
    s_add_u32 s33, s33, s56
    buffer_load_dwordx4 v[80:83], v4, s[8:11], s33 offen sc1
    v_mfma_f32_16x16x32_bf16 v[16:19], v[168:171], v[96:99], v[16:19]
    ds_read_b128 v[120:123], v2 offset:8192
    v_mfma_f32_16x16x32_bf16 v[20:23], v[168:171], v[100:103], v[20:23]
    ds_read_b128 v[124:127], v2 offset:9216
    v_mfma_f32_16x16x32_bf16 v[24:27], v[172:175], v[96:99], v[24:27]
    ds_read_b128 v[128:131], v2 offset:10240
    buffer_load_dwordx4 v[84:87], v5, s[8:11], s33 offen sc1
    v_mfma_f32_16x16x32_bf16 v[28:31], v[172:175], v[100:103], v[28:31]
    s_waitcnt vmcnt(6)
SVB_145:
    v_max3_u32 v242, v104, v106, v108
    v_max_u32 v242, v242, v110
    v_cmp_eq_u32 vcc, -1, v242
    s_nop 0
    s_cbranch_vccnz SVS_146
    v_swap_b32 v106, v108
    v_swap_b32 v107, v109
SVB_145_AFTER:
    v_mfma_f32_16x16x32_bf16 v[32:35], v[176:179], v[96:99], v[32:35]
    v_mfma_f32_16x16x32_bf16 v[36:39], v[176:179], v[100:103], v[36:39]
    v_mfma_f32_16x16x32_bf16 v[40:43], v[180:183], v[96:99], v[40:43]
    v_mfma_f32_16x16x32_bf16 v[44:47], v[180:183], v[100:103], v[44:47]
    s_waitcnt lgkmcnt(5)
    v_mfma_f32_16x16x32_bf16 v[8:11], v[48:51], v[104:107], v[8:11]
    ds_read_b128 v[164:167], v2 offset:16384
    v_mfma_f32_16x16x32_bf16 v[12:15], v[48:51], v[108:111], v[12:15]
    ds_read_b128 v[168:171], v2 offset:17408
    s_mov_b32 s33, 3932160
    s_cmp_lg_u32 s53, 0
    s_cmov_b32 s33, 4325376
    s_add_u32 s33, s33, s56
    buffer_load_dwordx4 v[96:99], v4, s[8:11], s33 offen sc1
    v_mfma_f32_16x16x32_bf16 v[16:19], v[52:55], v[104:107], v[16:19]
    ds_read_b128 v[172:175], v2 offset:18432
    v_mfma_f32_16x16x32_bf16 v[20:23], v[52:55], v[108:111], v[20:23]
    ds_read_b128 v[176:179], v2 offset:19456
    v_mfma_f32_16x16x32_bf16 v[24:27], v[56:59], v[104:107], v[24:27]
    ds_read_b128 v[180:183], v2 offset:20480
    buffer_load_dwordx4 v[100:103], v5, s[8:11], s33 offen sc1
    v_mfma_f32_16x16x32_bf16 v[28:31], v[56:59], v[108:111], v[28:31]
    s_waitcnt vmcnt(6)
SVB_147:
    v_max3_u32 v242, v148, v150, v152
    v_max_u32 v242, v242, v154
    v_cmp_eq_u32 vcc, -1, v242
    s_nop 0
    s_cbranch_vccnz SVS_148
    v_swap_b32 v150, v152
    v_swap_b32 v151, v153
SVB_147_AFTER:
    v_mfma_f32_16x16x32_bf16 v[32:35], v[60:63], v[104:107], v[32:35]
    v_mfma_f32_16x16x32_bf16 v[36:39], v[60:63], v[108:111], v[36:39]
    v_mfma_f32_16x16x32_bf16 v[40:43], v[64:67], v[104:107], v[40:43]
    v_mfma_f32_16x16x32_bf16 v[44:47], v[64:67], v[108:111], v[44:47]
    s_waitcnt lgkmcnt(5)
    v_mfma_f32_16x16x32_bf16 v[8:11], v[112:115], v[148:151], v[8:11]
    ds_read_b128 v[48:51], v2 offset:26624
    v_mfma_f32_16x16x32_bf16 v[12:15], v[112:115], v[152:155], v[12:15]
    ds_read_b128 v[52:55], v2 offset:27648
    s_mov_b32 s33, 4718592
    s_cmp_lg_u32 s53, 0
    s_cmov_b32 s33, 4849664
    s_add_u32 s33, s33, s56
    buffer_load_dwordx4 v[104:107], v4, s[8:11], s33 offen sc1
    v_mfma_f32_16x16x32_bf16 v[16:19], v[116:119], v[148:151], v[16:19]
    ds_read_b128 v[56:59], v2 offset:28672
    v_mfma_f32_16x16x32_bf16 v[20:23], v[116:119], v[152:155], v[20:23]
    ds_read_b128 v[60:63], v2 offset:29696
    v_mfma_f32_16x16x32_bf16 v[24:27], v[120:123], v[148:151], v[24:27]
    ds_read_b128 v[64:67], v2 offset:30720
    buffer_load_dwordx4 v[108:111], v5, s[8:11], s33 offen sc1
    v_mfma_f32_16x16x32_bf16 v[28:31], v[120:123], v[152:155], v[28:31]
    s_waitcnt vmcnt(6)
SVB_149:
    v_max3_u32 v242, v72, v74, v76
    v_max_u32 v242, v242, v78
    v_cmp_eq_u32 vcc, -1, v242
    s_nop 0
    s_cbranch_vccnz SVS_150
    v_swap_b32 v74, v76
    v_swap_b32 v75, v77
SVB_149_AFTER:
    v_mfma_f32_16x16x32_bf16 v[32:35], v[124:127], v[148:151], v[32:35]
    v_mfma_f32_16x16x32_bf16 v[36:39], v[124:127], v[152:155], v[36:39]
    v_mfma_f32_16x16x32_bf16 v[40:43], v[128:131], v[148:151], v[40:43]
    v_mfma_f32_16x16x32_bf16 v[44:47], v[128:131], v[152:155], v[44:47]
    s_waitcnt lgkmcnt(5)
    v_mul_u32_u24 v240, 81920, v7
    v_lshl_add_u32 v240, v6, 4, v240
    s_add_u32 s58, s55, s53
    s_lshl_b32 s58, s58, 3
    s_mul_i32 s59, s51, 327680
    s_add_u32 s58, s58, s59
    s_add_u32 s58, s58, 0x40000
    buffer_load_dwordx2 v[228:229], v240, s[8:11], s58 offen sc1
    s_add_u32 s58, s58, 16384
    buffer_load_dwordx2 v[230:231], v240, s[8:11], s58 offen sc1
    s_add_u32 s58, s58, 16384
    buffer_load_dwordx2 v[232:233], v240, s[8:11], s58 offen sc1
    s_add_u32 s58, s58, 16384
    buffer_load_dwordx2 v[234:235], v240, s[8:11], s58 offen sc1
    s_add_u32 s58, s58, 16384
    buffer_load_dwordx2 v[236:237], v240, s[8:11], s58 offen sc1
    v_mfma_f32_16x16x32_bf16 v[8:11], v[164:167], v[72:75], v[8:11]
    ds_read_b128 v[112:115], v2 offset:36864
    v_mfma_f32_16x16x32_bf16 v[12:15], v[164:167], v[76:79], v[12:15]
    ds_read_b128 v[116:119], v2 offset:37888
    s_mov_b32 s33, 5242880
    s_cmp_lg_u32 s53, 0
    s_cmov_b32 s33, 5636096
    s_add_u32 s33, s33, s56
    buffer_load_dwordx4 v[148:151], v4, s[8:11], s33 offen sc1
    v_mfma_f32_16x16x32_bf16 v[16:19], v[168:171], v[72:75], v[16:19]
    ds_read_b128 v[120:123], v2 offset:38912
    v_mfma_f32_16x16x32_bf16 v[20:23], v[168:171], v[76:79], v[20:23]
    ds_read_b128 v[124:127], v2 offset:39936
    v_mfma_f32_16x16x32_bf16 v[24:27], v[172:175], v[72:75], v[24:27]
    ds_read_b128 v[128:131], v2 offset:40960
    buffer_load_dwordx4 v[152:155], v5, s[8:11], s33 offen sc1
    v_mfma_f32_16x16x32_bf16 v[28:31], v[172:175], v[76:79], v[28:31]
    s_waitcnt vmcnt(11)
SVB_151:
    v_max3_u32 v242, v80, v82, v84
    v_max_u32 v242, v242, v86
    v_cmp_eq_u32 vcc, -1, v242
    s_nop 0
    s_cbranch_vccnz SVS_152
    v_swap_b32 v82, v84
    v_swap_b32 v83, v85
SVB_151_AFTER:
    v_mfma_f32_16x16x32_bf16 v[32:35], v[176:179], v[72:75], v[32:35]
    v_mfma_f32_16x16x32_bf16 v[36:39], v[176:179], v[76:79], v[36:39]
    v_mfma_f32_16x16x32_bf16 v[40:43], v[180:183], v[72:75], v[40:43]
    v_mfma_f32_16x16x32_bf16 v[44:47], v[180:183], v[76:79], v[44:47]
    s_waitcnt lgkmcnt(5)
    v_mfma_f32_16x16x32_bf16 v[8:11], v[48:51], v[80:83], v[8:11]
    ds_read_b128 v[164:167], v2 offset:47104
    v_mfma_f32_16x16x32_bf16 v[12:15], v[48:51], v[84:87], v[12:15]
    ds_read_b128 v[168:171], v2 offset:48128
    s_mov_b32 s33, 6029312
    s_cmp_lg_u32 s53, 0
    s_cmov_b32 s33, 6160384
    s_add_u32 s33, s33, s56
    buffer_load_dwordx4 v[72:75], v4, s[8:11], s33 offen sc1
    v_mfma_f32_16x16x32_bf16 v[16:19], v[52:55], v[80:83], v[16:19]
    ds_read_b128 v[172:175], v2 offset:49152
    v_mfma_f32_16x16x32_bf16 v[20:23], v[52:55], v[84:87], v[20:23]
    ds_read_b128 v[176:179], v2 offset:50176
    v_mfma_f32_16x16x32_bf16 v[24:27], v[56:59], v[80:83], v[24:27]
    ds_read_b128 v[180:183], v2 offset:51200
    buffer_load_dwordx4 v[76:79], v5, s[8:11], s33 offen sc1
    v_mfma_f32_16x16x32_bf16 v[28:31], v[56:59], v[84:87], v[28:31]
    s_waitcnt vmcnt(11)
SVB_153:
    v_max3_u32 v242, v96, v98, v100
    v_max_u32 v242, v242, v102
    v_cmp_eq_u32 vcc, -1, v242
    s_nop 0
    s_cbranch_vccnz SVS_154
    v_swap_b32 v98, v100
    v_swap_b32 v99, v101
SVB_153_AFTER:
    v_mfma_f32_16x16x32_bf16 v[32:35], v[60:63], v[80:83], v[32:35]
    v_mfma_f32_16x16x32_bf16 v[36:39], v[60:63], v[84:87], v[36:39]
    v_mfma_f32_16x16x32_bf16 v[40:43], v[64:67], v[80:83], v[40:43]
    v_mfma_f32_16x16x32_bf16 v[44:47], v[64:67], v[84:87], v[44:47]
    s_waitcnt lgkmcnt(0)
    s_barrier
    v_mfma_f32_16x16x32_bf16 v[8:11], v[112:115], v[96:99], v[8:11]
    ds_read_b128 v[48:51], v3 offset:0
    v_mfma_f32_16x16x32_bf16 v[12:15], v[112:115], v[100:103], v[12:15]
    ds_read_b128 v[52:55], v3 offset:1024
    s_mov_b32 s33, 6553600
    s_cmp_lg_u32 s53, 0
    s_cmov_b32 s33, 6946816
    s_add_u32 s33, s33, s56
    buffer_load_dwordx4 v[80:83], v4, s[8:11], s33 offen sc1
    v_mfma_f32_16x16x32_bf16 v[16:19], v[116:119], v[96:99], v[16:19]
    ds_read_b128 v[56:59], v3 offset:2048
    v_mfma_f32_16x16x32_bf16 v[20:23], v[116:119], v[100:103], v[20:23]
    ds_read_b128 v[60:63], v3 offset:3072
    v_mfma_f32_16x16x32_bf16 v[24:27], v[120:123], v[96:99], v[24:27]
    ds_read_b128 v[64:67], v3 offset:4096
    buffer_load_dwordx4 v[84:87], v5, s[8:11], s33 offen sc1
    v_mfma_f32_16x16x32_bf16 v[28:31], v[120:123], v[100:103], v[28:31]
    s_waitcnt vmcnt(11)
SVB_155:
    v_max3_u32 v242, v104, v106, v108
    v_max_u32 v242, v242, v110
    v_cmp_eq_u32 vcc, -1, v242
    s_nop 0
    s_cbranch_vccnz SVS_156
    v_swap_b32 v106, v108
    v_swap_b32 v107, v109
SVB_155_AFTER:
    v_mfma_f32_16x16x32_bf16 v[32:35], v[124:127], v[96:99], v[32:35]
    v_mfma_f32_16x16x32_bf16 v[36:39], v[124:127], v[100:103], v[36:39]
    v_mfma_f32_16x16x32_bf16 v[40:43], v[128:131], v[96:99], v[40:43]
    v_mfma_f32_16x16x32_bf16 v[44:47], v[128:131], v[100:103], v[44:47]
    s_waitcnt lgkmcnt(5)
    v_mfma_f32_16x16x32_bf16 v[8:11], v[164:167], v[104:107], v[8:11]
    ds_read_b128 v[112:115], v3 offset:10240
    v_mfma_f32_16x16x32_bf16 v[12:15], v[164:167], v[108:111], v[12:15]
    ds_read_b128 v[116:119], v3 offset:11264
    v_mfma_f32_16x16x32_bf16 v[16:19], v[168:171], v[104:107], v[16:19]
    ds_read_b128 v[120:123], v3 offset:12288
    v_mfma_f32_16x16x32_bf16 v[20:23], v[168:171], v[108:111], v[20:23]
    ds_read_b128 v[124:127], v3 offset:13312
    v_mfma_f32_16x16x32_bf16 v[24:27], v[172:175], v[104:107], v[24:27]
    ds_read_b128 v[128:131], v3 offset:14336
    v_mfma_f32_16x16x32_bf16 v[28:31], v[172:175], v[108:111], v[28:31]
    s_waitcnt vmcnt(4)
SVB_157:
    v_max3_u32 v242, v148, v150, v152
    v_max_u32 v242, v242, v154
    v_cmp_eq_u32 vcc, -1, v242
    s_nop 0
    s_cbranch_vccnz SVS_158
    v_swap_b32 v150, v152
    v_swap_b32 v151, v153
SVB_157_AFTER:
    v_mfma_f32_16x16x32_bf16 v[32:35], v[176:179], v[104:107], v[32:35]
    v_mfma_f32_16x16x32_bf16 v[36:39], v[176:179], v[108:111], v[36:39]
    v_mfma_f32_16x16x32_bf16 v[40:43], v[180:183], v[104:107], v[40:43]
    v_mfma_f32_16x16x32_bf16 v[44:47], v[180:183], v[108:111], v[44:47]
    s_waitcnt lgkmcnt(5)
    v_mfma_f32_16x16x32_bf16 v[8:11], v[48:51], v[148:151], v[8:11]
    ds_read_b128 v[164:167], v3 offset:20480
    v_mfma_f32_16x16x32_bf16 v[12:15], v[48:51], v[152:155], v[12:15]
    ds_read_b128 v[168:171], v3 offset:21504
    v_mfma_f32_16x16x32_bf16 v[16:19], v[52:55], v[148:151], v[16:19]
    ds_read_b128 v[172:175], v3 offset:22528
    v_mfma_f32_16x16x32_bf16 v[20:23], v[52:55], v[152:155], v[20:23]
    ds_read_b128 v[176:179], v3 offset:23552
    v_mfma_f32_16x16x32_bf16 v[24:27], v[56:59], v[148:151], v[24:27]
    ds_read_b128 v[180:183], v3 offset:24576
    v_mfma_f32_16x16x32_bf16 v[28:31], v[56:59], v[152:155], v[28:31]
    s_waitcnt vmcnt(2)
SVB_159:
    v_max3_u32 v242, v72, v74, v76
    v_max_u32 v242, v242, v78
    v_cmp_eq_u32 vcc, -1, v242
    s_nop 0
    s_cbranch_vccnz SVS_160
    v_swap_b32 v74, v76
    v_swap_b32 v75, v77
SVB_159_AFTER:
    v_mfma_f32_16x16x32_bf16 v[32:35], v[60:63], v[148:151], v[32:35]
    v_mfma_f32_16x16x32_bf16 v[36:39], v[60:63], v[152:155], v[36:39]
    v_mfma_f32_16x16x32_bf16 v[40:43], v[64:67], v[148:151], v[40:43]
    v_mfma_f32_16x16x32_bf16 v[44:47], v[64:67], v[152:155], v[44:47]
    s_waitcnt lgkmcnt(5)
    v_mfma_f32_16x16x32_bf16 v[8:11], v[112:115], v[72:75], v[8:11]
    v_mfma_f32_16x16x32_bf16 v[12:15], v[112:115], v[76:79], v[12:15]
    v_mfma_f32_16x16x32_bf16 v[16:19], v[116:119], v[72:75], v[16:19]
    v_mfma_f32_16x16x32_bf16 v[20:23], v[116:119], v[76:79], v[20:23]
    v_mfma_f32_16x16x32_bf16 v[24:27], v[120:123], v[72:75], v[24:27]
    v_mfma_f32_16x16x32_bf16 v[28:31], v[120:123], v[76:79], v[28:31]
    s_waitcnt vmcnt(0)
SVB_161:
    v_max3_u32 v242, v80, v82, v84
    v_max_u32 v242, v242, v86
    v_cmp_eq_u32 vcc, -1, v242
    s_nop 0
    s_cbranch_vccnz SVS_162
    v_swap_b32 v82, v84
    v_swap_b32 v83, v85
SVB_161_AFTER:
    v_mfma_f32_16x16x32_bf16 v[32:35], v[124:127], v[72:75], v[32:35]
    v_mfma_f32_16x16x32_bf16 v[36:39], v[124:127], v[76:79], v[36:39]
    v_mfma_f32_16x16x32_bf16 v[40:43], v[128:131], v[72:75], v[40:43]
    v_mfma_f32_16x16x32_bf16 v[44:47], v[128:131], v[76:79], v[44:47]
    s_waitcnt lgkmcnt(0)
    v_mfma_f32_16x16x32_bf16 v[8:11], v[164:167], v[80:83], v[8:11]
    v_mfma_f32_16x16x32_bf16 v[12:15], v[164:167], v[84:87], v[12:15]
    v_mfma_f32_16x16x32_bf16 v[16:19], v[168:171], v[80:83], v[16:19]
    v_mfma_f32_16x16x32_bf16 v[20:23], v[168:171], v[84:87], v[20:23]
    v_mfma_f32_16x16x32_bf16 v[24:27], v[172:175], v[80:83], v[24:27]
    v_mfma_f32_16x16x32_bf16 v[28:31], v[172:175], v[84:87], v[28:31]
    v_mfma_f32_16x16x32_bf16 v[32:35], v[176:179], v[80:83], v[32:35]
    v_mfma_f32_16x16x32_bf16 v[36:39], v[176:179], v[84:87], v[36:39]
    v_mfma_f32_16x16x32_bf16 v[40:43], v[180:183], v[80:83], v[40:43]
    v_mfma_f32_16x16x32_bf16 v[44:47], v[180:183], v[84:87], v[44:47]
    s_waitcnt lgkmcnt(0)
    s_barrier
    v_mbcnt_lo_u32_b32 v3, -1, 0
    v_mbcnt_hi_u32_b32 v3, -1, v3
    v_lshlrev_b32 v3, 4, v3
    s_mul_i32 s57, s24, 5120
    v_add_u32 v241, s57, v3
    s_xor_b32 s59, s24, 2
    s_mul_i32 s59, s59, 5120
    v_add_u32 v242, s59, v3
    s_cmp_eq_u32 s53, 0
    s_cbranch_scc1 KH0_163
    ds_write_b128 v241, v[8:11] offset:0
    v_mov_b32 v48, v12
    v_mov_b32 v49, v13
    v_mov_b32 v50, v14
    v_mov_b32 v51, v15
    ds_write_b128 v241, v[16:19] offset:1024
    v_mov_b32 v52, v20
    v_mov_b32 v53, v21
    v_mov_b32 v54, v22
    v_mov_b32 v55, v23
    ds_write_b128 v241, v[24:27] offset:2048
    v_mov_b32 v56, v28
    v_mov_b32 v57, v29
    v_mov_b32 v58, v30
    v_mov_b32 v59, v31
    ds_write_b128 v241, v[32:35] offset:3072
    v_mov_b32 v60, v36
    v_mov_b32 v61, v37
    v_mov_b32 v62, v38
    v_mov_b32 v63, v39
    ds_write_b128 v241, v[40:43] offset:4096
    v_mov_b32 v64, v44
    v_mov_b32 v65, v45
    v_mov_b32 v66, v46
    v_mov_b32 v67, v47
    s_branch RED_164
KH0_163:
    ds_write_b128 v241, v[12:15] offset:0
    v_mov_b32 v48, v8
    v_mov_b32 v49, v9
    v_mov_b32 v50, v10
    v_mov_b32 v51, v11
    ds_write_b128 v241, v[20:23] offset:1024
    v_mov_b32 v52, v16
    v_mov_b32 v53, v17
    v_mov_b32 v54, v18
    v_mov_b32 v55, v19
    ds_write_b128 v241, v[28:31] offset:2048
    v_mov_b32 v56, v24
    v_mov_b32 v57, v25
    v_mov_b32 v58, v26
    v_mov_b32 v59, v27
    ds_write_b128 v241, v[36:39] offset:3072
    v_mov_b32 v60, v32
    v_mov_b32 v61, v33
    v_mov_b32 v62, v34
    v_mov_b32 v63, v35
    ds_write_b128 v241, v[44:47] offset:4096
    v_mov_b32 v64, v40
    v_mov_b32 v65, v41
    v_mov_b32 v66, v42
    v_mov_b32 v67, v43
RED_164:
    s_waitcnt lgkmcnt(0)
    s_barrier
    ds_read_b128 v[112:115], v242 offset:0
    ds_read_b128 v[116:119], v242 offset:1024
    ds_read_b128 v[120:123], v242 offset:2048
    ds_read_b128 v[124:127], v242 offset:3072
    ds_read_b128 v[128:131], v242 offset:4096
    s_mov_b32 s16, s90
    s_mov_b32 s17, s91
    s_mov_b32 s18, 0x280000
    s_mov_b32 s19, 0x20000
    v_mul_u32_u24 v240, 2560, v6
    v_mul_u32_u24 v243, 40, v7
    v_add_u32 v240, v240, v243
    s_add_u32 s58, s55, s53
    s_mul_i32 s58, s58, 1280
    s_mul_i32 s59, s51, 160
    s_add_u32 s58, s58, s59
    s_waitcnt vmcnt(6)
    s_waitcnt lgkmcnt(4)
    v_lshlrev_b32 v164, 16, v228
    v_and_b32 v165, 0xffff0000, v228
    v_lshlrev_b32 v166, 16, v229
    v_and_b32 v167, 0xffff0000, v229
    v_add_f32 v48, v48, v112
    v_add_f32 v164, v164, v48
    v_add_f32 v49, v49, v113
    v_add_f32 v165, v165, v49
    v_add_f32 v50, v50, v114
    v_add_f32 v166, v166, v50
    v_add_f32 v51, v51, v115
    v_add_f32 v167, v167, v51
    v_cvt_pk_bf16_f32 v228, v164, v165
    v_cvt_pk_bf16_f32 v229, v166, v167
    buffer_store_dwordx2 v[228:229], v240, s[16:19], s58 offen offset:0
    s_waitcnt lgkmcnt(3)
    v_lshlrev_b32 v168, 16, v230
    v_and_b32 v169, 0xffff0000, v230
    v_lshlrev_b32 v170, 16, v231
    v_and_b32 v171, 0xffff0000, v231
    v_add_f32 v52, v52, v116
    v_add_f32 v168, v168, v52
    v_add_f32 v53, v53, v117
    v_add_f32 v169, v169, v53
    v_add_f32 v54, v54, v118
    v_add_f32 v170, v170, v54
    v_add_f32 v55, v55, v119
    v_add_f32 v171, v171, v55
    v_cvt_pk_bf16_f32 v230, v168, v169
    v_cvt_pk_bf16_f32 v231, v170, v171
    buffer_store_dwordx2 v[230:231], v240, s[16:19], s58 offen offset:8
    s_waitcnt lgkmcnt(2)
    v_lshlrev_b32 v172, 16, v232
    v_and_b32 v173, 0xffff0000, v232
    v_lshlrev_b32 v174, 16, v233
    v_and_b32 v175, 0xffff0000, v233
    v_add_f32 v56, v56, v120
    v_add_f32 v172, v172, v56
    v_add_f32 v57, v57, v121
    v_add_f32 v173, v173, v57
    v_add_f32 v58, v58, v122
    v_add_f32 v174, v174, v58
    v_add_f32 v59, v59, v123
    v_add_f32 v175, v175, v59
    v_cvt_pk_bf16_f32 v232, v172, v173
    v_cvt_pk_bf16_f32 v233, v174, v175
    buffer_store_dwordx2 v[232:233], v240, s[16:19], s58 offen offset:16
    s_waitcnt lgkmcnt(1)
    v_lshlrev_b32 v176, 16, v234
    v_and_b32 v177, 0xffff0000, v234
    v_lshlrev_b32 v178, 16, v235
    v_and_b32 v179, 0xffff0000, v235
    v_add_f32 v60, v60, v124
    v_add_f32 v176, v176, v60
    v_add_f32 v61, v61, v125
    v_add_f32 v177, v177, v61
    v_add_f32 v62, v62, v126
    v_add_f32 v178, v178, v62
    v_add_f32 v63, v63, v127
    v_add_f32 v179, v179, v63
    v_cvt_pk_bf16_f32 v234, v176, v177
    v_cvt_pk_bf16_f32 v235, v178, v179
    buffer_store_dwordx2 v[234:235], v240, s[16:19], s58 offen offset:24
    s_waitcnt lgkmcnt(0)
    v_lshlrev_b32 v180, 16, v236
    v_and_b32 v181, 0xffff0000, v236
    v_lshlrev_b32 v182, 16, v237
    v_and_b32 v183, 0xffff0000, v237
    v_add_f32 v64, v64, v128
    v_add_f32 v180, v180, v64
    v_add_f32 v65, v65, v129
    v_add_f32 v181, v181, v65
    v_add_f32 v66, v66, v130
    v_add_f32 v182, v182, v66
    v_add_f32 v67, v67, v131
    v_add_f32 v183, v183, v67
    v_cvt_pk_bf16_f32 v236, v180, v181
    v_cvt_pk_bf16_f32 v237, v182, v183
    buffer_store_dwordx2 v[236:237], v240, s[16:19], s58 offen offset:32
    s_endpgm
SVS_66:
    s_add_u32 s100, s100, 1
    s_cmp_gt_u32 s100, 200000
    s_cbranch_scc1 SVX_165
    s_waitcnt vmcnt(0)
    s_add_u32 s35, s26, 0
    buffer_load_dwordx4 v[168:171], v4, s[8:11], s35 offen sc1
    buffer_load_dwordx4 v[172:175], v5, s[8:11], s35 offen sc1
    s_add_u32 s35, s26, 131072
    buffer_load_dwordx4 v[176:179], v4, s[8:11], s35 offen sc1
    buffer_load_dwordx4 v[180:183], v5, s[8:11], s35 offen sc1
    s_add_u32 s35, s26, 262144
    buffer_load_dwordx4 v[184:187], v4, s[8:11], s35 offen sc1
    buffer_load_dwordx4 v[188:191], v5, s[8:11], s35 offen sc1
    s_add_u32 s35, s26, 393216
    buffer_load_dwordx4 v[192:195], v4, s[8:11], s35 offen sc1
    buffer_load_dwordx4 v[196:199], v5, s[8:11], s35 offen sc1
    s_add_u32 s35, s26, 524288
    buffer_load_dwordx4 v[200:203], v4, s[8:11], s35 offen sc1
    buffer_load_dwordx4 v[204:207], v5, s[8:11], s35 offen sc1
    s_add_u32 s35, s26, 655360
    buffer_load_dwordx4 v[208:211], v4, s[8:11], s35 offen sc1
    buffer_load_dwordx4 v[212:215], v5, s[8:11], s35 offen sc1
    s_add_u32 s35, s26, 786432
    buffer_load_dwordx4 v[216:219], v4, s[8:11], s35 offen sc1
    buffer_load_dwordx4 v[220:223], v5, s[8:11], s35 offen sc1
    s_add_u32 s35, s26, 917504
    buffer_load_dwordx4 v[224:227], v4, s[8:11], s35 offen sc1
    buffer_load_dwordx4 v[228:231], v5, s[8:11], s35 offen sc1
    s_add_u32 s35, s26, 1048576
    buffer_load_dwordx4 v[232:235], v4, s[8:11], s35 offen sc1
    buffer_load_dwordx4 v[236:239], v5, s[8:11], s35 offen sc1
    s_waitcnt vmcnt(16)
    s_branch SVB_65
SVX_165:
    v_swap_b32 v170, v172
    v_swap_b32 v171, v173
    s_branch SVB_65_AFTER
SVS_68:
    s_add_u32 s100, s100, 1
    s_cmp_gt_u32 s100, 200000
    s_cbranch_scc1 SVX_166
    s_waitcnt vmcnt(0)
    s_add_u32 s35, s26, 131072
    buffer_load_dwordx4 v[176:179], v4, s[8:11], s35 offen sc1
    buffer_load_dwordx4 v[180:183], v5, s[8:11], s35 offen sc1
    s_add_u32 s35, s26, 262144
    buffer_load_dwordx4 v[184:187], v4, s[8:11], s35 offen sc1
    buffer_load_dwordx4 v[188:191], v5, s[8:11], s35 offen sc1
    s_add_u32 s35, s26, 393216
    buffer_load_dwordx4 v[192:195], v4, s[8:11], s35 offen sc1
    buffer_load_dwordx4 v[196:199], v5, s[8:11], s35 offen sc1
    s_add_u32 s35, s26, 524288
    buffer_load_dwordx4 v[200:203], v4, s[8:11], s35 offen sc1
    buffer_load_dwordx4 v[204:207], v5, s[8:11], s35 offen sc1
    s_add_u32 s35, s26, 655360
    buffer_load_dwordx4 v[208:211], v4, s[8:11], s35 offen sc1
    buffer_load_dwordx4 v[212:215], v5, s[8:11], s35 offen sc1
    s_add_u32 s35, s26, 786432
    buffer_load_dwordx4 v[216:219], v4, s[8:11], s35 offen sc1
    buffer_load_dwordx4 v[220:223], v5, s[8:11], s35 offen sc1
    s_add_u32 s35, s26, 917504
    buffer_load_dwordx4 v[224:227], v4, s[8:11], s35 offen sc1
    buffer_load_dwordx4 v[228:231], v5, s[8:11], s35 offen sc1
    s_add_u32 s35, s26, 1048576
    buffer_load_dwordx4 v[232:235], v4, s[8:11], s35 offen sc1
    buffer_load_dwordx4 v[236:239], v5, s[8:11], s35 offen sc1
    s_add_u32 s35, s26, 1179648
    buffer_load_dwordx4 v[240:243], v4, s[8:11], s35 offen sc1
    buffer_load_dwordx4 v[244:247], v5, s[8:11], s35 offen sc1
    s_waitcnt vmcnt(16)
    s_branch SVB_67
SVX_166:
    v_swap_b32 v178, v180
    v_swap_b32 v179, v181
    s_branch SVB_67_AFTER
SVS_70:
    s_add_u32 s100, s100, 1
    s_cmp_gt_u32 s100, 200000
    s_cbranch_scc1 SVX_167
    s_waitcnt vmcnt(0)
    s_add_u32 s35, s26, 262144
    buffer_load_dwordx4 v[184:187], v4, s[8:11], s35 offen sc1
    buffer_load_dwordx4 v[188:191], v5, s[8:11], s35 offen sc1
    s_add_u32 s35, s26, 393216
    buffer_load_dwordx4 v[192:195], v4, s[8:11], s35 offen sc1
    buffer_load_dwordx4 v[196:199], v5, s[8:11], s35 offen sc1
    s_add_u32 s35, s26, 524288
    buffer_load_dwordx4 v[200:203], v4, s[8:11], s35 offen sc1
    buffer_load_dwordx4 v[204:207], v5, s[8:11], s35 offen sc1
    s_add_u32 s35, s26, 655360
    buffer_load_dwordx4 v[208:211], v4, s[8:11], s35 offen sc1
    buffer_load_dwordx4 v[212:215], v5, s[8:11], s35 offen sc1
    s_add_u32 s35, s26, 786432
    buffer_load_dwordx4 v[216:219], v4, s[8:11], s35 offen sc1
    buffer_load_dwordx4 v[220:223], v5, s[8:11], s35 offen sc1
    s_add_u32 s35, s26, 917504
    buffer_load_dwordx4 v[224:227], v4, s[8:11], s35 offen sc1
    buffer_load_dwordx4 v[228:231], v5, s[8:11], s35 offen sc1
    s_add_u32 s35, s26, 1048576
    buffer_load_dwordx4 v[232:235], v4, s[8:11], s35 offen sc1
    buffer_load_dwordx4 v[236:239], v5, s[8:11], s35 offen sc1
    s_add_u32 s35, s26, 1179648
    buffer_load_dwordx4 v[240:243], v4, s[8:11], s35 offen sc1
    buffer_load_dwordx4 v[244:247], v5, s[8:11], s35 offen sc1
    s_add_u32 s35, s26, 1310720
    buffer_load_dwordx4 v[168:171], v4, s[8:11], s35 offen sc1
    buffer_load_dwordx4 v[172:175], v5, s[8:11], s35 offen sc1
    s_waitcnt vmcnt(16)
    s_branch SVB_69
SVX_167:
    v_swap_b32 v186, v188
    v_swap_b32 v187, v189
    s_branch SVB_69_AFTER
SVS_72:
    s_add_u32 s100, s100, 1
    s_cmp_gt_u32 s100, 200000
    s_cbranch_scc1 SVX_168
    s_waitcnt vmcnt(0)
    s_add_u32 s35, s26, 393216
    buffer_load_dwordx4 v[192:195], v4, s[8:11], s35 offen sc1
    buffer_load_dwordx4 v[196:199], v5, s[8:11], s35 offen sc1
    s_add_u32 s35, s26, 524288
    buffer_load_dwordx4 v[200:203], v4, s[8:11], s35 offen sc1
    buffer_load_dwordx4 v[204:207], v5, s[8:11], s35 offen sc1
    s_add_u32 s35, s26, 655360
    buffer_load_dwordx4 v[208:211], v4, s[8:11], s35 offen sc1
    buffer_load_dwordx4 v[212:215], v5, s[8:11], s35 offen sc1
    s_add_u32 s35, s26, 786432
    buffer_load_dwordx4 v[216:219], v4, s[8:11], s35 offen sc1
    buffer_load_dwordx4 v[220:223], v5, s[8:11], s35 offen sc1
    s_add_u32 s35, s26, 917504
    buffer_load_dwordx4 v[224:227], v4, s[8:11], s35 offen sc1
    buffer_load_dwordx4 v[228:231], v5, s[8:11], s35 offen sc1
    s_add_u32 s35, s26, 1048576
    buffer_load_dwordx4 v[232:235], v4, s[8:11], s35 offen sc1
    buffer_load_dwordx4 v[236:239], v5, s[8:11], s35 offen sc1
    s_add_u32 s35, s26, 1179648
    buffer_load_dwordx4 v[240:243], v4, s[8:11], s35 offen sc1
    buffer_load_dwordx4 v[244:247], v5, s[8:11], s35 offen sc1
    s_add_u32 s35, s26, 1310720
    buffer_load_dwordx4 v[168:171], v4, s[8:11], s35 offen sc1
    buffer_load_dwordx4 v[172:175], v5, s[8:11], s35 offen sc1
    s_add_u32 s35, s26, 1441792
    buffer_load_dwordx4 v[176:179], v4, s[8:11], s35 offen sc1
    buffer_load_dwordx4 v[180:183], v5, s[8:11], s35 offen sc1
    s_waitcnt vmcnt(16)
    s_branch SVB_71
SVX_168:
    v_swap_b32 v194, v196
    v_swap_b32 v195, v197
    s_branch SVB_71_AFTER
SVS_74:
    s_add_u32 s100, s100, 1
    s_cmp_gt_u32 s100, 200000
    s_cbranch_scc1 SVX_169
    s_waitcnt vmcnt(0)
    s_add_u32 s35, s26, 524288
    buffer_load_dwordx4 v[200:203], v4, s[8:11], s35 offen sc1
    buffer_load_dwordx4 v[204:207], v5, s[8:11], s35 offen sc1
    s_add_u32 s35, s26, 655360
    buffer_load_dwordx4 v[208:211], v4, s[8:11], s35 offen sc1
    buffer_load_dwordx4 v[212:215], v5, s[8:11], s35 offen sc1
    s_add_u32 s35, s26, 786432
    buffer_load_dwordx4 v[216:219], v4, s[8:11], s35 offen sc1
    buffer_load_dwordx4 v[220:223], v5, s[8:11], s35 offen sc1
    s_add_u32 s35, s26, 917504
    buffer_load_dwordx4 v[224:227], v4, s[8:11], s35 offen sc1
    buffer_load_dwordx4 v[228:231], v5, s[8:11], s35 offen sc1
    s_add_u32 s35, s26, 1048576
    buffer_load_dwordx4 v[232:235], v4, s[8:11], s35 offen sc1
    buffer_load_dwordx4 v[236:239], v5, s[8:11], s35 offen sc1
    s_add_u32 s35, s26, 1179648
    buffer_load_dwordx4 v[240:243], v4, s[8:11], s35 offen sc1
    buffer_load_dwordx4 v[244:247], v5, s[8:11], s35 offen sc1
    s_add_u32 s35, s26, 1310720
    buffer_load_dwordx4 v[168:171], v4, s[8:11], s35 offen sc1
    buffer_load_dwordx4 v[172:175], v5, s[8:11], s35 offen sc1
    s_add_u32 s35, s26, 1441792
    buffer_load_dwordx4 v[176:179], v4, s[8:11], s35 offen sc1
    buffer_load_dwordx4 v[180:183], v5, s[8:11], s35 offen sc1
    s_add_u32 s35, s26, 1572864
    buffer_load_dwordx4 v[184:187], v4, s[8:11], s35 offen sc1
    buffer_load_dwordx4 v[188:191], v5, s[8:11], s35 offen sc1
    s_waitcnt vmcnt(16)
    s_branch SVB_73
SVX_169:
    v_swap_b32 v202, v204
    v_swap_b32 v203, v205
    s_branch SVB_73_AFTER
SVS_76:
    s_add_u32 s100, s100, 1
    s_cmp_gt_u32 s100, 200000
    s_cbranch_scc1 SVX_170
    s_waitcnt vmcnt(0)
    s_add_u32 s35, s26, 655360
    buffer_load_dwordx4 v[208:211], v4, s[8:11], s35 offen sc1
    buffer_load_dwordx4 v[212:215], v5, s[8:11], s35 offen sc1
    s_add_u32 s35, s26, 786432
    buffer_load_dwordx4 v[216:219], v4, s[8:11], s35 offen sc1
    buffer_load_dwordx4 v[220:223], v5, s[8:11], s35 offen sc1
    s_add_u32 s35, s26, 917504
    buffer_load_dwordx4 v[224:227], v4, s[8:11], s35 offen sc1
    buffer_load_dwordx4 v[228:231], v5, s[8:11], s35 offen sc1
    s_add_u32 s35, s26, 1048576
    buffer_load_dwordx4 v[232:235], v4, s[8:11], s35 offen sc1
    buffer_load_dwordx4 v[236:239], v5, s[8:11], s35 offen sc1
    s_add_u32 s35, s26, 1179648
    buffer_load_dwordx4 v[240:243], v4, s[8:11], s35 offen sc1
    buffer_load_dwordx4 v[244:247], v5, s[8:11], s35 offen sc1
    s_add_u32 s35, s26, 1310720
    buffer_load_dwordx4 v[168:171], v4, s[8:11], s35 offen sc1
    buffer_load_dwordx4 v[172:175], v5, s[8:11], s35 offen sc1
    s_add_u32 s35, s26, 1441792
    buffer_load_dwordx4 v[176:179], v4, s[8:11], s35 offen sc1
    buffer_load_dwordx4 v[180:183], v5, s[8:11], s35 offen sc1
    s_add_u32 s35, s26, 1572864
    buffer_load_dwordx4 v[184:187], v4, s[8:11], s35 offen sc1
    buffer_load_dwordx4 v[188:191], v5, s[8:11], s35 offen sc1
    s_add_u32 s35, s26, 1703936
    buffer_load_dwordx4 v[192:195], v4, s[8:11], s35 offen sc1
    buffer_load_dwordx4 v[196:199], v5, s[8:11], s35 offen sc1
    s_waitcnt vmcnt(16)
    s_branch SVB_75
SVX_170:
    v_swap_b32 v210, v212
    v_swap_b32 v211, v213
    s_branch SVB_75_AFTER
SVS_78:
    s_add_u32 s100, s100, 1
    s_cmp_gt_u32 s100, 200000
    s_cbranch_scc1 SVX_171
    s_waitcnt vmcnt(0)
    s_add_u32 s35, s26, 786432
    buffer_load_dwordx4 v[216:219], v4, s[8:11], s35 offen sc1
    buffer_load_dwordx4 v[220:223], v5, s[8:11], s35 offen sc1
    s_add_u32 s35, s26, 917504
    buffer_load_dwordx4 v[224:227], v4, s[8:11], s35 offen sc1
    buffer_load_dwordx4 v[228:231], v5, s[8:11], s35 offen sc1
    s_add_u32 s35, s26, 1048576
    buffer_load_dwordx4 v[232:235], v4, s[8:11], s35 offen sc1
    buffer_load_dwordx4 v[236:239], v5, s[8:11], s35 offen sc1
    s_add_u32 s35, s26, 1179648
    buffer_load_dwordx4 v[240:243], v4, s[8:11], s35 offen sc1
    buffer_load_dwordx4 v[244:247], v5, s[8:11], s35 offen sc1
    s_add_u32 s35, s26, 1310720
    buffer_load_dwordx4 v[168:171], v4, s[8:11], s35 offen sc1
    buffer_load_dwordx4 v[172:175], v5, s[8:11], s35 offen sc1
    s_add_u32 s35, s26, 1441792
    buffer_load_dwordx4 v[176:179], v4, s[8:11], s35 offen sc1
    buffer_load_dwordx4 v[180:183], v5, s[8:11], s35 offen sc1
    s_add_u32 s35, s26, 1572864
    buffer_load_dwordx4 v[184:187], v4, s[8:11], s35 offen sc1
    buffer_load_dwordx4 v[188:191], v5, s[8:11], s35 offen sc1
    s_add_u32 s35, s26, 1703936
    buffer_load_dwordx4 v[192:195], v4, s[8:11], s35 offen sc1
    buffer_load_dwordx4 v[196:199], v5, s[8:11], s35 offen sc1
    s_add_u32 s35, s26, 1835008
    buffer_load_dwordx4 v[200:203], v4, s[8:11], s35 offen sc1
    buffer_load_dwordx4 v[204:207], v5, s[8:11], s35 offen sc1
    s_waitcnt vmcnt(16)
    s_branch SVB_77
SVX_171:
    v_swap_b32 v218, v220
    v_swap_b32 v219, v221
    s_branch SVB_77_AFTER
SVS_80:
    s_add_u32 s100, s100, 1
    s_cmp_gt_u32 s100, 200000
    s_cbranch_scc1 SVX_172
    s_waitcnt vmcnt(0)
    s_add_u32 s35, s26, 917504
    buffer_load_dwordx4 v[224:227], v4, s[8:11], s35 offen sc1
    buffer_load_dwordx4 v[228:231], v5, s[8:11], s35 offen sc1
    s_add_u32 s35, s26, 1048576
    buffer_load_dwordx4 v[232:235], v4, s[8:11], s35 offen sc1
    buffer_load_dwordx4 v[236:239], v5, s[8:11], s35 offen sc1
    s_add_u32 s35, s26, 1179648
    buffer_load_dwordx4 v[240:243], v4, s[8:11], s35 offen sc1
    buffer_load_dwordx4 v[244:247], v5, s[8:11], s35 offen sc1
    s_add_u32 s35, s26, 1310720
    buffer_load_dwordx4 v[168:171], v4, s[8:11], s35 offen sc1
    buffer_load_dwordx4 v[172:175], v5, s[8:11], s35 offen sc1
    s_add_u32 s35, s26, 1441792
    buffer_load_dwordx4 v[176:179], v4, s[8:11], s35 offen sc1
    buffer_load_dwordx4 v[180:183], v5, s[8:11], s35 offen sc1
    s_add_u32 s35, s26, 1572864
    buffer_load_dwordx4 v[184:187], v4, s[8:11], s35 offen sc1
    buffer_load_dwordx4 v[188:191], v5, s[8:11], s35 offen sc1
    s_add_u32 s35, s26, 1703936
    buffer_load_dwordx4 v[192:195], v4, s[8:11], s35 offen sc1
    buffer_load_dwordx4 v[196:199], v5, s[8:11], s35 offen sc1
    s_add_u32 s35, s26, 1835008
    buffer_load_dwordx4 v[200:203], v4, s[8:11], s35 offen sc1
    buffer_load_dwordx4 v[204:207], v5, s[8:11], s35 offen sc1
    s_add_u32 s35, s26, 1966080
    buffer_load_dwordx4 v[208:211], v4, s[8:11], s35 offen sc1
    buffer_load_dwordx4 v[212:215], v5, s[8:11], s35 offen sc1
    s_waitcnt vmcnt(16)
    s_branch SVB_79
SVX_172:
    v_swap_b32 v226, v228
    v_swap_b32 v227, v229
    s_branch SVB_79_AFTER
SVS_82:
    s_add_u32 s100, s100, 1
    s_cmp_gt_u32 s100, 200000
    s_cbranch_scc1 SVX_173
    s_waitcnt vmcnt(0)
    s_add_u32 s35, s26, 1048576
    buffer_load_dwordx4 v[232:235], v4, s[8:11], s35 offen sc1
    buffer_load_dwordx4 v[236:239], v5, s[8:11], s35 offen sc1
    s_add_u32 s35, s26, 1179648
    buffer_load_dwordx4 v[240:243], v4, s[8:11], s35 offen sc1
    buffer_load_dwordx4 v[244:247], v5, s[8:11], s35 offen sc1
    s_add_u32 s35, s26, 1310720
    buffer_load_dwordx4 v[168:171], v4, s[8:11], s35 offen sc1
    buffer_load_dwordx4 v[172:175], v5, s[8:11], s35 offen sc1
    s_add_u32 s35, s26, 1441792
    buffer_load_dwordx4 v[176:179], v4, s[8:11], s35 offen sc1
    buffer_load_dwordx4 v[180:183], v5, s[8:11], s35 offen sc1
    s_add_u32 s35, s26, 1572864
    buffer_load_dwordx4 v[184:187], v4, s[8:11], s35 offen sc1
    buffer_load_dwordx4 v[188:191], v5, s[8:11], s35 offen sc1
    s_add_u32 s35, s26, 1703936
    buffer_load_dwordx4 v[192:195], v4, s[8:11], s35 offen sc1
    buffer_load_dwordx4 v[196:199], v5, s[8:11], s35 offen sc1
    s_add_u32 s35, s26, 1835008
    buffer_load_dwordx4 v[200:203], v4, s[8:11], s35 offen sc1
    buffer_load_dwordx4 v[204:207], v5, s[8:11], s35 offen sc1
    s_add_u32 s35, s26, 1966080
    buffer_load_dwordx4 v[208:211], v4, s[8:11], s35 offen sc1
    buffer_load_dwordx4 v[212:215], v5, s[8:11], s35 offen sc1
    s_add_u32 s35, s26, 2097152
    buffer_load_dwordx4 v[216:219], v4, s[8:11], s35 offen sc1
    buffer_load_dwordx4 v[220:223], v5, s[8:11], s35 offen sc1
    s_waitcnt vmcnt(16)
    s_branch SVB_81
SVX_173:
    v_swap_b32 v234, v236
    v_swap_b32 v235, v237
    s_branch SVB_81_AFTER
SVS_84:
    s_add_u32 s100, s100, 1
    s_cmp_gt_u32 s100, 200000
    s_cbranch_scc1 SVX_174
    s_waitcnt vmcnt(0)
    s_add_u32 s35, s26, 1179648
    buffer_load_dwordx4 v[240:243], v4, s[8:11], s35 offen sc1
    buffer_load_dwordx4 v[244:247], v5, s[8:11], s35 offen sc1
    s_add_u32 s35, s26, 1310720
    buffer_load_dwordx4 v[168:171], v4, s[8:11], s35 offen sc1
    buffer_load_dwordx4 v[172:175], v5, s[8:11], s35 offen sc1
    s_add_u32 s35, s26, 1441792
    buffer_load_dwordx4 v[176:179], v4, s[8:11], s35 offen sc1
    buffer_load_dwordx4 v[180:183], v5, s[8:11], s35 offen sc1
    s_add_u32 s35, s26, 1572864
    buffer_load_dwordx4 v[184:187], v4, s[8:11], s35 offen sc1
    buffer_load_dwordx4 v[188:191], v5, s[8:11], s35 offen sc1
    s_add_u32 s35, s26, 1703936
    buffer_load_dwordx4 v[192:195], v4, s[8:11], s35 offen sc1
    buffer_load_dwordx4 v[196:199], v5, s[8:11], s35 offen sc1
    s_add_u32 s35, s26, 1835008
    buffer_load_dwordx4 v[200:203], v4, s[8:11], s35 offen sc1
    buffer_load_dwordx4 v[204:207], v5, s[8:11], s35 offen sc1
    s_add_u32 s35, s26, 1966080
    buffer_load_dwordx4 v[208:211], v4, s[8:11], s35 offen sc1
    buffer_load_dwordx4 v[212:215], v5, s[8:11], s35 offen sc1
    s_add_u32 s35, s26, 2097152
    buffer_load_dwordx4 v[216:219], v4, s[8:11], s35 offen sc1
    buffer_load_dwordx4 v[220:223], v5, s[8:11], s35 offen sc1
    s_add_u32 s35, s26, 2228224
    buffer_load_dwordx4 v[224:227], v4, s[8:11], s35 offen sc1
    buffer_load_dwordx4 v[228:231], v5, s[8:11], s35 offen sc1
    s_waitcnt vmcnt(16)
    s_branch SVB_83
SVX_174:
    v_swap_b32 v242, v244
    v_swap_b32 v243, v245
    s_branch SVB_83_AFTER
SVS_86:
    s_add_u32 s100, s100, 1
    s_cmp_gt_u32 s100, 200000
    s_cbranch_scc1 SVX_175
    s_waitcnt vmcnt(0)
    s_add_u32 s35, s26, 1310720
    buffer_load_dwordx4 v[168:171], v4, s[8:11], s35 offen sc1
    buffer_load_dwordx4 v[172:175], v5, s[8:11], s35 offen sc1
    s_add_u32 s35, s26, 1441792
    buffer_load_dwordx4 v[176:179], v4, s[8:11], s35 offen sc1
    buffer_load_dwordx4 v[180:183], v5, s[8:11], s35 offen sc1
    s_add_u32 s35, s26, 1572864
    buffer_load_dwordx4 v[184:187], v4, s[8:11], s35 offen sc1
    buffer_load_dwordx4 v[188:191], v5, s[8:11], s35 offen sc1
    s_add_u32 s35, s26, 1703936
    buffer_load_dwordx4 v[192:195], v4, s[8:11], s35 offen sc1
    buffer_load_dwordx4 v[196:199], v5, s[8:11], s35 offen sc1
    s_add_u32 s35, s26, 1835008
    buffer_load_dwordx4 v[200:203], v4, s[8:11], s35 offen sc1
    buffer_load_dwordx4 v[204:207], v5, s[8:11], s35 offen sc1
    s_add_u32 s35, s26, 1966080
    buffer_load_dwordx4 v[208:211], v4, s[8:11], s35 offen sc1
    buffer_load_dwordx4 v[212:215], v5, s[8:11], s35 offen sc1
    s_add_u32 s35, s26, 2097152
    buffer_load_dwordx4 v[216:219], v4, s[8:11], s35 offen sc1
    buffer_load_dwordx4 v[220:223], v5, s[8:11], s35 offen sc1
    s_add_u32 s35, s26, 2228224
    buffer_load_dwordx4 v[224:227], v4, s[8:11], s35 offen sc1
    buffer_load_dwordx4 v[228:231], v5, s[8:11], s35 offen sc1
    s_add_u32 s35, s26, 2359296
    buffer_load_dwordx4 v[232:235], v4, s[8:11], s35 offen sc1
    buffer_load_dwordx4 v[236:239], v5, s[8:11], s35 offen sc1
    s_waitcnt vmcnt(16)
    s_branch SVB_85
SVX_175:
    v_swap_b32 v170, v172
    v_swap_b32 v171, v173
    s_branch SVB_85_AFTER
SVS_88:
    s_add_u32 s100, s100, 1
    s_cmp_gt_u32 s100, 200000
    s_cbranch_scc1 SVX_176
    s_waitcnt vmcnt(0)
    s_add_u32 s35, s26, 1441792
    buffer_load_dwordx4 v[176:179], v4, s[8:11], s35 offen sc1
    buffer_load_dwordx4 v[180:183], v5, s[8:11], s35 offen sc1
    s_add_u32 s35, s26, 1572864
    buffer_load_dwordx4 v[184:187], v4, s[8:11], s35 offen sc1
    buffer_load_dwordx4 v[188:191], v5, s[8:11], s35 offen sc1
    s_add_u32 s35, s26, 1703936
    buffer_load_dwordx4 v[192:195], v4, s[8:11], s35 offen sc1
    buffer_load_dwordx4 v[196:199], v5, s[8:11], s35 offen sc1
    s_add_u32 s35, s26, 1835008
    buffer_load_dwordx4 v[200:203], v4, s[8:11], s35 offen sc1
    buffer_load_dwordx4 v[204:207], v5, s[8:11], s35 offen sc1
    s_add_u32 s35, s26, 1966080
    buffer_load_dwordx4 v[208:211], v4, s[8:11], s35 offen sc1
    buffer_load_dwordx4 v[212:215], v5, s[8:11], s35 offen sc1
    s_add_u32 s35, s26, 2097152
    buffer_load_dwordx4 v[216:219], v4, s[8:11], s35 offen sc1
    buffer_load_dwordx4 v[220:223], v5, s[8:11], s35 offen sc1
    s_add_u32 s35, s26, 2228224
    buffer_load_dwordx4 v[224:227], v4, s[8:11], s35 offen sc1
    buffer_load_dwordx4 v[228:231], v5, s[8:11], s35 offen sc1
    s_add_u32 s35, s26, 2359296
    buffer_load_dwordx4 v[232:235], v4, s[8:11], s35 offen sc1
    buffer_load_dwordx4 v[236:239], v5, s[8:11], s35 offen sc1
    s_add_u32 s35, s26, 2490368
    buffer_load_dwordx4 v[240:243], v4, s[8:11], s35 offen sc1
    buffer_load_dwordx4 v[244:247], v5, s[8:11], s35 offen sc1
    s_waitcnt vmcnt(16)
    s_branch SVB_87
SVX_176:
    v_swap_b32 v178, v180
    v_swap_b32 v179, v181
    s_branch SVB_87_AFTER
SVS_90:
    s_add_u32 s100, s100, 1
    s_cmp_gt_u32 s100, 200000
    s_cbranch_scc1 SVX_177
    s_waitcnt vmcnt(0)
    s_add_u32 s35, s26, 1572864
    buffer_load_dwordx4 v[184:187], v4, s[8:11], s35 offen sc1
    buffer_load_dwordx4 v[188:191], v5, s[8:11], s35 offen sc1
    s_add_u32 s35, s26, 1703936
    buffer_load_dwordx4 v[192:195], v4, s[8:11], s35 offen sc1
    buffer_load_dwordx4 v[196:199], v5, s[8:11], s35 offen sc1
    s_add_u32 s35, s26, 1835008
    buffer_load_dwordx4 v[200:203], v4, s[8:11], s35 offen sc1
    buffer_load_dwordx4 v[204:207], v5, s[8:11], s35 offen sc1
    s_add_u32 s35, s26, 1966080
    buffer_load_dwordx4 v[208:211], v4, s[8:11], s35 offen sc1
    buffer_load_dwordx4 v[212:215], v5, s[8:11], s35 offen sc1
    s_add_u32 s35, s26, 2097152
    buffer_load_dwordx4 v[216:219], v4, s[8:11], s35 offen sc1
    buffer_load_dwordx4 v[220:223], v5, s[8:11], s35 offen sc1
    s_add_u32 s35, s26, 2228224
    buffer_load_dwordx4 v[224:227], v4, s[8:11], s35 offen sc1
    buffer_load_dwordx4 v[228:231], v5, s[8:11], s35 offen sc1
    s_add_u32 s35, s26, 2359296
    buffer_load_dwordx4 v[232:235], v4, s[8:11], s35 offen sc1
    buffer_load_dwordx4 v[236:239], v5, s[8:11], s35 offen sc1
    s_add_u32 s35, s26, 2490368
    buffer_load_dwordx4 v[240:243], v4, s[8:11], s35 offen sc1
    buffer_load_dwordx4 v[244:247], v5, s[8:11], s35 offen sc1
    s_waitcnt vmcnt(14)
    s_branch SVB_89
SVX_177:
    v_swap_b32 v186, v188
    v_swap_b32 v187, v189
    s_branch SVB_89_AFTER
SVS_92:
    s_add_u32 s100, s100, 1
    s_cmp_gt_u32 s100, 200000
    s_cbranch_scc1 SVX_178
    s_waitcnt vmcnt(0)
    s_add_u32 s35, s26, 1703936
    buffer_load_dwordx4 v[192:195], v4, s[8:11], s35 offen sc1
    buffer_load_dwordx4 v[196:199], v5, s[8:11], s35 offen sc1
    s_add_u32 s35, s26, 1835008
    buffer_load_dwordx4 v[200:203], v4, s[8:11], s35 offen sc1
    buffer_load_dwordx4 v[204:207], v5, s[8:11], s35 offen sc1
    s_add_u32 s35, s26, 1966080
    buffer_load_dwordx4 v[208:211], v4, s[8:11], s35 offen sc1
    buffer_load_dwordx4 v[212:215], v5, s[8:11], s35 offen sc1
    s_add_u32 s35, s26, 2097152
    buffer_load_dwordx4 v[216:219], v4, s[8:11], s35 offen sc1
    buffer_load_dwordx4 v[220:223], v5, s[8:11], s35 offen sc1
    s_add_u32 s35, s26, 2228224
    buffer_load_dwordx4 v[224:227], v4, s[8:11], s35 offen sc1
    buffer_load_dwordx4 v[228:231], v5, s[8:11], s35 offen sc1
    s_add_u32 s35, s26, 2359296
    buffer_load_dwordx4 v[232:235], v4, s[8:11], s35 offen sc1
    buffer_load_dwordx4 v[236:239], v5, s[8:11], s35 offen sc1
    s_add_u32 s35, s26, 2490368
    buffer_load_dwordx4 v[240:243], v4, s[8:11], s35 offen sc1
    buffer_load_dwordx4 v[244:247], v5, s[8:11], s35 offen sc1
    s_waitcnt vmcnt(12)
    s_branch SVB_91
SVX_178:
    v_swap_b32 v194, v196
    v_swap_b32 v195, v197
    s_branch SVB_91_AFTER
SVS_94:
    s_add_u32 s100, s100, 1
    s_cmp_gt_u32 s100, 200000
    s_cbranch_scc1 SVX_179
    s_waitcnt vmcnt(0)
    s_add_u32 s35, s26, 1835008
    buffer_load_dwordx4 v[200:203], v4, s[8:11], s35 offen sc1
    buffer_load_dwordx4 v[204:207], v5, s[8:11], s35 offen sc1
    s_add_u32 s35, s26, 1966080
    buffer_load_dwordx4 v[208:211], v4, s[8:11], s35 offen sc1
    buffer_load_dwordx4 v[212:215], v5, s[8:11], s35 offen sc1
    s_add_u32 s35, s26, 2097152
    buffer_load_dwordx4 v[216:219], v4, s[8:11], s35 offen sc1
    buffer_load_dwordx4 v[220:223], v5, s[8:11], s35 offen sc1
    s_add_u32 s35, s26, 2228224
    buffer_load_dwordx4 v[224:227], v4, s[8:11], s35 offen sc1
    buffer_load_dwordx4 v[228:231], v5, s[8:11], s35 offen sc1
    s_add_u32 s35, s26, 2359296
    buffer_load_dwordx4 v[232:235], v4, s[8:11], s35 offen sc1
    buffer_load_dwordx4 v[236:239], v5, s[8:11], s35 offen sc1
    s_add_u32 s35, s26, 2490368
    buffer_load_dwordx4 v[240:243], v4, s[8:11], s35 offen sc1
    buffer_load_dwordx4 v[244:247], v5, s[8:11], s35 offen sc1
    s_waitcnt vmcnt(10)
    s_branch SVB_93
SVX_179:
    v_swap_b32 v202, v204
    v_swap_b32 v203, v205
    s_branch SVB_93_AFTER
SVS_96:
    s_add_u32 s100, s100, 1
    s_cmp_gt_u32 s100, 200000
    s_cbranch_scc1 SVX_180
    s_waitcnt vmcnt(0)
    s_add_u32 s35, s26, 1966080
    buffer_load_dwordx4 v[208:211], v4, s[8:11], s35 offen sc1
    buffer_load_dwordx4 v[212:215], v5, s[8:11], s35 offen sc1
    s_add_u32 s35, s26, 2097152
    buffer_load_dwordx4 v[216:219], v4, s[8:11], s35 offen sc1
    buffer_load_dwordx4 v[220:223], v5, s[8:11], s35 offen sc1
    s_add_u32 s35, s26, 2228224
    buffer_load_dwordx4 v[224:227], v4, s[8:11], s35 offen sc1
    buffer_load_dwordx4 v[228:231], v5, s[8:11], s35 offen sc1
    s_add_u32 s35, s26, 2359296
    buffer_load_dwordx4 v[232:235], v4, s[8:11], s35 offen sc1
    buffer_load_dwordx4 v[236:239], v5, s[8:11], s35 offen sc1
    s_add_u32 s35, s26, 2490368
    buffer_load_dwordx4 v[240:243], v4, s[8:11], s35 offen sc1
    buffer_load_dwordx4 v[244:247], v5, s[8:11], s35 offen sc1
    s_waitcnt vmcnt(8)
    s_branch SVB_95
SVX_180:
    v_swap_b32 v210, v212
    v_swap_b32 v211, v213
    s_branch SVB_95_AFTER
SVS_98:
    s_add_u32 s100, s100, 1
    s_cmp_gt_u32 s100, 200000
    s_cbranch_scc1 SVX_181
    s_waitcnt vmcnt(0)
    s_add_u32 s35, s26, 2097152
    buffer_load_dwordx4 v[216:219], v4, s[8:11], s35 offen sc1
    buffer_load_dwordx4 v[220:223], v5, s[8:11], s35 offen sc1
    s_add_u32 s35, s26, 2228224
    buffer_load_dwordx4 v[224:227], v4, s[8:11], s35 offen sc1
    buffer_load_dwordx4 v[228:231], v5, s[8:11], s35 offen sc1
    s_add_u32 s35, s26, 2359296
    buffer_load_dwordx4 v[232:235], v4, s[8:11], s35 offen sc1
    buffer_load_dwordx4 v[236:239], v5, s[8:11], s35 offen sc1
    s_add_u32 s35, s26, 2490368
    buffer_load_dwordx4 v[240:243], v4, s[8:11], s35 offen sc1
    buffer_load_dwordx4 v[244:247], v5, s[8:11], s35 offen sc1
    s_waitcnt vmcnt(6)
    s_branch SVB_97
SVX_181:
    v_swap_b32 v218, v220
    v_swap_b32 v219, v221
    s_branch SVB_97_AFTER
SVS_100:
    s_add_u32 s100, s100, 1
    s_cmp_gt_u32 s100, 200000
    s_cbranch_scc1 SVX_182
    s_waitcnt vmcnt(0)
    s_add_u32 s35, s26, 2228224
    buffer_load_dwordx4 v[224:227], v4, s[8:11], s35 offen sc1
    buffer_load_dwordx4 v[228:231], v5, s[8:11], s35 offen sc1
    s_add_u32 s35, s26, 2359296
    buffer_load_dwordx4 v[232:235], v4, s[8:11], s35 offen sc1
    buffer_load_dwordx4 v[236:239], v5, s[8:11], s35 offen sc1
    s_add_u32 s35, s26, 2490368
    buffer_load_dwordx4 v[240:243], v4, s[8:11], s35 offen sc1
    buffer_load_dwordx4 v[244:247], v5, s[8:11], s35 offen sc1
    s_waitcnt vmcnt(4)
    s_branch SVB_99
SVX_182:
    v_swap_b32 v226, v228
    v_swap_b32 v227, v229
    s_branch SVB_99_AFTER
SVS_102:
    s_add_u32 s100, s100, 1
    s_cmp_gt_u32 s100, 200000
    s_cbranch_scc1 SVX_183
    s_waitcnt vmcnt(0)
    s_add_u32 s35, s26, 2359296
    buffer_load_dwordx4 v[232:235], v4, s[8:11], s35 offen sc1
    buffer_load_dwordx4 v[236:239], v5, s[8:11], s35 offen sc1
    s_add_u32 s35, s26, 2490368
    buffer_load_dwordx4 v[240:243], v4, s[8:11], s35 offen sc1
    buffer_load_dwordx4 v[244:247], v5, s[8:11], s35 offen sc1
    s_waitcnt vmcnt(2)
    s_branch SVB_101
SVX_183:
    v_swap_b32 v234, v236
    v_swap_b32 v235, v237
    s_branch SVB_101_AFTER
SVS_104:
    s_add_u32 s100, s100, 1
    s_cmp_gt_u32 s100, 200000
    s_cbranch_scc1 SVX_184
    s_waitcnt vmcnt(0)
    s_add_u32 s35, s26, 2490368
    buffer_load_dwordx4 v[240:243], v4, s[8:11], s35 offen sc1
    buffer_load_dwordx4 v[244:247], v5, s[8:11], s35 offen sc1
    s_waitcnt vmcnt(0)
    s_branch SVB_103
SVX_184:
    v_swap_b32 v242, v244
    v_swap_b32 v243, v245
    s_branch SVB_103_AFTER
SVS_110:
    s_add_u32 s100, s100, 1
    s_cmp_gt_u32 s100, 200000
    s_cbranch_scc1 SVX_185
    s_waitcnt vmcnt(0)
    s_mov_b32 s35, 0
    s_cmp_lg_u32 s53, 0
    s_cmov_b32 s35, 3538944
    s_add_u32 s35, s35, s56
    buffer_load_dwordx4 v[72:75], v4, s[8:11], s35 offen sc1
    buffer_load_dwordx4 v[76:79], v5, s[8:11], s35 offen sc1
    s_mov_b32 s35, 917504
    s_cmp_lg_u32 s53, 0
    s_cmov_b32 s35, 1835008
    s_add_u32 s35, s35, s56
    buffer_load_dwordx4 v[80:83], v4, s[8:11], s35 offen sc1
    buffer_load_dwordx4 v[84:87], v5, s[8:11], s35 offen sc1
    s_mov_b32 s35, 2228224
    s_cmp_lg_u32 s53, 0
    s_cmov_b32 s35, 3145728
    s_add_u32 s35, s35, s56
    buffer_load_dwordx4 v[96:99], v4, s[8:11], s35 offen sc1
    buffer_load_dwordx4 v[100:103], v5, s[8:11], s35 offen sc1
    s_mov_b32 s35, 4456448
    s_cmp_lg_u32 s53, 0
    s_cmov_b32 s35, 5373952
    s_add_u32 s35, s35, s56
    buffer_load_dwordx4 v[104:107], v4, s[8:11], s35 offen sc1
    buffer_load_dwordx4 v[108:111], v5, s[8:11], s35 offen sc1
    s_waitcnt vmcnt(6)
    s_branch SVB_109
SVX_185:
    v_swap_b32 v74, v76
    v_swap_b32 v75, v77
    s_branch SVB_109_AFTER
SVS_112:
    s_add_u32 s100, s100, 1
    s_cmp_gt_u32 s100, 200000
    s_cbranch_scc1 SVX_186
    s_waitcnt vmcnt(0)
    s_mov_b32 s35, 917504
    s_cmp_lg_u32 s53, 0
    s_cmov_b32 s35, 1835008
    s_add_u32 s35, s35, s56
    buffer_load_dwordx4 v[80:83], v4, s[8:11], s35 offen sc1
    buffer_load_dwordx4 v[84:87], v5, s[8:11], s35 offen sc1
    s_mov_b32 s35, 2228224
    s_cmp_lg_u32 s53, 0
    s_cmov_b32 s35, 3145728
    s_add_u32 s35, s35, s56
    buffer_load_dwordx4 v[96:99], v4, s[8:11], s35 offen sc1
    buffer_load_dwordx4 v[100:103], v5, s[8:11], s35 offen sc1
    s_mov_b32 s35, 4456448
    s_cmp_lg_u32 s53, 0
    s_cmov_b32 s35, 5373952
    s_add_u32 s35, s35, s56
    buffer_load_dwordx4 v[104:107], v4, s[8:11], s35 offen sc1
    buffer_load_dwordx4 v[108:111], v5, s[8:11], s35 offen sc1
    s_mov_b32 s35, 5767168
    s_cmp_lg_u32 s53, 0
    s_cmov_b32 s35, 6684672
    s_add_u32 s35, s35, s56
    buffer_load_dwordx4 v[148:151], v4, s[8:11], s35 offen sc1
    buffer_load_dwordx4 v[152:155], v5, s[8:11], s35 offen sc1
    s_waitcnt vmcnt(6)
    s_branch SVB_111
SVX_186:
    v_swap_b32 v82, v84
    v_swap_b32 v83, v85
    s_branch SVB_111_AFTER
SVS_114:
    s_add_u32 s100, s100, 1
    s_cmp_gt_u32 s100, 200000
    s_cbranch_scc1 SVX_187
    s_waitcnt vmcnt(0)
    s_mov_b32 s35, 2228224
    s_cmp_lg_u32 s53, 0
    s_cmov_b32 s35, 3145728
    s_add_u32 s35, s35, s56
    buffer_load_dwordx4 v[96:99], v4, s[8:11], s35 offen sc1
    buffer_load_dwordx4 v[100:103], v5, s[8:11], s35 offen sc1
    s_mov_b32 s35, 4456448
    s_cmp_lg_u32 s53, 0
    s_cmov_b32 s35, 5373952
    s_add_u32 s35, s35, s56
    buffer_load_dwordx4 v[104:107], v4, s[8:11], s35 offen sc1
    buffer_load_dwordx4 v[108:111], v5, s[8:11], s35 offen sc1
    s_mov_b32 s35, 5767168
    s_cmp_lg_u32 s53, 0
    s_cmov_b32 s35, 6684672
    s_add_u32 s35, s35, s56
    buffer_load_dwordx4 v[148:151], v4, s[8:11], s35 offen sc1
    buffer_load_dwordx4 v[152:155], v5, s[8:11], s35 offen sc1
    s_mov_b32 s35, 131072
    s_cmp_lg_u32 s53, 0
    s_cmov_b32 s35, 524288
    s_add_u32 s35, s35, s56
    buffer_load_dwordx4 v[72:75], v4, s[8:11], s35 offen sc1
    buffer_load_dwordx4 v[76:79], v5, s[8:11], s35 offen sc1
    s_waitcnt vmcnt(6)
    s_branch SVB_113
SVX_187:
    v_swap_b32 v98, v100
    v_swap_b32 v99, v101
    s_branch SVB_113_AFTER
SVS_116:
    s_add_u32 s100, s100, 1
    s_cmp_gt_u32 s100, 200000
    s_cbranch_scc1 SVX_188
    s_waitcnt vmcnt(0)
    s_mov_b32 s35, 4456448
    s_cmp_lg_u32 s53, 0
    s_cmov_b32 s35, 5373952
    s_add_u32 s35, s35, s56
    buffer_load_dwordx4 v[104:107], v4, s[8:11], s35 offen sc1
    buffer_load_dwordx4 v[108:111], v5, s[8:11], s35 offen sc1
    s_mov_b32 s35, 5767168
    s_cmp_lg_u32 s53, 0
    s_cmov_b32 s35, 6684672
    s_add_u32 s35, s35, s56
    buffer_load_dwordx4 v[148:151], v4, s[8:11], s35 offen sc1
    buffer_load_dwordx4 v[152:155], v5, s[8:11], s35 offen sc1
    s_mov_b32 s35, 131072
    s_cmp_lg_u32 s53, 0
    s_cmov_b32 s35, 524288
    s_add_u32 s35, s35, s56
    buffer_load_dwordx4 v[72:75], v4, s[8:11], s35 offen sc1
    buffer_load_dwordx4 v[76:79], v5, s[8:11], s35 offen sc1
    s_mov_b32 s35, 1441792
    s_cmp_lg_u32 s53, 0
    s_cmov_b32 s35, 2752512
    s_add_u32 s35, s35, s56
    buffer_load_dwordx4 v[80:83], v4, s[8:11], s35 offen sc1
    buffer_load_dwordx4 v[84:87], v5, s[8:11], s35 offen sc1
    s_waitcnt vmcnt(6)
    s_branch SVB_115
SVX_188:
    v_swap_b32 v106, v108
    v_swap_b32 v107, v109
    s_branch SVB_115_AFTER
SVS_118:
    s_add_u32 s100, s100, 1
    s_cmp_gt_u32 s100, 200000
    s_cbranch_scc1 SVX_189
    s_waitcnt vmcnt(0)
    s_mov_b32 s35, 5767168
    s_cmp_lg_u32 s53, 0
    s_cmov_b32 s35, 6684672
    s_add_u32 s35, s35, s56
    buffer_load_dwordx4 v[148:151], v4, s[8:11], s35 offen sc1
    buffer_load_dwordx4 v[152:155], v5, s[8:11], s35 offen sc1
    s_mov_b32 s35, 131072
    s_cmp_lg_u32 s53, 0
    s_cmov_b32 s35, 524288
    s_add_u32 s35, s35, s56
    buffer_load_dwordx4 v[72:75], v4, s[8:11], s35 offen sc1
    buffer_load_dwordx4 v[76:79], v5, s[8:11], s35 offen sc1
    s_mov_b32 s35, 1441792
    s_cmp_lg_u32 s53, 0
    s_cmov_b32 s35, 2752512
    s_add_u32 s35, s35, s56
    buffer_load_dwordx4 v[80:83], v4, s[8:11], s35 offen sc1
    buffer_load_dwordx4 v[84:87], v5, s[8:11], s35 offen sc1
    s_mov_b32 s35, 3670016
    s_cmp_lg_u32 s53, 0
    s_cmov_b32 s35, 4063232
    s_add_u32 s35, s35, s56
    buffer_load_dwordx4 v[96:99], v4, s[8:11], s35 offen sc1
    buffer_load_dwordx4 v[100:103], v5, s[8:11], s35 offen sc1
    s_waitcnt vmcnt(6)
    s_branch SVB_117
SVX_189:
    v_swap_b32 v150, v152
    v_swap_b32 v151, v153
    s_branch SVB_117_AFTER
SVS_120:
    s_add_u32 s100, s100, 1
    s_cmp_gt_u32 s100, 200000
    s_cbranch_scc1 SVX_190
    s_waitcnt vmcnt(0)
    s_mov_b32 s35, 131072
    s_cmp_lg_u32 s53, 0
    s_cmov_b32 s35, 524288
    s_add_u32 s35, s35, s56
    buffer_load_dwordx4 v[72:75], v4, s[8:11], s35 offen sc1
    buffer_load_dwordx4 v[76:79], v5, s[8:11], s35 offen sc1
    s_mov_b32 s35, 1441792
    s_cmp_lg_u32 s53, 0
    s_cmov_b32 s35, 2752512
    s_add_u32 s35, s35, s56
    buffer_load_dwordx4 v[80:83], v4, s[8:11], s35 offen sc1
    buffer_load_dwordx4 v[84:87], v5, s[8:11], s35 offen sc1
    s_mov_b32 s35, 3670016
    s_cmp_lg_u32 s53, 0
    s_cmov_b32 s35, 4063232
    s_add_u32 s35, s35, s56
    buffer_load_dwordx4 v[96:99], v4, s[8:11], s35 offen sc1
    buffer_load_dwordx4 v[100:103], v5, s[8:11], s35 offen sc1
    s_mov_b32 s35, 4980736
    s_cmp_lg_u32 s53, 0
    s_cmov_b32 s35, 6291456
    s_add_u32 s35, s35, s56
    buffer_load_dwordx4 v[104:107], v4, s[8:11], s35 offen sc1
    buffer_load_dwordx4 v[108:111], v5, s[8:11], s35 offen sc1
    s_waitcnt vmcnt(6)
    s_branch SVB_119
SVX_190:
    v_swap_b32 v74, v76
    v_swap_b32 v75, v77
    s_branch SVB_119_AFTER
SVS_122:
    s_add_u32 s100, s100, 1
    s_cmp_gt_u32 s100, 200000
    s_cbranch_scc1 SVX_191
    s_waitcnt vmcnt(0)
    s_mov_b32 s35, 1441792
    s_cmp_lg_u32 s53, 0
    s_cmov_b32 s35, 2752512
    s_add_u32 s35, s35, s56
    buffer_load_dwordx4 v[80:83], v4, s[8:11], s35 offen sc1
    buffer_load_dwordx4 v[84:87], v5, s[8:11], s35 offen sc1
    s_mov_b32 s35, 3670016
    s_cmp_lg_u32 s53, 0
    s_cmov_b32 s35, 4063232
    s_add_u32 s35, s35, s56
    buffer_load_dwordx4 v[96:99], v4, s[8:11], s35 offen sc1
    buffer_load_dwordx4 v[100:103], v5, s[8:11], s35 offen sc1
    s_mov_b32 s35, 4980736
    s_cmp_lg_u32 s53, 0
    s_cmov_b32 s35, 6291456
    s_add_u32 s35, s35, s56
    buffer_load_dwordx4 v[104:107], v4, s[8:11], s35 offen sc1
    buffer_load_dwordx4 v[108:111], v5, s[8:11], s35 offen sc1
    s_mov_b32 s35, 1048576
    s_cmp_lg_u32 s53, 0
    s_cmov_b32 s35, 1966080
    s_add_u32 s35, s35, s56
    buffer_load_dwordx4 v[148:151], v4, s[8:11], s35 offen sc1
    buffer_load_dwordx4 v[152:155], v5, s[8:11], s35 offen sc1
    s_waitcnt vmcnt(6)
    s_branch SVB_121
SVX_191:
    v_swap_b32 v82, v84
    v_swap_b32 v83, v85
    s_branch SVB_121_AFTER
SVS_124:
    s_add_u32 s100, s100, 1
    s_cmp_gt_u32 s100, 200000
    s_cbranch_scc1 SVX_192
    s_waitcnt vmcnt(0)
    s_mov_b32 s35, 3670016
    s_cmp_lg_u32 s53, 0
    s_cmov_b32 s35, 4063232
    s_add_u32 s35, s35, s56
    buffer_load_dwordx4 v[96:99], v4, s[8:11], s35 offen sc1
    buffer_load_dwordx4 v[100:103], v5, s[8:11], s35 offen sc1
    s_mov_b32 s35, 4980736
    s_cmp_lg_u32 s53, 0
    s_cmov_b32 s35, 6291456
    s_add_u32 s35, s35, s56
    buffer_load_dwordx4 v[104:107], v4, s[8:11], s35 offen sc1
    buffer_load_dwordx4 v[108:111], v5, s[8:11], s35 offen sc1
    s_mov_b32 s35, 1048576
    s_cmp_lg_u32 s53, 0
    s_cmov_b32 s35, 1966080
    s_add_u32 s35, s35, s56
    buffer_load_dwordx4 v[148:151], v4, s[8:11], s35 offen sc1
    buffer_load_dwordx4 v[152:155], v5, s[8:11], s35 offen sc1
    s_mov_b32 s35, 2359296
    s_cmp_lg_u32 s53, 0
    s_cmov_b32 s35, 3276800
    s_add_u32 s35, s35, s56
    buffer_load_dwordx4 v[72:75], v4, s[8:11], s35 offen sc1
    buffer_load_dwordx4 v[76:79], v5, s[8:11], s35 offen sc1
    s_waitcnt vmcnt(6)
    s_branch SVB_123
SVX_192:
    v_swap_b32 v98, v100
    v_swap_b32 v99, v101
    s_branch SVB_123_AFTER
SVS_126:
    s_add_u32 s100, s100, 1
    s_cmp_gt_u32 s100, 200000
    s_cbranch_scc1 SVX_193
    s_waitcnt vmcnt(0)
    s_mov_b32 s35, 4980736
    s_cmp_lg_u32 s53, 0
    s_cmov_b32 s35, 6291456
    s_add_u32 s35, s35, s56
    buffer_load_dwordx4 v[104:107], v4, s[8:11], s35 offen sc1
    buffer_load_dwordx4 v[108:111], v5, s[8:11], s35 offen sc1
    s_mov_b32 s35, 1048576
    s_cmp_lg_u32 s53, 0
    s_cmov_b32 s35, 1966080
    s_add_u32 s35, s35, s56
    buffer_load_dwordx4 v[148:151], v4, s[8:11], s35 offen sc1
    buffer_load_dwordx4 v[152:155], v5, s[8:11], s35 offen sc1
    s_mov_b32 s35, 2359296
    s_cmp_lg_u32 s53, 0
    s_cmov_b32 s35, 3276800
    s_add_u32 s35, s35, s56
    buffer_load_dwordx4 v[72:75], v4, s[8:11], s35 offen sc1
    buffer_load_dwordx4 v[76:79], v5, s[8:11], s35 offen sc1
    s_mov_b32 s35, 4587520
    s_cmp_lg_u32 s53, 0
    s_cmov_b32 s35, 5505024
    s_add_u32 s35, s35, s56
    buffer_load_dwordx4 v[80:83], v4, s[8:11], s35 offen sc1
    buffer_load_dwordx4 v[84:87], v5, s[8:11], s35 offen sc1
    s_waitcnt vmcnt(6)
    s_branch SVB_125
SVX_193:
    v_swap_b32 v106, v108
    v_swap_b32 v107, v109
    s_branch SVB_125_AFTER
SVS_128:
    s_add_u32 s100, s100, 1
    s_cmp_gt_u32 s100, 200000
    s_cbranch_scc1 SVX_194
    s_waitcnt vmcnt(0)
    s_mov_b32 s35, 1048576
    s_cmp_lg_u32 s53, 0
    s_cmov_b32 s35, 1966080
    s_add_u32 s35, s35, s56
    buffer_load_dwordx4 v[148:151], v4, s[8:11], s35 offen sc1
    buffer_load_dwordx4 v[152:155], v5, s[8:11], s35 offen sc1
    s_mov_b32 s35, 2359296
    s_cmp_lg_u32 s53, 0
    s_cmov_b32 s35, 3276800
    s_add_u32 s35, s35, s56
    buffer_load_dwordx4 v[72:75], v4, s[8:11], s35 offen sc1
    buffer_load_dwordx4 v[76:79], v5, s[8:11], s35 offen sc1
    s_mov_b32 s35, 4587520
    s_cmp_lg_u32 s53, 0
    s_cmov_b32 s35, 5505024
    s_add_u32 s35, s35, s56
    buffer_load_dwordx4 v[80:83], v4, s[8:11], s35 offen sc1
    buffer_load_dwordx4 v[84:87], v5, s[8:11], s35 offen sc1
    s_mov_b32 s35, 5898240
    s_cmp_lg_u32 s53, 0
    s_cmov_b32 s35, 6815744
    s_add_u32 s35, s35, s56
    buffer_load_dwordx4 v[96:99], v4, s[8:11], s35 offen sc1
    buffer_load_dwordx4 v[100:103], v5, s[8:11], s35 offen sc1
    s_waitcnt vmcnt(6)
    s_branch SVB_127
SVX_194:
    v_swap_b32 v150, v152
    v_swap_b32 v151, v153
    s_branch SVB_127_AFTER
SVS_130:
    s_add_u32 s100, s100, 1
    s_cmp_gt_u32 s100, 200000
    s_cbranch_scc1 SVX_195
    s_waitcnt vmcnt(0)
    s_mov_b32 s35, 2359296
    s_cmp_lg_u32 s53, 0
    s_cmov_b32 s35, 3276800
    s_add_u32 s35, s35, s56
    buffer_load_dwordx4 v[72:75], v4, s[8:11], s35 offen sc1
    buffer_load_dwordx4 v[76:79], v5, s[8:11], s35 offen sc1
    s_mov_b32 s35, 4587520
    s_cmp_lg_u32 s53, 0
    s_cmov_b32 s35, 5505024
    s_add_u32 s35, s35, s56
    buffer_load_dwordx4 v[80:83], v4, s[8:11], s35 offen sc1
    buffer_load_dwordx4 v[84:87], v5, s[8:11], s35 offen sc1
    s_mov_b32 s35, 5898240
    s_cmp_lg_u32 s53, 0
    s_cmov_b32 s35, 6815744
    s_add_u32 s35, s35, s56
    buffer_load_dwordx4 v[96:99], v4, s[8:11], s35 offen sc1
    buffer_load_dwordx4 v[100:103], v5, s[8:11], s35 offen sc1
    s_mov_b32 s35, 262144
    s_cmp_lg_u32 s53, 0
    s_cmov_b32 s35, 655360
    s_add_u32 s35, s35, s56
    buffer_load_dwordx4 v[104:107], v4, s[8:11], s35 offen sc1
    buffer_load_dwordx4 v[108:111], v5, s[8:11], s35 offen sc1
    s_waitcnt vmcnt(6)
    s_branch SVB_129
SVX_195:
    v_swap_b32 v74, v76
    v_swap_b32 v75, v77
    s_branch SVB_129_AFTER
SVS_132:
    s_add_u32 s100, s100, 1
    s_cmp_gt_u32 s100, 200000
    s_cbranch_scc1 SVX_196
    s_waitcnt vmcnt(0)
    s_mov_b32 s35, 4587520
    s_cmp_lg_u32 s53, 0
    s_cmov_b32 s35, 5505024
    s_add_u32 s35, s35, s56
    buffer_load_dwordx4 v[80:83], v4, s[8:11], s35 offen sc1
    buffer_load_dwordx4 v[84:87], v5, s[8:11], s35 offen sc1
    s_mov_b32 s35, 5898240
    s_cmp_lg_u32 s53, 0
    s_cmov_b32 s35, 6815744
    s_add_u32 s35, s35, s56
    buffer_load_dwordx4 v[96:99], v4, s[8:11], s35 offen sc1
    buffer_load_dwordx4 v[100:103], v5, s[8:11], s35 offen sc1
    s_mov_b32 s35, 262144
    s_cmp_lg_u32 s53, 0
    s_cmov_b32 s35, 655360
    s_add_u32 s35, s35, s56
    buffer_load_dwordx4 v[104:107], v4, s[8:11], s35 offen sc1
    buffer_load_dwordx4 v[108:111], v5, s[8:11], s35 offen sc1
    s_mov_b32 s35, 1572864
    s_cmp_lg_u32 s53, 0
    s_cmov_b32 s35, 2883584
    s_add_u32 s35, s35, s56
    buffer_load_dwordx4 v[148:151], v4, s[8:11], s35 offen sc1
    buffer_load_dwordx4 v[152:155], v5, s[8:11], s35 offen sc1
    s_waitcnt vmcnt(6)
    s_branch SVB_131
SVX_196:
    v_swap_b32 v82, v84
    v_swap_b32 v83, v85
    s_branch SVB_131_AFTER
SVS_134:
    s_add_u32 s100, s100, 1
    s_cmp_gt_u32 s100, 200000
    s_cbranch_scc1 SVX_197
    s_waitcnt vmcnt(0)
    s_mov_b32 s35, 5898240
    s_cmp_lg_u32 s53, 0
    s_cmov_b32 s35, 6815744
    s_add_u32 s35, s35, s56
    buffer_load_dwordx4 v[96:99], v4, s[8:11], s35 offen sc1
    buffer_load_dwordx4 v[100:103], v5, s[8:11], s35 offen sc1
    s_mov_b32 s35, 262144
    s_cmp_lg_u32 s53, 0
    s_cmov_b32 s35, 655360
    s_add_u32 s35, s35, s56
    buffer_load_dwordx4 v[104:107], v4, s[8:11], s35 offen sc1
    buffer_load_dwordx4 v[108:111], v5, s[8:11], s35 offen sc1
    s_mov_b32 s35, 1572864
    s_cmp_lg_u32 s53, 0
    s_cmov_b32 s35, 2883584
    s_add_u32 s35, s35, s56
    buffer_load_dwordx4 v[148:151], v4, s[8:11], s35 offen sc1
    buffer_load_dwordx4 v[152:155], v5, s[8:11], s35 offen sc1
    s_mov_b32 s35, 3801088
    s_cmp_lg_u32 s53, 0
    s_cmov_b32 s35, 4194304
    s_add_u32 s35, s35, s56
    buffer_load_dwordx4 v[72:75], v4, s[8:11], s35 offen sc1
    buffer_load_dwordx4 v[76:79], v5, s[8:11], s35 offen sc1
    s_waitcnt vmcnt(6)
    s_branch SVB_133
SVX_197:
    v_swap_b32 v98, v100
    v_swap_b32 v99, v101
    s_branch SVB_133_AFTER
SVS_136:
    s_add_u32 s100, s100, 1
    s_cmp_gt_u32 s100, 200000
    s_cbranch_scc1 SVX_198
    s_waitcnt vmcnt(0)
    s_mov_b32 s35, 262144
    s_cmp_lg_u32 s53, 0
    s_cmov_b32 s35, 655360
    s_add_u32 s35, s35, s56
    buffer_load_dwordx4 v[104:107], v4, s[8:11], s35 offen sc1
    buffer_load_dwordx4 v[108:111], v5, s[8:11], s35 offen sc1
    s_mov_b32 s35, 1572864
    s_cmp_lg_u32 s53, 0
    s_cmov_b32 s35, 2883584
    s_add_u32 s35, s35, s56
    buffer_load_dwordx4 v[148:151], v4, s[8:11], s35 offen sc1
    buffer_load_dwordx4 v[152:155], v5, s[8:11], s35 offen sc1
    s_mov_b32 s35, 3801088
    s_cmp_lg_u32 s53, 0
    s_cmov_b32 s35, 4194304
    s_add_u32 s35, s35, s56
    buffer_load_dwordx4 v[72:75], v4, s[8:11], s35 offen sc1
    buffer_load_dwordx4 v[76:79], v5, s[8:11], s35 offen sc1
    s_mov_b32 s35, 5111808
    s_cmp_lg_u32 s53, 0
    s_cmov_b32 s35, 6422528
    s_add_u32 s35, s35, s56
    buffer_load_dwordx4 v[80:83], v4, s[8:11], s35 offen sc1
    buffer_load_dwordx4 v[84:87], v5, s[8:11], s35 offen sc1
    s_waitcnt vmcnt(6)
    s_branch SVB_135
SVX_198:
    v_swap_b32 v106, v108
    v_swap_b32 v107, v109
    s_branch SVB_135_AFTER
SVS_138:
    s_add_u32 s100, s100, 1
    s_cmp_gt_u32 s100, 200000
    s_cbranch_scc1 SVX_199
    s_waitcnt vmcnt(0)
    s_mov_b32 s35, 1572864
    s_cmp_lg_u32 s53, 0
    s_cmov_b32 s35, 2883584
    s_add_u32 s35, s35, s56
    buffer_load_dwordx4 v[148:151], v4, s[8:11], s35 offen sc1
    buffer_load_dwordx4 v[152:155], v5, s[8:11], s35 offen sc1
    s_mov_b32 s35, 3801088
    s_cmp_lg_u32 s53, 0
    s_cmov_b32 s35, 4194304
    s_add_u32 s35, s35, s56
    buffer_load_dwordx4 v[72:75], v4, s[8:11], s35 offen sc1
    buffer_load_dwordx4 v[76:79], v5, s[8:11], s35 offen sc1
    s_mov_b32 s35, 5111808
    s_cmp_lg_u32 s53, 0
    s_cmov_b32 s35, 6422528
    s_add_u32 s35, s35, s56
    buffer_load_dwordx4 v[80:83], v4, s[8:11], s35 offen sc1
    buffer_load_dwordx4 v[84:87], v5, s[8:11], s35 offen sc1
    s_mov_b32 s35, 393216
    s_cmp_lg_u32 s53, 0
    s_cmov_b32 s35, 786432
    s_add_u32 s35, s35, s56
    buffer_load_dwordx4 v[96:99], v4, s[8:11], s35 offen sc1
    buffer_load_dwordx4 v[100:103], v5, s[8:11], s35 offen sc1
    s_waitcnt vmcnt(6)
    s_branch SVB_137
SVX_199:
    v_swap_b32 v150, v152
    v_swap_b32 v151, v153
    s_branch SVB_137_AFTER
SVS_140:
    s_add_u32 s100, s100, 1
    s_cmp_gt_u32 s100, 200000
    s_cbranch_scc1 SVX_200
    s_waitcnt vmcnt(0)
    s_mov_b32 s35, 3801088
    s_cmp_lg_u32 s53, 0
    s_cmov_b32 s35, 4194304
    s_add_u32 s35, s35, s56
    buffer_load_dwordx4 v[72:75], v4, s[8:11], s35 offen sc1
    buffer_load_dwordx4 v[76:79], v5, s[8:11], s35 offen sc1
    s_mov_b32 s35, 5111808
    s_cmp_lg_u32 s53, 0
    s_cmov_b32 s35, 6422528
    s_add_u32 s35, s35, s56
    buffer_load_dwordx4 v[80:83], v4, s[8:11], s35 offen sc1
    buffer_load_dwordx4 v[84:87], v5, s[8:11], s35 offen sc1
    s_mov_b32 s35, 393216
    s_cmp_lg_u32 s53, 0
    s_cmov_b32 s35, 786432
    s_add_u32 s35, s35, s56
    buffer_load_dwordx4 v[96:99], v4, s[8:11], s35 offen sc1
    buffer_load_dwordx4 v[100:103], v5, s[8:11], s35 offen sc1
    s_mov_b32 s35, 1179648
    s_cmp_lg_u32 s53, 0
    s_cmov_b32 s35, 1310720
    s_add_u32 s35, s35, s56
    buffer_load_dwordx4 v[104:107], v4, s[8:11], s35 offen sc1
    buffer_load_dwordx4 v[108:111], v5, s[8:11], s35 offen sc1
    s_waitcnt vmcnt(6)
    s_branch SVB_139
SVX_200:
    v_swap_b32 v74, v76
    v_swap_b32 v75, v77
    s_branch SVB_139_AFTER
SVS_142:
    s_add_u32 s100, s100, 1
    s_cmp_gt_u32 s100, 200000
    s_cbranch_scc1 SVX_201
    s_waitcnt vmcnt(0)
    s_mov_b32 s35, 5111808
    s_cmp_lg_u32 s53, 0
    s_cmov_b32 s35, 6422528
    s_add_u32 s35, s35, s56
    buffer_load_dwordx4 v[80:83], v4, s[8:11], s35 offen sc1
    buffer_load_dwordx4 v[84:87], v5, s[8:11], s35 offen sc1
    s_mov_b32 s35, 393216
    s_cmp_lg_u32 s53, 0
    s_cmov_b32 s35, 786432
    s_add_u32 s35, s35, s56
    buffer_load_dwordx4 v[96:99], v4, s[8:11], s35 offen sc1
    buffer_load_dwordx4 v[100:103], v5, s[8:11], s35 offen sc1
    s_mov_b32 s35, 1179648
    s_cmp_lg_u32 s53, 0
    s_cmov_b32 s35, 1310720
    s_add_u32 s35, s35, s56
    buffer_load_dwordx4 v[104:107], v4, s[8:11], s35 offen sc1
    buffer_load_dwordx4 v[108:111], v5, s[8:11], s35 offen sc1
    s_mov_b32 s35, 1703936
    s_cmp_lg_u32 s53, 0
    s_cmov_b32 s35, 2097152
    s_add_u32 s35, s35, s56
    buffer_load_dwordx4 v[148:151], v4, s[8:11], s35 offen sc1
    buffer_load_dwordx4 v[152:155], v5, s[8:11], s35 offen sc1
    s_waitcnt vmcnt(6)
    s_branch SVB_141
SVX_201:
    v_swap_b32 v82, v84
    v_swap_b32 v83, v85
    s_branch SVB_141_AFTER
SVS_144:
    s_add_u32 s100, s100, 1
    s_cmp_gt_u32 s100, 200000
    s_cbranch_scc1 SVX_202
    s_waitcnt vmcnt(0)
    s_mov_b32 s35, 393216
    s_cmp_lg_u32 s53, 0
    s_cmov_b32 s35, 786432
    s_add_u32 s35, s35, s56
    buffer_load_dwordx4 v[96:99], v4, s[8:11], s35 offen sc1
    buffer_load_dwordx4 v[100:103], v5, s[8:11], s35 offen sc1
    s_mov_b32 s35, 1179648
    s_cmp_lg_u32 s53, 0
    s_cmov_b32 s35, 1310720
    s_add_u32 s35, s35, s56
    buffer_load_dwordx4 v[104:107], v4, s[8:11], s35 offen sc1
    buffer_load_dwordx4 v[108:111], v5, s[8:11], s35 offen sc1
    s_mov_b32 s35, 1703936
    s_cmp_lg_u32 s53, 0
    s_cmov_b32 s35, 2097152
    s_add_u32 s35, s35, s56
    buffer_load_dwordx4 v[148:151], v4, s[8:11], s35 offen sc1
    buffer_load_dwordx4 v[152:155], v5, s[8:11], s35 offen sc1
    s_mov_b32 s35, 2490368
    s_cmp_lg_u32 s53, 0
    s_cmov_b32 s35, 2621440
    s_add_u32 s35, s35, s56
    buffer_load_dwordx4 v[72:75], v4, s[8:11], s35 offen sc1
    buffer_load_dwordx4 v[76:79], v5, s[8:11], s35 offen sc1
    s_waitcnt vmcnt(6)
    s_branch SVB_143
SVX_202:
    v_swap_b32 v98, v100
    v_swap_b32 v99, v101
    s_branch SVB_143_AFTER
SVS_146:
    s_add_u32 s100, s100, 1
    s_cmp_gt_u32 s100, 200000
    s_cbranch_scc1 SVX_203
    s_waitcnt vmcnt(0)
    s_mov_b32 s35, 1179648
    s_cmp_lg_u32 s53, 0
    s_cmov_b32 s35, 1310720
    s_add_u32 s35, s35, s56
    buffer_load_dwordx4 v[104:107], v4, s[8:11], s35 offen sc1
    buffer_load_dwordx4 v[108:111], v5, s[8:11], s35 offen sc1
    s_mov_b32 s35, 1703936
    s_cmp_lg_u32 s53, 0
    s_cmov_b32 s35, 2097152
    s_add_u32 s35, s35, s56
    buffer_load_dwordx4 v[148:151], v4, s[8:11], s35 offen sc1
    buffer_load_dwordx4 v[152:155], v5, s[8:11], s35 offen sc1
    s_mov_b32 s35, 2490368
    s_cmp_lg_u32 s53, 0
    s_cmov_b32 s35, 2621440
    s_add_u32 s35, s35, s56
    buffer_load_dwordx4 v[72:75], v4, s[8:11], s35 offen sc1
    buffer_load_dwordx4 v[76:79], v5, s[8:11], s35 offen sc1
    s_mov_b32 s35, 3014656
    s_cmp_lg_u32 s53, 0
    s_cmov_b32 s35, 3407872
    s_add_u32 s35, s35, s56
    buffer_load_dwordx4 v[80:83], v4, s[8:11], s35 offen sc1
    buffer_load_dwordx4 v[84:87], v5, s[8:11], s35 offen sc1
    s_waitcnt vmcnt(6)
    s_branch SVB_145
SVX_203:
    v_swap_b32 v106, v108
    v_swap_b32 v107, v109
    s_branch SVB_145_AFTER
SVS_148:
    s_add_u32 s100, s100, 1
    s_cmp_gt_u32 s100, 200000
    s_cbranch_scc1 SVX_204
    s_waitcnt vmcnt(0)
    s_mov_b32 s35, 1703936
    s_cmp_lg_u32 s53, 0
    s_cmov_b32 s35, 2097152
    s_add_u32 s35, s35, s56
    buffer_load_dwordx4 v[148:151], v4, s[8:11], s35 offen sc1
    buffer_load_dwordx4 v[152:155], v5, s[8:11], s35 offen sc1
    s_mov_b32 s35, 2490368
    s_cmp_lg_u32 s53, 0
    s_cmov_b32 s35, 2621440
    s_add_u32 s35, s35, s56
    buffer_load_dwordx4 v[72:75], v4, s[8:11], s35 offen sc1
    buffer_load_dwordx4 v[76:79], v5, s[8:11], s35 offen sc1
    s_mov_b32 s35, 3014656
    s_cmp_lg_u32 s53, 0
    s_cmov_b32 s35, 3407872
    s_add_u32 s35, s35, s56
    buffer_load_dwordx4 v[80:83], v4, s[8:11], s35 offen sc1
    buffer_load_dwordx4 v[84:87], v5, s[8:11], s35 offen sc1
    s_mov_b32 s35, 3932160
    s_cmp_lg_u32 s53, 0
    s_cmov_b32 s35, 4325376
    s_add_u32 s35, s35, s56
    buffer_load_dwordx4 v[96:99], v4, s[8:11], s35 offen sc1
    buffer_load_dwordx4 v[100:103], v5, s[8:11], s35 offen sc1
    s_waitcnt vmcnt(6)
    s_branch SVB_147
SVX_204:
    v_swap_b32 v150, v152
    v_swap_b32 v151, v153
    s_branch SVB_147_AFTER
SVS_150:
    s_add_u32 s100, s100, 1
    s_cmp_gt_u32 s100, 200000
    s_cbranch_scc1 SVX_205
    s_waitcnt vmcnt(0)
    s_mov_b32 s35, 2490368
    s_cmp_lg_u32 s53, 0
    s_cmov_b32 s35, 2621440
    s_add_u32 s35, s35, s56
    buffer_load_dwordx4 v[72:75], v4, s[8:11], s35 offen sc1
    buffer_load_dwordx4 v[76:79], v5, s[8:11], s35 offen sc1
    s_mov_b32 s35, 3014656
    s_cmp_lg_u32 s53, 0
    s_cmov_b32 s35, 3407872
    s_add_u32 s35, s35, s56
    buffer_load_dwordx4 v[80:83], v4, s[8:11], s35 offen sc1
    buffer_load_dwordx4 v[84:87], v5, s[8:11], s35 offen sc1
    s_mov_b32 s35, 3932160
    s_cmp_lg_u32 s53, 0
    s_cmov_b32 s35, 4325376
    s_add_u32 s35, s35, s56
    buffer_load_dwordx4 v[96:99], v4, s[8:11], s35 offen sc1
    buffer_load_dwordx4 v[100:103], v5, s[8:11], s35 offen sc1
    s_mov_b32 s35, 4718592
    s_cmp_lg_u32 s53, 0
    s_cmov_b32 s35, 4849664
    s_add_u32 s35, s35, s56
    buffer_load_dwordx4 v[104:107], v4, s[8:11], s35 offen sc1
    buffer_load_dwordx4 v[108:111], v5, s[8:11], s35 offen sc1
    s_waitcnt vmcnt(6)
    s_branch SVB_149
SVX_205:
    v_swap_b32 v74, v76
    v_swap_b32 v75, v77
    s_branch SVB_149_AFTER
SVS_152:
    s_add_u32 s100, s100, 1
    s_cmp_gt_u32 s100, 200000
    s_cbranch_scc1 SVX_206
    s_waitcnt vmcnt(0)
    s_mov_b32 s35, 3014656
    s_cmp_lg_u32 s53, 0
    s_cmov_b32 s35, 3407872
    s_add_u32 s35, s35, s56
    buffer_load_dwordx4 v[80:83], v4, s[8:11], s35 offen sc1
    buffer_load_dwordx4 v[84:87], v5, s[8:11], s35 offen sc1
    s_mov_b32 s35, 3932160
    s_cmp_lg_u32 s53, 0
    s_cmov_b32 s35, 4325376
    s_add_u32 s35, s35, s56
    buffer_load_dwordx4 v[96:99], v4, s[8:11], s35 offen sc1
    buffer_load_dwordx4 v[100:103], v5, s[8:11], s35 offen sc1
    s_mov_b32 s35, 4718592
    s_cmp_lg_u32 s53, 0
    s_cmov_b32 s35, 4849664
    s_add_u32 s35, s35, s56
    buffer_load_dwordx4 v[104:107], v4, s[8:11], s35 offen sc1
    buffer_load_dwordx4 v[108:111], v5, s[8:11], s35 offen sc1
    s_mov_b32 s35, 5242880
    s_cmp_lg_u32 s53, 0
    s_cmov_b32 s35, 5636096
    s_add_u32 s35, s35, s56
    buffer_load_dwordx4 v[148:151], v4, s[8:11], s35 offen sc1
    buffer_load_dwordx4 v[152:155], v5, s[8:11], s35 offen sc1
    s_waitcnt vmcnt(6)
    s_branch SVB_151
SVX_206:
    v_swap_b32 v82, v84
    v_swap_b32 v83, v85
    s_branch SVB_151_AFTER
SVS_154:
    s_add_u32 s100, s100, 1
    s_cmp_gt_u32 s100, 200000
    s_cbranch_scc1 SVX_207
    s_waitcnt vmcnt(0)
    s_mov_b32 s35, 3932160
    s_cmp_lg_u32 s53, 0
    s_cmov_b32 s35, 4325376
    s_add_u32 s35, s35, s56
    buffer_load_dwordx4 v[96:99], v4, s[8:11], s35 offen sc1
    buffer_load_dwordx4 v[100:103], v5, s[8:11], s35 offen sc1
    s_mov_b32 s35, 4718592
    s_cmp_lg_u32 s53, 0
    s_cmov_b32 s35, 4849664
    s_add_u32 s35, s35, s56
    buffer_load_dwordx4 v[104:107], v4, s[8:11], s35 offen sc1
    buffer_load_dwordx4 v[108:111], v5, s[8:11], s35 offen sc1
    s_mov_b32 s35, 5242880
    s_cmp_lg_u32 s53, 0
    s_cmov_b32 s35, 5636096
    s_add_u32 s35, s35, s56
    buffer_load_dwordx4 v[148:151], v4, s[8:11], s35 offen sc1
    buffer_load_dwordx4 v[152:155], v5, s[8:11], s35 offen sc1
    s_mov_b32 s35, 6029312
    s_cmp_lg_u32 s53, 0
    s_cmov_b32 s35, 6160384
    s_add_u32 s35, s35, s56
    buffer_load_dwordx4 v[72:75], v4, s[8:11], s35 offen sc1
    buffer_load_dwordx4 v[76:79], v5, s[8:11], s35 offen sc1
    s_waitcnt vmcnt(6)
    s_branch SVB_153
SVX_207:
    v_swap_b32 v98, v100
    v_swap_b32 v99, v101
    s_branch SVB_153_AFTER
SVS_156:
    s_add_u32 s100, s100, 1
    s_cmp_gt_u32 s100, 200000
    s_cbranch_scc1 SVX_208
    s_waitcnt vmcnt(0)
    s_mov_b32 s35, 4718592
    s_cmp_lg_u32 s53, 0
    s_cmov_b32 s35, 4849664
    s_add_u32 s35, s35, s56
    buffer_load_dwordx4 v[104:107], v4, s[8:11], s35 offen sc1
    buffer_load_dwordx4 v[108:111], v5, s[8:11], s35 offen sc1
    s_mov_b32 s35, 5242880
    s_cmp_lg_u32 s53, 0
    s_cmov_b32 s35, 5636096
    s_add_u32 s35, s35, s56
    buffer_load_dwordx4 v[148:151], v4, s[8:11], s35 offen sc1
    buffer_load_dwordx4 v[152:155], v5, s[8:11], s35 offen sc1
    s_mov_b32 s35, 6029312
    s_cmp_lg_u32 s53, 0
    s_cmov_b32 s35, 6160384
    s_add_u32 s35, s35, s56
    buffer_load_dwordx4 v[72:75], v4, s[8:11], s35 offen sc1
    buffer_load_dwordx4 v[76:79], v5, s[8:11], s35 offen sc1
    s_mov_b32 s35, 6553600
    s_cmp_lg_u32 s53, 0
    s_cmov_b32 s35, 6946816
    s_add_u32 s35, s35, s56
    buffer_load_dwordx4 v[80:83], v4, s[8:11], s35 offen sc1
    buffer_load_dwordx4 v[84:87], v5, s[8:11], s35 offen sc1
    s_waitcnt vmcnt(6)
    s_branch SVB_155
SVX_208:
    v_swap_b32 v106, v108
    v_swap_b32 v107, v109
    s_branch SVB_155_AFTER
SVS_158:
    s_add_u32 s100, s100, 1
    s_cmp_gt_u32 s100, 200000
    s_cbranch_scc1 SVX_209
    s_waitcnt vmcnt(0)
    s_mov_b32 s35, 5242880
    s_cmp_lg_u32 s53, 0
    s_cmov_b32 s35, 5636096
    s_add_u32 s35, s35, s56
    buffer_load_dwordx4 v[148:151], v4, s[8:11], s35 offen sc1
    buffer_load_dwordx4 v[152:155], v5, s[8:11], s35 offen sc1
    s_mov_b32 s35, 6029312
    s_cmp_lg_u32 s53, 0
    s_cmov_b32 s35, 6160384
    s_add_u32 s35, s35, s56
    buffer_load_dwordx4 v[72:75], v4, s[8:11], s35 offen sc1
    buffer_load_dwordx4 v[76:79], v5, s[8:11], s35 offen sc1
    s_mov_b32 s35, 6553600
    s_cmp_lg_u32 s53, 0
    s_cmov_b32 s35, 6946816
    s_add_u32 s35, s35, s56
    buffer_load_dwordx4 v[80:83], v4, s[8:11], s35 offen sc1
    buffer_load_dwordx4 v[84:87], v5, s[8:11], s35 offen sc1
    s_waitcnt vmcnt(4)
    s_branch SVB_157
SVX_209:
    v_swap_b32 v150, v152
    v_swap_b32 v151, v153
    s_branch SVB_157_AFTER
SVS_160:
    s_add_u32 s100, s100, 1
    s_cmp_gt_u32 s100, 200000
    s_cbranch_scc1 SVX_210
    s_waitcnt vmcnt(0)
    s_mov_b32 s35, 6029312
    s_cmp_lg_u32 s53, 0
    s_cmov_b32 s35, 6160384
    s_add_u32 s35, s35, s56
    buffer_load_dwordx4 v[72:75], v4, s[8:11], s35 offen sc1
    buffer_load_dwordx4 v[76:79], v5, s[8:11], s35 offen sc1
    s_mov_b32 s35, 6553600
    s_cmp_lg_u32 s53, 0
    s_cmov_b32 s35, 6946816
    s_add_u32 s35, s35, s56
    buffer_load_dwordx4 v[80:83], v4, s[8:11], s35 offen sc1
    buffer_load_dwordx4 v[84:87], v5, s[8:11], s35 offen sc1
    s_waitcnt vmcnt(2)
    s_branch SVB_159
SVX_210:
    v_swap_b32 v74, v76
    v_swap_b32 v75, v77
    s_branch SVB_159_AFTER
SVS_162:
    s_add_u32 s100, s100, 1
    s_cmp_gt_u32 s100, 200000
    s_cbranch_scc1 SVX_211
    s_waitcnt vmcnt(0)
    s_mov_b32 s35, 6553600
    s_cmp_lg_u32 s53, 0
    s_cmov_b32 s35, 6946816
    s_add_u32 s35, s35, s56
    buffer_load_dwordx4 v[80:83], v4, s[8:11], s35 offen sc1
    buffer_load_dwordx4 v[84:87], v5, s[8:11], s35 offen sc1
    s_waitcnt vmcnt(0)
    s_branch SVB_161
SVX_211:
    v_swap_b32 v82, v84
    v_swap_b32 v83, v85
    s_branch SVB_161_AFTER
L_G1:
    v_mov_b32 v8, 161920
    v_mov_b32 v9, 1
    s_mov_b64 exec, 1
    ds_add_u32 v8, v9
    s_mov_b64 exec, -1
L_G1B:
    s_cmp_lg_u32 s24, 3
    s_cbranch_scc1 L_NOPOLL
    v_mbcnt_lo_u32_b32 v16, -1, 0
    v_mbcnt_hi_u32_b32 v16, -1, v16
    v_lshlrev_b32 v17, 7, v16
    v_and_b32 v18, 31, v16
    v_lshlrev_b32 v18, 7, v18
    v_add_u32 v18, 8192, v18
    s_mov_b32 s27, 0x35000
    s_mov_b32 s101, 0
POLL_212:
    s_add_u32 s101, s101, 1
    s_cmp_gt_u32 s101, 200000
    s_cbranch_scc1 POLLX_213
    buffer_load_dword v20, v17, s[8:11], s27 offen sc1
    buffer_load_dword v21, v18, s[8:11], s27 offen sc1
    s_waitcnt vmcnt(0)
    v_cmp_ne_u32 vcc, s49, v20
    v_cmp_ne_u32 s[34:35], s49, v21
    s_nop 0
    s_or_b64 vcc, vcc, s[34:35]
    s_cbranch_vccnz POLL_212
POLLX_213:
    v_mov_b32 v22, 161924
    v_mov_b32 v23, 1
    s_mov_b64 exec, 1
    ds_add_u32 v22, v23
    s_mov_b64 exec, -1
L_NOPOLL:
    v_mbcnt_lo_u32_b32 v1, -1, 0
    v_mbcnt_hi_u32_b32 v1, -1, v1
    v_min_u32 v8, 53, v1
    v_lshlrev_b32 v8, 6, v8
    s_mov_b32 s27, 0x1c000
    s_mov_b32 s101, 0
POLL_214:
    s_add_u32 s101, s101, 1
    s_cmp_gt_u32 s101, 200000
    s_cbranch_scc1 POLLX_215
    buffer_load_dword v10, v8, s[8:11], s27 offen sc1
    s_waitcnt vmcnt(0)
    v_cmp_ne_u32 vcc, s49, v10
    s_nop 0
    s_cbranch_vccnz POLL_214
POLLX_215:
    v_mov_b32 v8, 161944
    s_mov_b32 s101, 0
LW_216:
    s_add_u32 s101, s101, 1
    s_cmp_gt_u32 s101, 4000000
    s_cbranch_scc1 LWX_217
    ds_read_b32 v9, v8
    s_waitcnt lgkmcnt(0)
    v_readfirstlane_b32 s34, v9
    s_nop 0
    s_cmp_ge_u32 s34, 4
    s_cbranch_scc1 LWX_217
    s_branch LW_216
LWX_217:
    s_cmp_lg_u32 s24, 0
    s_cbranch_scc1 L_NOCS
    v_mov_b32 v8, 161924
    s_mov_b32 s101, 0
LW_218:
    s_add_u32 s101, s101, 1
    s_cmp_gt_u32 s101, 4000000
    s_cbranch_scc1 LWX_219
    ds_read_b32 v9, v8
    s_waitcnt lgkmcnt(0)
    v_readfirstlane_b32 s34, v9
    s_nop 0
    s_cmp_ge_u32 s34, 1
    s_cbranch_scc1 LWX_219
    s_branch LW_218
LWX_219:
    v_mbcnt_lo_u32_b32 v1, -1, 0
    v_mbcnt_hi_u32_b32 v1, -1, v1
    s_mov_b32 s16, s86
    s_mov_b32 s17, s87
    s_mov_b32 s18, 0xd80
    s_mov_b32 s19, 0x20000
    s_mul_i32 s34, s23, 432
    s_add_u32 s34, s34, 0x20000
    v_lshlrev_b32 v8, 4, v1
    s_mul_i32 s35, s23, 216
    v_lshlrev_b32 v9, 2, v1
    v_add_u32 v9, s35, v9
    buffer_load_dwordx4 v[16:19], v8, s[8:11], s34 offen sc1
    buffer_load_dword v20, v9, s[16:19], 0 offen
    v_add_u32 v8, 143360, v8
    v_lshlrev_b32 v9, 2, v1
    v_add_u32 v9, 143808, v9
    s_waitcnt vmcnt(0)
    s_mov_b32 exec_lo, 0x0fffffff
    s_mov_b32 exec_hi, 0
    ds_write_b128 v8, v[16:19]
    s_mov_b32 exec_lo, -1
    s_mov_b32 exec_hi, 0x00ffffff
    ds_write_b32 v9, v20
    s_mov_b64 exec, -1
    s_waitcnt lgkmcnt(0)
    v_mov_b32 v8, 161956
    v_mov_b32 v9, 1
    s_mov_b64 exec, 1
    ds_add_u32 v8, v9
    s_mov_b64 exec, -1
L_NOCS:
    s_lshr_b32 s50, s23, 3
    s_lshl_b32 s51, s22, 1
    s_add_u32 s50, s50, s51
    s_and_b32 s51, s23, 7
    s_mul_i32 s45, s51, 27
    s_lshr_b32 s45, s45, 3
    s_mov_b32 s45, 0
    s_and_b32 s52, s24, 1
    s_lshr_b32 s53, s24, 1
    v_mbcnt_lo_u32_b32 v1, -1, 0
    v_mbcnt_hi_u32_b32 v1, -1, v1
    v_lshlrev_b32 v6, 4, v1
    s_mul_i32 s46, s51, 276480
    s_add_u32 s46, s46, 0x4f0000
    s_mul_i32 s27, s24, 5120
    v_add_u32 v12, s27, v6
    v_add_u32 v13, 0x10000, v12
    s_mov_b32 s44, 0
    s_cmp_eq_u32 s24, 1
    s_cmov_b32 s44, 138240
    s_cmp_eq_u32 s24, 2
    s_cmov_b32 s44, 35840
    s_cmp_eq_u32 s24, 3
    s_cmov_b32 s44, 71680
    s_add_u32 s44, s44, s46
    buffer_load_dwordx4 v[16:19], v6, s[8:11], s44 offen offset:0 sc1
    buffer_load_dwordx4 v[20:23], v6, s[8:11], s44 offen offset:1024 sc1
    buffer_load_dwordx4 v[24:27], v6, s[8:11], s44 offen offset:2048 sc1
    buffer_load_dwordx4 v[28:31], v6, s[8:11], s44 offen offset:3072 sc1
    s_add_u32 s27, s44, 4096
    buffer_load_dwordx4 v[32:35], v6, s[8:11], s27 offen sc1
    s_waitcnt vmcnt(4)
    s_mov_b32 s44, 87040
    s_cmp_eq_u32 s24, 1
    s_cmov_b32 s44, 122880
    s_cmp_eq_u32 s24, 2
    s_cmov_b32 s44, 174080
    s_cmp_eq_u32 s24, 3
    s_cmov_b32 s44, 209920
    s_add_u32 s44, s44, s46
    buffer_load_dwordx4 v[36:39], v6, s[8:11], s44 offen offset:0 sc1
    s_waitcnt vmcnt(4)
    buffer_load_dwordx4 v[40:43], v6, s[8:11], s44 offen offset:1024 sc1
    s_waitcnt vmcnt(4)
    buffer_load_dwordx4 v[44:47], v6, s[8:11], s44 offen offset:2048 sc1
    s_waitcnt vmcnt(4)
    buffer_load_dwordx4 v[48:51], v6, s[8:11], s44 offen offset:3072 sc1
    s_waitcnt vmcnt(4)
    s_add_u32 s27, s44, 4096
    buffer_load_dwordx4 v[52:55], v6, s[8:11], s27 offen sc1
    s_waitcnt vmcnt(4)
    s_mov_b32 s44, 225280
    s_cmp_eq_u32 s24, 1
    s_cmov_b32 s44, 261120
    s_cmp_eq_u32 s24, 2
    s_cmov_b32 s44, 5120
    s_cmp_eq_u32 s24, 3
    s_cmov_b32 s44, 20480
    s_add_u32 s44, s44, s46
    buffer_load_dwordx4 v[56:59], v6, s[8:11], s44 offen offset:0 sc1
    s_waitcnt vmcnt(4)
    buffer_load_dwordx4 v[60:63], v6, s[8:11], s44 offen offset:1024 sc1
    s_waitcnt vmcnt(4)
    buffer_load_dwordx4 v[64:67], v6, s[8:11], s44 offen offset:2048 sc1
    s_waitcnt vmcnt(4)
    buffer_load_dwordx4 v[68:71], v6, s[8:11], s44 offen offset:3072 sc1
    s_waitcnt vmcnt(4)
    s_add_u32 s27, s44, 4096
    buffer_load_dwordx4 v[72:75], v6, s[8:11], s27 offen sc1
    s_waitcnt vmcnt(4)
    s_mov_b32 s44, 56320
    s_cmp_eq_u32 s24, 1
    s_cmov_b32 s44, 107520
    s_cmp_eq_u32 s24, 2
    s_cmov_b32 s44, 143360
    s_cmp_eq_u32 s24, 3
    s_cmov_b32 s44, 158720
    s_add_u32 s44, s44, s46
    buffer_load_dwordx4 v[76:79], v6, s[8:11], s44 offen offset:0 sc1
    s_waitcnt vmcnt(4)
    buffer_load_dwordx4 v[80:83], v6, s[8:11], s44 offen offset:1024 sc1
    s_waitcnt vmcnt(4)
    buffer_load_dwordx4 v[84:87], v6, s[8:11], s44 offen offset:2048 sc1
    s_waitcnt vmcnt(4)
    buffer_load_dwordx4 v[88:91], v6, s[8:11], s44 offen offset:3072 sc1
    s_waitcnt vmcnt(4)
    s_add_u32 s27, s44, 4096
    buffer_load_dwordx4 v[92:95], v6, s[8:11], s27 offen sc1
    s_waitcnt vmcnt(4)
    s_mov_b32 s44, 194560
    s_cmp_eq_u32 s24, 1
    s_cmov_b32 s44, 245760
    s_cmp_eq_u32 s24, 2
    s_cmov_b32 s44, 40960
    s_cmp_eq_u32 s24, 3
    s_cmov_b32 s44, 76800
    s_add_u32 s44, s44, s46
    buffer_load_dwordx4 v[96:99], v6, s[8:11], s44 offen offset:0 sc1
    s_waitcnt vmcnt(4)
    buffer_load_dwordx4 v[100:103], v6, s[8:11], s44 offen offset:1024 sc1
    s_waitcnt vmcnt(4)
    buffer_load_dwordx4 v[104:107], v6, s[8:11], s44 offen offset:2048 sc1
    s_waitcnt vmcnt(4)
    buffer_load_dwordx4 v[108:111], v6, s[8:11], s44 offen offset:3072 sc1
    s_waitcnt vmcnt(4)
    s_add_u32 s27, s44, 4096
    buffer_load_dwordx4 v[112:115], v6, s[8:11], s27 offen sc1
    s_waitcnt vmcnt(4)
    s_mov_b32 s44, 92160
    s_cmp_eq_u32 s24, 1
    s_cmov_b32 s44, 128000
    s_cmp_eq_u32 s24, 2
    s_cmov_b32 s44, 179200
    s_cmp_eq_u32 s24, 3
    s_cmov_b32 s44, 215040
    s_add_u32 s44, s44, s46
    buffer_load_dwordx4 v[116:119], v6, s[8:11], s44 offen offset:0 sc1
    s_waitcnt vmcnt(4)
    buffer_load_dwordx4 v[120:123], v6, s[8:11], s44 offen offset:1024 sc1
    s_waitcnt vmcnt(4)
    buffer_load_dwordx4 v[124:127], v6, s[8:11], s44 offen offset:2048 sc1
    s_waitcnt vmcnt(4)
    buffer_load_dwordx4 v[128:131], v6, s[8:11], s44 offen offset:3072 sc1
    s_waitcnt vmcnt(4)
    s_add_u32 s27, s44, 4096
    buffer_load_dwordx4 v[132:135], v6, s[8:11], s27 offen sc1
    s_waitcnt vmcnt(4)
    s_mov_b32 s44, 230400
    s_cmp_eq_u32 s24, 1
    s_cmov_b32 s44, 266240
    s_cmp_eq_u32 s24, 2
    s_cmov_b32 s44, 10240
    s_cmp_eq_u32 s24, 3
    s_cmov_b32 s44, 25600
    s_add_u32 s44, s44, s46
    buffer_load_dwordx4 v[136:139], v6, s[8:11], s44 offen offset:0 sc1
    s_waitcnt vmcnt(4)
    buffer_load_dwordx4 v[140:143], v6, s[8:11], s44 offen offset:1024 sc1
    s_waitcnt vmcnt(4)
    buffer_load_dwordx4 v[144:147], v6, s[8:11], s44 offen offset:2048 sc1
    s_waitcnt vmcnt(4)
    buffer_load_dwordx4 v[148:151], v6, s[8:11], s44 offen offset:3072 sc1
    s_waitcnt vmcnt(4)
    s_add_u32 s27, s44, 4096
    buffer_load_dwordx4 v[152:155], v6, s[8:11], s27 offen sc1
    s_waitcnt vmcnt(4)
    s_mov_b32 s44, 61440
    s_cmp_eq_u32 s24, 1
    s_cmov_b32 s44, 112640
    s_cmp_eq_u32 s24, 2
    s_cmov_b32 s44, 148480
    s_cmp_eq_u32 s24, 3
    s_cmov_b32 s44, 163840
    s_add_u32 s44, s44, s46
    buffer_load_dwordx4 v[156:159], v6, s[8:11], s44 offen offset:0 sc1
    s_waitcnt vmcnt(4)
    buffer_load_dwordx4 v[160:163], v6, s[8:11], s44 offen offset:1024 sc1
    s_waitcnt vmcnt(4)
    buffer_load_dwordx4 v[164:167], v6, s[8:11], s44 offen offset:2048 sc1
    s_waitcnt vmcnt(4)
    buffer_load_dwordx4 v[168:171], v6, s[8:11], s44 offen offset:3072 sc1
    s_waitcnt vmcnt(4)
    s_add_u32 s27, s44, 4096
    buffer_load_dwordx4 v[172:175], v6, s[8:11], s27 offen sc1
    s_waitcnt vmcnt(4)
    s_mov_b32 s44, 199680
    s_cmp_eq_u32 s24, 1
    s_cmov_b32 s44, 250880
    s_cmp_eq_u32 s24, 2
    s_cmov_b32 s44, 15360
    s_cmp_eq_u32 s24, 3
    s_cmov_b32 s44, 30720
    s_add_u32 s44, s44, s46
    buffer_load_dwordx4 v[176:179], v6, s[8:11], s44 offen offset:0 sc1
    s_waitcnt vmcnt(4)
    buffer_load_dwordx4 v[180:183], v6, s[8:11], s44 offen offset:1024 sc1
    s_waitcnt vmcnt(4)
    buffer_load_dwordx4 v[184:187], v6, s[8:11], s44 offen offset:2048 sc1
    s_waitcnt vmcnt(4)
    buffer_load_dwordx4 v[188:191], v6, s[8:11], s44 offen offset:3072 sc1
    s_waitcnt vmcnt(4)
    s_add_u32 s27, s44, 4096
    buffer_load_dwordx4 v[192:195], v6, s[8:11], s27 offen sc1
    s_waitcnt vmcnt(4)
    s_mov_b32 s44, 46080
    s_cmp_eq_u32 s24, 1
    s_cmov_b32 s44, 51200
    s_cmp_eq_u32 s24, 2
    s_cmov_b32 s44, 66560
    s_cmp_eq_u32 s24, 3
    s_cmov_b32 s44, 81920
    s_add_u32 s44, s44, s46
    buffer_load_dwordx4 v[196:199], v6, s[8:11], s44 offen offset:0 sc1
    s_waitcnt vmcnt(4)
    buffer_load_dwordx4 v[200:203], v6, s[8:11], s44 offen offset:1024 sc1
    s_waitcnt vmcnt(4)
    buffer_load_dwordx4 v[204:207], v6, s[8:11], s44 offen offset:2048 sc1
    s_waitcnt vmcnt(4)
    buffer_load_dwordx4 v[208:211], v6, s[8:11], s44 offen offset:3072 sc1
    s_waitcnt vmcnt(4)
    s_add_u32 s27, s44, 4096
    buffer_load_dwordx4 v[212:215], v6, s[8:11], s27 offen sc1
    s_waitcnt vmcnt(4)
    s_mov_b32 s44, 97280
    s_cmp_eq_u32 s24, 1
    s_cmov_b32 s44, 102400
    s_cmp_eq_u32 s24, 2
    s_cmov_b32 s44, 117760
    s_cmp_eq_u32 s24, 3
    s_cmov_b32 s44, 133120
    s_add_u32 s44, s44, s46
    buffer_load_dwordx4 v[216:219], v6, s[8:11], s44 offen offset:0 sc1
    s_waitcnt vmcnt(4)
    buffer_load_dwordx4 v[220:223], v6, s[8:11], s44 offen offset:1024 sc1
    s_waitcnt vmcnt(4)
    buffer_load_dwordx4 v[224:227], v6, s[8:11], s44 offen offset:2048 sc1
    s_waitcnt vmcnt(4)
    buffer_load_dwordx4 v[228:231], v6, s[8:11], s44 offen offset:3072 sc1
    s_waitcnt vmcnt(4)
    s_add_u32 s27, s44, 4096
    buffer_load_dwordx4 v[232:235], v6, s[8:11], s27 offen sc1
    s_waitcnt vmcnt(4)
    s_mov_b32 s44, 153600
    s_cmp_eq_u32 s24, 1
    s_cmov_b32 s44, 168960
    s_cmp_eq_u32 s24, 2
    s_cmov_b32 s44, 184320
    s_cmp_eq_u32 s24, 3
    s_cmov_b32 s44, 189440
    s_add_u32 s44, s44, s46
    buffer_load_dwordx4 v[236:239], v6, s[8:11], s44 offen offset:0 sc1
    s_waitcnt vmcnt(4)
    buffer_load_dwordx4 v[240:243], v6, s[8:11], s44 offen offset:1024 sc1
    s_waitcnt vmcnt(4)
    buffer_load_dwordx4 v[244:247], v6, s[8:11], s44 offen offset:2048 sc1
    s_waitcnt vmcnt(4)
    buffer_load_dwordx4 v[248:251], v6, s[8:11], s44 offen offset:3072 sc1
    s_waitcnt vmcnt(4)
    s_add_u32 s27, s44, 4096
    buffer_load_dwordx4 v[252:255], v6, s[8:11], s27 offen sc1
    s_waitcnt vmcnt(4)
    v_mov_b32 v8, 161928
    s_mov_b32 s101, 0
LW_220:
    s_add_u32 s101, s101, 1
    s_cmp_gt_u32 s101, 4000000
    s_cbranch_scc1 LWX_221
    ds_read_b32 v9, v8
    s_waitcnt lgkmcnt(0)
    v_readfirstlane_b32 s34, v9
    s_nop 0
    s_cmp_ge_u32 s34, 4
    s_cbranch_scc1 LWX_221
    s_branch LW_220
LWX_221:
    s_waitcnt vmcnt(59)
    ds_write_b128 v12, v[16:19] offset:0
    s_waitcnt vmcnt(58)
    ds_write_b128 v12, v[20:23] offset:1024
    s_waitcnt vmcnt(57)
    ds_write_b128 v12, v[24:27] offset:2048
    s_waitcnt vmcnt(56)
    ds_write_b128 v12, v[28:31] offset:3072
    s_waitcnt vmcnt(55)
    ds_write_b128 v12, v[32:35] offset:4096
    s_waitcnt vmcnt(54)
    ds_write_b128 v12, v[36:39] offset:20480
    s_waitcnt vmcnt(53)
    ds_write_b128 v12, v[40:43] offset:21504
    s_waitcnt vmcnt(52)
    ds_write_b128 v12, v[44:47] offset:22528
    s_waitcnt vmcnt(51)
    ds_write_b128 v12, v[48:51] offset:23552
    s_waitcnt vmcnt(50)
    ds_write_b128 v12, v[52:55] offset:24576
    s_waitcnt vmcnt(49)
    ds_write_b128 v12, v[56:59] offset:40960
    s_waitcnt vmcnt(48)
    ds_write_b128 v12, v[60:63] offset:41984
    s_waitcnt vmcnt(47)
    ds_write_b128 v12, v[64:67] offset:43008
    s_waitcnt vmcnt(46)
    ds_write_b128 v12, v[68:71] offset:44032
    s_waitcnt vmcnt(45)
    ds_write_b128 v12, v[72:75] offset:45056
    s_waitcnt vmcnt(44)
    ds_write_b128 v12, v[76:79] offset:61440
    s_waitcnt vmcnt(43)
    ds_write_b128 v12, v[80:83] offset:62464
    s_waitcnt vmcnt(42)
    ds_write_b128 v12, v[84:87] offset:63488
    s_waitcnt vmcnt(41)
    ds_write_b128 v12, v[88:91] offset:64512
    s_waitcnt vmcnt(40)
    ds_write_b128 v13, v[92:95] offset:0
    s_waitcnt vmcnt(39)
    ds_write_b128 v13, v[96:99] offset:16384
    s_waitcnt vmcnt(38)
    ds_write_b128 v13, v[100:103] offset:17408
    s_waitcnt vmcnt(37)
    ds_write_b128 v13, v[104:107] offset:18432
    s_waitcnt vmcnt(36)
    ds_write_b128 v13, v[108:111] offset:19456
    s_waitcnt vmcnt(35)
    ds_write_b128 v13, v[112:115] offset:20480
    s_waitcnt vmcnt(34)
    ds_write_b128 v13, v[116:119] offset:36864
    s_waitcnt vmcnt(33)
    ds_write_b128 v13, v[120:123] offset:37888
    s_waitcnt vmcnt(32)
    ds_write_b128 v13, v[124:127] offset:38912
    s_waitcnt vmcnt(31)
    ds_write_b128 v13, v[128:131] offset:39936
    s_waitcnt vmcnt(30)
    ds_write_b128 v13, v[132:135] offset:40960
    s_waitcnt lgkmcnt(0)
    v_mov_b32 v8, 161936
    v_mov_b32 v9, 1
    s_mov_b64 exec, 1
    ds_add_u32 v8, v9
    s_mov_b64 exec, -1
    v_mov_b32 v8, 161972
    s_mov_b32 s101, 0
LW_222:
    s_add_u32 s101, s101, 1
    s_cmp_gt_u32 s101, 4000000
    s_cbranch_scc1 LWX_223
    ds_read_b32 v9, v8
    s_waitcnt lgkmcnt(0)
    v_readfirstlane_b32 s34, v9
    s_nop 0
    s_cmp_ge_u32 s34, 4
    s_cbranch_scc1 LWX_223
    s_branch LW_222
LWX_223:
    s_mov_b32 s44, 204800
    s_cmp_eq_u32 s24, 1
    s_cmov_b32 s44, 220160
    s_cmp_eq_u32 s24, 2
    s_cmov_b32 s44, 235520
    s_cmp_eq_u32 s24, 3
    s_cmov_b32 s44, 240640
    s_add_u32 s44, s44, s46
    buffer_load_dwordx4 v[16:19], v6, s[8:11], s44 offen offset:0 sc1
    buffer_load_dwordx4 v[20:23], v6, s[8:11], s44 offen offset:1024 sc1
    buffer_load_dwordx4 v[24:27], v6, s[8:11], s44 offen offset:2048 sc1
    buffer_load_dwordx4 v[28:31], v6, s[8:11], s44 offen offset:3072 sc1
    s_add_u32 s27, s44, 4096
    buffer_load_dwordx4 v[32:35], v6, s[8:11], s27 offen sc1
    s_mov_b32 s44, 256000
    s_cmp_eq_u32 s24, 1
    s_cmov_b32 s44, 271360
    s_cmp_eq_u32 s24, 2
    s_cmov_b32 s44, 0
    s_cmp_eq_u32 s24, 3
    s_cmov_b32 s44, 0
    s_add_u32 s44, s44, s46
    buffer_load_dwordx4 v[36:39], v6, s[8:11], s44 offen offset:0 sc1
    buffer_load_dwordx4 v[40:43], v6, s[8:11], s44 offen offset:1024 sc1
    buffer_load_dwordx4 v[44:47], v6, s[8:11], s44 offen offset:2048 sc1
    buffer_load_dwordx4 v[48:51], v6, s[8:11], s44 offen offset:3072 sc1
    s_add_u32 s27, s44, 4096
    buffer_load_dwordx4 v[52:55], v6, s[8:11], s27 offen sc1
    s_barrier
    s_waitcnt vmcnt(39)
    ds_write_b128 v12, v[136:139] offset:0
    s_waitcnt vmcnt(38)
    ds_write_b128 v12, v[140:143] offset:1024
    s_waitcnt vmcnt(37)
    ds_write_b128 v12, v[144:147] offset:2048
    s_waitcnt vmcnt(36)
    ds_write_b128 v12, v[148:151] offset:3072
    s_waitcnt vmcnt(35)
    ds_write_b128 v12, v[152:155] offset:4096
    s_waitcnt vmcnt(34)
    ds_write_b128 v12, v[156:159] offset:20480
    s_waitcnt vmcnt(33)
    ds_write_b128 v12, v[160:163] offset:21504
    s_waitcnt vmcnt(32)
    ds_write_b128 v12, v[164:167] offset:22528
    s_waitcnt vmcnt(31)
    ds_write_b128 v12, v[168:171] offset:23552
    s_waitcnt vmcnt(30)
    ds_write_b128 v12, v[172:175] offset:24576
    s_waitcnt vmcnt(29)
    ds_write_b128 v12, v[176:179] offset:40960
    s_waitcnt vmcnt(28)
    ds_write_b128 v12, v[180:183] offset:41984
    s_waitcnt vmcnt(27)
    ds_write_b128 v12, v[184:187] offset:43008
    s_waitcnt vmcnt(26)
    ds_write_b128 v12, v[188:191] offset:44032
    s_waitcnt vmcnt(25)
    ds_write_b128 v12, v[192:195] offset:45056
    s_waitcnt lgkmcnt(0)
    s_barrier
    s_waitcnt vmcnt(24)
    ds_write_b128 v12, v[196:199] offset:61440
    s_waitcnt vmcnt(23)
    ds_write_b128 v12, v[200:203] offset:62464
    s_waitcnt vmcnt(22)
    ds_write_b128 v12, v[204:207] offset:63488
    s_waitcnt vmcnt(21)
    ds_write_b128 v12, v[208:211] offset:64512
    s_waitcnt vmcnt(20)
    ds_write_b128 v13, v[212:215] offset:0
    s_waitcnt vmcnt(19)
    ds_write_b128 v13, v[216:219] offset:16384
    s_waitcnt vmcnt(18)
    ds_write_b128 v13, v[220:223] offset:17408
    s_waitcnt vmcnt(17)
    ds_write_b128 v13, v[224:227] offset:18432
    s_waitcnt vmcnt(16)
    ds_write_b128 v13, v[228:231] offset:19456
    s_waitcnt vmcnt(15)
    ds_write_b128 v13, v[232:235] offset:20480
    s_waitcnt vmcnt(14)
    ds_write_b128 v13, v[236:239] offset:36864
    s_waitcnt vmcnt(13)
    ds_write_b128 v13, v[240:243] offset:37888
    s_waitcnt vmcnt(12)
    ds_write_b128 v13, v[244:247] offset:38912
    s_waitcnt vmcnt(11)
    ds_write_b128 v13, v[248:251] offset:39936
    s_waitcnt vmcnt(10)
    ds_write_b128 v13, v[252:255] offset:40960
    s_waitcnt lgkmcnt(0)
    s_barrier
    s_waitcnt vmcnt(9)
    ds_write_b128 v12, v[16:19] offset:0
    s_waitcnt vmcnt(8)
    ds_write_b128 v12, v[20:23] offset:1024
    s_waitcnt vmcnt(7)
    ds_write_b128 v12, v[24:27] offset:2048
    s_waitcnt vmcnt(6)
    ds_write_b128 v12, v[28:31] offset:3072
    s_waitcnt vmcnt(5)
    ds_write_b128 v12, v[32:35] offset:4096
    s_waitcnt vmcnt(4)
    ds_write_b128 v12, v[36:39] offset:20480
    s_waitcnt vmcnt(3)
    ds_write_b128 v12, v[40:43] offset:21504
    s_waitcnt vmcnt(2)
    ds_write_b128 v12, v[44:47] offset:22528
    s_waitcnt vmcnt(1)
    ds_write_b128 v12, v[48:51] offset:23552
    s_waitcnt vmcnt(0)
    ds_write_b128 v12, v[52:55] offset:24576
    s_waitcnt lgkmcnt(0)
    s_barrier
    s_barrier
    s_barrier
P_END:
    s_endpgm
.section .rodata,"a"
.p2align 6
.amdhsa_kernel sequential_preLN__ssm_conv_s4__dense_activation_mish__prompt_kernel
  .amdhsa_next_free_vgpr 256
  .amdhsa_next_free_sgpr 102
  .amdhsa_accum_offset 256
  .amdhsa_group_segment_fixed_size 0
  .amdhsa_kernarg_size 128
  .amdhsa_user_sgpr_count 2
  .amdhsa_user_sgpr_kernarg_segment_ptr 1
  .amdhsa_system_sgpr_workgroup_id_x 1
.end_amdhsa_kernel
```
